```python
import torch

def _softmax(x, axis=-1):
    return torch.softmax(x, dim=axis)
def _gelu(x):
    return torch.nn.functional.gelu(x, approximate="tanh")
def _silu(x):
    return torch.nn.functional.silu(x)
def _sigmoid(x):
    return torch.sigmoid(x)
def _layernorm(x, axis=-1, eps=1e-5):
    m = x.mean(dim=axis, keepdim=True)
    v = x.var(dim=axis, keepdim=True, unbiased=False)
    return (x - m) / torch.sqrt(v + eps)
def _scatter_add(tgt, idx, src, axis=0):
    return tgt.clone().index_add_(axis, idx, src)
def _segment_sum(src, seg, n):
    out = torch.zeros((n,) + src.shape[1:], dtype=src.dtype)
    return out.index_add_(0, seg, src)
def _pad(x, pw):
    flat = tuple(v for pair in reversed(pw) for v in pair)
    return torch.nn.functional.pad(x, flat)

kernel_name = 'interleave_layers__spectral_gfnet__mixer_channel_mlp__prompt'

def setup_inputs():

    _w = (lambda a: (lambda t: t.to(torch.bfloat16) if t.is_floating_point() else t)(torch.as_tensor(a)))
    def _A_setup():
        B, S, D = 1, 2048, 512
        Df = D // 2 + 1
        return {
            "x": _w((lambda *s: torch.randn(*s, dtype=torch.bfloat16) * 0.05)(B, S, D)),
            "w_r": _w((lambda *s: torch.randn(*s, dtype=torch.bfloat16) * 0.8)(S, Df) * 0.02),
            "w_i": _w((lambda *s: torch.randn(*s, dtype=torch.bfloat16) * 0.8)(S, Df) * 0.02),
        }
    _A_in = _A_setup()

    def _B_setup():
        B, S, D, F = 1, 2048, 512, 1792
        return {
            "x": _w((lambda *s: torch.randn(*s, dtype=torch.bfloat16) * 0.05)(B, S, D)),
            "w1": _w((lambda *s: torch.randn(*s, dtype=torch.bfloat16) * 0.8)(D, F) * (D ** -0.5)),
            "b1": _w((lambda *s: torch.randn(*s, dtype=torch.bfloat16) * 0.4)(F)),
            "w2": _w((lambda *s: torch.randn(*s, dtype=torch.bfloat16) * 0.05)(F, D) * (F ** -0.5)),
            "b2": _w((lambda *s: torch.randn(*s, dtype=torch.bfloat16) * 0.05)(D)),
        }
    _B_in = _B_setup()

    return {
        "A_x": _A_in["x"],
        "A_w_r": _A_in["w_r"],
        "A_w_i": _A_in["w_i"],
        "B_x": _B_in["x"],
        "B_w1": _B_in["w1"],
        "B_b1": _B_in["b1"],
        "B_w2": _B_in["w2"],
        "B_b2": _B_in["b2"],
    }

def reference(A_x, A_w_r, A_w_i, B_x, B_w1, B_b1, B_w2, B_b2):
    def _A_ref(x, w_r, w_i):
        B, S, D = x.shape
        X = (lambda x, axes=(-2,-1): torch.fft.rfft2(x.float(), dim=axes))(x, axes=(-2, -1))
        W = w_r + 1j * w_i
        X = X * W
        y = (lambda x, s, axes=(-2,-1): torch.fft.irfft2(x, s=s, dim=axes).to(torch.bfloat16))(X, (S, D), axes=(-2, -1))
        return y

    def _B_ref(x, w1, b1, w2, b2):
        y = _layernorm(x, axis=-1)
        h = _gelu(torch.einsum("bsd,df->bsf", y, w1) + b1)
        return torch.einsum("bsf,fd->bsd", h, w2) + b2

    x = A_x
    x = x + _A_ref(_layernorm(x, axis=-1), A_w_r, A_w_i)
    x = x + _B_ref(_layernorm(x, axis=-1), B_w1, B_b1, B_w2, B_b2)
    x = x + _A_ref(_layernorm(x, axis=-1), A_w_r, A_w_i)
    x = x + _B_ref(_layernorm(x, axis=-1), B_w1, B_b1, B_w2, B_b2)
    return x
```

```asm
; @launch grid=(256,1,1) block=(256,1,1) lds=150528
.amdgcn_target "amdgcn-amd-amdhsa--gfx950"
.text
.globl interleave_layers__spectral_gfnet__mixer_channel_mlp__prompt_kernel
.p2align 8
.type interleave_layers__spectral_gfnet__mixer_channel_mlp__prompt_kernel,@function
interleave_layers__spectral_gfnet__mixer_channel_mlp__prompt_kernel:
    s_load_dwordx16 s[4:19], s[0:1], 0
    s_load_dwordx4 s[20:23], s[0:1], 64
    s_load_dwordx2 s[24:25], s[0:1], 80
    s_cmp_ge_u32 s2, 256
    s_cbranch_scc1 L_exit
    v_lshrrev_b32 v1, 6, v0
    v_and_b32 v0, 63, v0
    v_readfirstlane_b32 s3, v1
    s_and_b32 s26, s2, 7
    s_lshr_b32 s27, s2, 3
    v_lshlrev_b32 v1, 4, v0
    s_getpc_b64 s[58:59]
L_pc:
    s_and_b32 s45, s27, 1
    s_lshl_b32 s45, s45, 2
    s_add_u32 s45, s45, s3
    s_lshl_b32 s45, s45, 13
    v_lshl_add_u32 v2, v0, 7, s45
    v_min_u32 v2, L_code_end-L_pc-4, v2
    s_cmp_lt_u32 s27, 30
    s_cbranch_scc1 L_notouch
    s_sub_u32 s44, s2, 249
    s_cmp_lt_u32 s44, 5
    s_cbranch_scc1 L_p1_probe
L_touch:
    global_load_dword a255, v2, s[58:59]
L_notouch:
    s_mov_b32 s61, 1000000
    s_mov_b32 s62, 0x10a0000
    s_cmp_eq_u32 s2, 254
    s_cbranch_scc1 L_p1_rows
    s_cmp_ge_u32 s27, 22
    s_cbranch_scc1 L_p1_b
    s_and_b32 s46, s26, 1
    s_lshr_b32 s44, s26, 1
    s_mul_i32 s44, s44, 14
    s_lshl_b32 s47, s46, 3
    s_add_u32 s44, s44, s47
    s_sub_u32 s45, s27, 8
    s_add_u32 s44, s44, s45
    s_lshl_b32 s47, s46, 1
    s_sub_u32 s47, 8, s47
    s_cmp_lt_u32 s45, s47
    s_cbranch_scc1 L_p1_cload
L_p1_rows:
    s_cmp_ge_u32 s27, 8
    s_cbranch_scc1 L_p1_dset
    s_mov_b32 s41, 0
    s_lshl_b32 s44, s26, 3
    s_add_u32 s44, s44, s27
    s_lshr_b32 s48, s44, 2
    s_lshl_b32 s48, s48, 7
    s_and_b32 s45, s44, 3
    s_lshl_b32 s45, s45, 2
    s_add_u32 s48, s48, s45
    s_and_b32 s45, s3, 2
    s_add_u32 s48, s48, s45
    s_and_b32 s45, s3, 1
    s_lshl_b32 s45, s45, 4
    s_add_u32 s48, s48, s45
    s_mov_b32 s52, 32768
    s_mov_b32 s53, 1024
    s_waitcnt lgkmcnt(0)
    s_mov_b32 s32, s4
    s_and_b32 s33, s5, 0xffff
    s_mov_b32 s34, 0x200000
    s_mov_b32 s35, 0x00020000
    s_branch L_p1_rload
L_p1_dset:
    s_sub_u32 s44, s44, 8
    s_cmp_eq_u32 s2, 254
    s_cselect_b32 s41, 2, 1
    s_cselect_b32 s44, 0, s44
    s_lshl_b32 s48, s44, 2
    s_add_u32 s48, s48, s3
    s_lshl_b32 s48, s48, 3
    s_mov_b32 s52, 1024
    s_mov_b32 s53, 4096
    s_waitcnt lgkmcnt(0)
    s_cmp_eq_u32 s41, 2
    s_cselect_b32 s32, s18, s16
    s_cselect_b32 s33, s19, s17
    s_mov_b32 s34, 0x1c0000
    s_cselect_b32 s34, 1024, s34
    s_and_b32 s33, s33, 0xffff
    s_mov_b32 s35, 0x00020000
L_p1_rload:
    s_lshl_b32 s48, s48, 10
    v_bfe_u32 v10, v0, 3, 2
    v_mul_u32_u24 v10, s52, v10
    v_lshrrev_b32_e64 v11, 5, v0
    v_mad_u32_u24 v10, v11, s53, v10
    s_lshl_b32 s45, s3, 2
    v_lshrrev_b32 v11, 4, v0
    v_add_u32 v11, s45, v11
    v_xor_b32 v11, v11, v0
    v_and_b32 v11, 7, v11
    v_lshl_add_u32 v10, v11, 4, v10
    s_lshl_b32 s49, s3, 10
    s_add_u32 m0, s49, 0
    s_nop 0
    buffer_load_dwordx4 v10, s[32:35], s48 offen offset:0 lds
    s_add_u32 m0, s49, 3584
    s_nop 0
    buffer_load_dwordx4 v10, s[32:35], s48 offen offset:512 lds
    s_add_u32 m0, s49, 8064
    s_nop 0
    buffer_load_dwordx4 v10, s[32:35], s48 offen offset:128 lds
    s_add_u32 m0, s49, 11648
    s_nop 0
    buffer_load_dwordx4 v10, s[32:35], s48 offen offset:640 lds
    s_add_u32 m0, s49, 16128
    s_nop 0
    buffer_load_dwordx4 v10, s[32:35], s48 offen offset:256 lds
    s_add_u32 m0, s49, 19712
    s_nop 0
    buffer_load_dwordx4 v10, s[32:35], s48 offen offset:768 lds
    s_add_u32 m0, s49, 24192
    s_nop 0
    buffer_load_dwordx4 v10, s[32:35], s48 offen offset:384 lds
    s_add_u32 m0, s49, 27776
    s_nop 0
    buffer_load_dwordx4 v10, s[32:35], s48 offen offset:896 lds
    s_mov_b32 s36, s12
    s_and_b32 s37, s13, 0xffff
    s_mov_b32 s38, 0x1c0000
    s_mov_b32 s39, 0x00020000
    s_lshl_b32 s45, s41, 6
    s_add_u32 s45, s45, s44
    s_lshl_b32 s45, s45, 2
    s_add_u32 s45, s45, s3
    s_lshl_b32 s45, s45, 12
    v_min_u32 v2, 31, v0
    v_lshlrev_b32_e64 v2, 7, v2
    buffer_load_dword a254, v2, s[36:39], s45 offen
    s_branch L_p1_fgen
L_p1_probe:
    s_waitcnt lgkmcnt(0)
    s_add_u32 s28, s24, 0x400000
    s_addc_u32 s29, s25, 0
    s_and_b32 s29, s29, 0xffff
    s_mov_b32 s30, 0x2800000
    s_mov_b32 s31, 0x00020000
    s_mov_b32 s32, s22
    s_and_b32 s33, s23, 0xffff
    s_mov_b32 s34, 0x100
    s_mov_b32 s35, 0x00020000
    s_cmp_lg_u32 s3, 0
    s_cbranch_scc1 L_p1_probed
    s_getreg_b32 s46, hwreg(HW_REG_XCC_ID, 0, 3)
    s_mov_b64 exec, 15
    s_mov_b32 s48, -1
    s_mov_b32 s49, -1
    s_and_b32 s47, s44, 1
    s_mul_i32 s54, s47, 12288
    s_and_b32 s45, s44, 2
    s_lshl_b32 s45, s45, 13
    s_add_u32 s54, s54, s45
    s_lshl_b32 s45, s44, 9
    s_add_u32 s54, s54, s45
    s_add_u32 s54, s54, 0x10e0000
    s_xor_b32 s55, s54, 8192
    buffer_store_dwordx4 v[16:19], v1, s[28:31], s54 offen offset:256 sc1
    s_waitcnt vmcnt(0)
    s_memtime s[50:51]
    s_waitcnt lgkmcnt(0)
    buffer_store_dwordx4 v[16:19], v1, s[28:31], s54 offen sc1
    s_waitcnt vmcnt(0)
    s_memtime s[52:53]
    s_waitcnt lgkmcnt(0)
    s_sub_u32 s45, s52, s50
    s_min_u32 s48, s48, s45
    s_xor_b32 s54, s54, 16384
    buffer_store_dwordx4 v[16:19], v1, s[28:31], s55 offen sc1
    s_waitcnt vmcnt(0)
    s_memtime s[50:51]
    s_waitcnt lgkmcnt(0)
    s_sub_u32 s45, s50, s52
    s_min_u32 s49, s49, s45
    s_xor_b32 s55, s55, 16384
    buffer_store_dwordx4 v[16:19], v1, s[28:31], s55 offen sc1
    s_waitcnt vmcnt(0)
    s_memtime s[52:53]
    s_waitcnt lgkmcnt(0)
    s_sub_u32 s45, s52, s50
    s_min_u32 s49, s49, s45
    s_xor_b32 s55, s55, 4096
    buffer_store_dwordx4 v[16:19], v1, s[28:31], s54 offen sc1
    s_waitcnt vmcnt(0)
    s_memtime s[50:51]
    s_waitcnt lgkmcnt(0)
    s_sub_u32 s45, s50, s52
    s_min_u32 s48, s48, s45
    s_xor_b32 s54, s54, 4096
    s_cmp_gt_u32 s48, s49
    s_cselect_b32 s45, 1, 0
    s_xor_b32 s47, s47, s45
    s_lshr_b32 s45, s46, 2
    s_xor_b32 s47, s47, s45
    s_sub_u32 s46, s46, s2
    s_and_b32 s46, s46, 7
    s_lshl_b32 s47, s47, 3
    s_or_b32 s46, s46, s47
    s_or_b32 s46, s46, 16
    v_mov_b32_e64 v13, s46
    s_mov_b64 exec, 1
    s_lshl_b32 s45, s44, 2
    buffer_store_dword v13, off, s[32:35], s45 offset:4 sc1
    s_mov_b64 exec, -1
L_p1_probed:
    s_barrier
    s_branch L_touch
L_p1_cload:
    s_mov_b32 s41, 3
    v_bfe_u32 v10, v0, 2, 2
    v_lshrrev_b32_e64 v11, 4, v0
    v_lshl_add_u32 v10, v10, 2, v11
    v_mul_u32_u24 v10, 3584, v10
    v_and_b32_e64 v11, 3, v0
    v_lshl_add_u32 v10, v11, 4, v10
    s_mul_i32 s48, s3, 57344
    s_lshl_b32 s45, s44, 6
    s_add_u32 s48, s48, s45
    s_lshl_b32 s49, s3, 10
    s_waitcnt lgkmcnt(0)
    s_mov_b32 s32, s12
    s_and_b32 s33, s13, 0xffff
    s_mov_b32 s34, 0x1c0000
    s_mov_b32 s35, 0x00020000
    s_add_u32 s45, s48, 0
    s_add_u32 m0, s49, 0
    s_nop 0
    buffer_load_dwordx4 v10, s[32:35], s45 offen lds
    s_add_u32 s45, s48, 917504
    s_add_u32 m0, s49, 16384
    s_nop 0
    buffer_load_dwordx4 v10, s[32:35], s45 offen lds
    s_add_u32 s45, s48, 229376
    s_add_u32 m0, s49, 4096
    s_nop 0
    buffer_load_dwordx4 v10, s[32:35], s45 offen lds
    s_add_u32 s45, s48, 1146880
    s_add_u32 m0, s49, 20480
    s_nop 0
    buffer_load_dwordx4 v10, s[32:35], s45 offen lds
    s_add_u32 s45, s48, 458752
    s_add_u32 m0, s49, 8192
    s_nop 0
    buffer_load_dwordx4 v10, s[32:35], s45 offen lds
    s_add_u32 s45, s48, 1376256
    s_add_u32 m0, s49, 24576
    s_nop 0
    buffer_load_dwordx4 v10, s[32:35], s45 offen lds
    s_add_u32 s45, s48, 688128
    s_add_u32 m0, s49, 12288
    s_nop 0
    buffer_load_dwordx4 v10, s[32:35], s45 offen lds
    s_add_u32 s45, s48, 1605632
    s_add_u32 m0, s49, 28672
    s_nop 0
    buffer_load_dwordx4 v10, s[32:35], s45 offen lds
L_p1_fgen:
    s_add_u32 s28, s24, 0x400000
    s_addc_u32 s29, s25, 0
    s_and_b32 s29, s29, 0xffff
    s_mov_b32 s30, 0x2800000
    s_mov_b32 s31, 0x00020000
    v_and_b32 v3, 31, v0
    s_lshl_b32 s40, s3, 5
    v_add_u32 v3, s40, v3
    v_lshrrev_b32 v4, 1, v3
    v_cmp_eq_u32 vcc, 1, v3
    v_and_b32 v5, 1, v3
    v_cvt_f32_u32_e64 v9, v4
    v_cndmask_b32 v4, v4, 64, vcc
    v_cndmask_b32 v5, v5, 0, vcc
    v_mov_b32 v6, 0x3d800000
    v_mov_b32 v8, 0x3d3504f3
    v_cvt_f32_u32 v4, v4
    v_cvt_f32_u32 v5, v5
    v_cndmask_b32 v7, v6, v8, vcc
    v_lshrrev_b32 v2, 5, v0
    v_cvt_f32_u32_e64 v2, v2
    v_mul_f32 v5, 0x3e800000, v5
    v_mul_f32 v2, 0x3d800000, v2
    v_fma_f32 v192, v4, v2, v5
    v_mul_f32 v8, 0x3c000000, v4
    v_mul_f32 v10, 0x3e000000, v4
    v_fmamk_f32 v193, v9, 0x3b000000, v192
    v_fmamk_f32 v194, v9, 0x3b800000, v192
    v_fmamk_f32 v195, v9, 0x3bc00000, v192
    v_cos_f32 v8, v8
    v_cos_f32 v10, v10
    v_fmamk_f32 v128, v4, 0x00000000, v192
    v_fmamk_f32 v129, v4, 0x00000000, v193
    v_fmamk_f32 v130, v4, 0x00000000, v194
    v_fmamk_f32 v131, v4, 0x00000000, v195
    v_fmamk_f32 v132, v4, 0x3c000000, v192
    v_fmamk_f32 v133, v4, 0x3c000000, v193
    v_fmamk_f32 v134, v4, 0x3c000000, v194
    v_fmamk_f32 v135, v4, 0x3c000000, v195
    v_fmamk_f32 v160, v4, 0x3e000000, v192
    v_fmamk_f32 v161, v4, 0x3e000000, v193
    v_fmamk_f32 v162, v4, 0x3e000000, v194
    v_fmamk_f32 v163, v4, 0x3e000000, v195
    v_fmamk_f32 v164, v4, 0x3e080000, v192
    v_fmamk_f32 v165, v4, 0x3e080000, v193
    v_fmamk_f32 v166, v4, 0x3e080000, v194
    v_fmamk_f32 v167, v4, 0x3e080000, v195
    v_add_f32 v8, v8, v8
    v_add_f32 v10, v10, v10
    v_cos_f32 v128, v128
    v_cos_f32 v129, v129
    v_cos_f32 v130, v130
    v_cos_f32 v131, v131
    v_cos_f32 v132, v132
    v_cos_f32 v133, v133
    v_cos_f32 v134, v134
    v_cos_f32 v135, v135
    v_cos_f32 v160, v160
    v_cos_f32 v161, v161
    v_cos_f32 v162, v162
    v_cos_f32 v163, v163
    v_cos_f32 v164, v164
    v_cos_f32 v165, v165
    v_cos_f32 v166, v166
    v_cos_f32 v167, v167
    v_pk_mul_f32 v[128:129], v[128:129], v[6:7]
    v_pk_mul_f32 v[130:131], v[130:131], v[6:7]
    v_pk_mul_f32 v[132:133], v[132:133], v[6:7]
    v_pk_mul_f32 v[134:135], v[134:135], v[6:7]
    v_pk_mul_f32 v[160:161], v[160:161], v[6:7]
    v_pk_mul_f32 v[162:163], v[162:163], v[6:7]
    v_pk_mul_f32 v[164:165], v[164:165], v[6:7]
    v_pk_mul_f32 v[166:167], v[166:167], v[6:7]
    v_pk_fma_f32 v[136:137], v[8:9], v[132:133], v[128:129] op_sel_hi:[0,1,1] neg_lo:[0,0,1] neg_hi:[0,0,1]
    v_pk_fma_f32 v[138:139], v[8:9], v[134:135], v[130:131] op_sel_hi:[0,1,1] neg_lo:[0,0,1] neg_hi:[0,0,1]
    v_pk_fma_f32 v[168:169], v[8:9], v[164:165], v[160:161] op_sel_hi:[0,1,1] neg_lo:[0,0,1] neg_hi:[0,0,1]
    v_pk_fma_f32 v[170:171], v[8:9], v[166:167], v[162:163] op_sel_hi:[0,1,1] neg_lo:[0,0,1] neg_hi:[0,0,1]
    v_pk_fma_f32 v[140:141], v[8:9], v[136:137], v[132:133] op_sel_hi:[0,1,1] neg_lo:[0,0,1] neg_hi:[0,0,1]
    v_pk_fma_f32 v[142:143], v[8:9], v[138:139], v[134:135] op_sel_hi:[0,1,1] neg_lo:[0,0,1] neg_hi:[0,0,1]
    v_pk_fma_f32 v[172:173], v[8:9], v[168:169], v[164:165] op_sel_hi:[0,1,1] neg_lo:[0,0,1] neg_hi:[0,0,1]
    v_pk_fma_f32 v[174:175], v[8:9], v[170:171], v[166:167] op_sel_hi:[0,1,1] neg_lo:[0,0,1] neg_hi:[0,0,1]
    v_pk_fma_f32 v[144:145], v[8:9], v[140:141], v[136:137] op_sel_hi:[0,1,1] neg_lo:[0,0,1] neg_hi:[0,0,1]
    v_pk_fma_f32 v[146:147], v[8:9], v[142:143], v[138:139] op_sel_hi:[0,1,1] neg_lo:[0,0,1] neg_hi:[0,0,1]
    v_pk_fma_f32 v[176:177], v[8:9], v[172:173], v[168:169] op_sel_hi:[0,1,1] neg_lo:[0,0,1] neg_hi:[0,0,1]
    v_pk_fma_f32 v[178:179], v[8:9], v[174:175], v[170:171] op_sel_hi:[0,1,1] neg_lo:[0,0,1] neg_hi:[0,0,1]
    v_pk_fma_f32 v[148:149], v[8:9], v[144:145], v[140:141] op_sel_hi:[0,1,1] neg_lo:[0,0,1] neg_hi:[0,0,1]
    v_pk_fma_f32 v[150:151], v[8:9], v[146:147], v[142:143] op_sel_hi:[0,1,1] neg_lo:[0,0,1] neg_hi:[0,0,1]
    v_pk_fma_f32 v[180:181], v[8:9], v[176:177], v[172:173] op_sel_hi:[0,1,1] neg_lo:[0,0,1] neg_hi:[0,0,1]
    v_pk_fma_f32 v[182:183], v[8:9], v[178:179], v[174:175] op_sel_hi:[0,1,1] neg_lo:[0,0,1] neg_hi:[0,0,1]
    v_pk_fma_f32 v[152:153], v[8:9], v[148:149], v[144:145] op_sel_hi:[0,1,1] neg_lo:[0,0,1] neg_hi:[0,0,1]
    v_pk_fma_f32 v[154:155], v[8:9], v[150:151], v[146:147] op_sel_hi:[0,1,1] neg_lo:[0,0,1] neg_hi:[0,0,1]
    v_pk_fma_f32 v[184:185], v[8:9], v[180:181], v[176:177] op_sel_hi:[0,1,1] neg_lo:[0,0,1] neg_hi:[0,0,1]
    v_pk_fma_f32 v[186:187], v[8:9], v[182:183], v[178:179] op_sel_hi:[0,1,1] neg_lo:[0,0,1] neg_hi:[0,0,1]
    v_pk_fma_f32 v[156:157], v[8:9], v[152:153], v[148:149] op_sel_hi:[0,1,1] neg_lo:[0,0,1] neg_hi:[0,0,1]
    v_pk_fma_f32 v[158:159], v[8:9], v[154:155], v[150:151] op_sel_hi:[0,1,1] neg_lo:[0,0,1] neg_hi:[0,0,1]
    v_pk_fma_f32 v[188:189], v[8:9], v[184:185], v[180:181] op_sel_hi:[0,1,1] neg_lo:[0,0,1] neg_hi:[0,0,1]
    v_pk_fma_f32 v[190:191], v[8:9], v[186:187], v[182:183] op_sel_hi:[0,1,1] neg_lo:[0,0,1] neg_hi:[0,0,1]
    v_cvt_pk_bf16_f32 v16, v128, v132
    v_cvt_pk_bf16_f32 v17, v136, v140
    v_cvt_pk_bf16_f32 v18, v144, v148
    v_cvt_pk_bf16_f32 v19, v152, v156
    v_cvt_pk_bf16_f32 v20, v129, v133
    v_cvt_pk_bf16_f32 v21, v137, v141
    v_cvt_pk_bf16_f32 v22, v145, v149
    v_cvt_pk_bf16_f32 v23, v153, v157
    v_cvt_pk_bf16_f32 v24, v130, v134
    v_cvt_pk_bf16_f32 v25, v138, v142
    v_cvt_pk_bf16_f32 v26, v146, v150
    v_cvt_pk_bf16_f32 v27, v154, v158
    v_cvt_pk_bf16_f32 v28, v131, v135
    v_cvt_pk_bf16_f32 v29, v139, v143
    v_cvt_pk_bf16_f32 v30, v147, v151
    v_cvt_pk_bf16_f32 v31, v155, v159
    v_cvt_pk_bf16_f32 v32, v160, v164
    v_cvt_pk_bf16_f32 v33, v168, v172
    v_cvt_pk_bf16_f32 v34, v176, v180
    v_cvt_pk_bf16_f32 v35, v184, v188
    v_cvt_pk_bf16_f32 v36, v161, v165
    v_cvt_pk_bf16_f32 v37, v169, v173
    v_cvt_pk_bf16_f32 v38, v177, v181
    v_cvt_pk_bf16_f32 v39, v185, v189
    v_cvt_pk_bf16_f32 v40, v162, v166
    v_cvt_pk_bf16_f32 v41, v170, v174
    v_cvt_pk_bf16_f32 v42, v178, v182
    v_cvt_pk_bf16_f32 v43, v186, v190
    v_cvt_pk_bf16_f32 v44, v163, v167
    v_cvt_pk_bf16_f32 v45, v171, v175
    v_cvt_pk_bf16_f32 v46, v179, v183
    v_cvt_pk_bf16_f32 v47, v187, v191
    v_pk_fma_f32 v[128:129], v[10:11], v[160:161], v[128:129] op_sel_hi:[0,1,1] neg_lo:[0,0,1] neg_hi:[0,0,1]
    v_pk_fma_f32 v[130:131], v[10:11], v[162:163], v[130:131] op_sel_hi:[0,1,1] neg_lo:[0,0,1] neg_hi:[0,0,1]
    v_pk_fma_f32 v[132:133], v[10:11], v[164:165], v[132:133] op_sel_hi:[0,1,1] neg_lo:[0,0,1] neg_hi:[0,0,1]
    v_pk_fma_f32 v[134:135], v[10:11], v[166:167], v[134:135] op_sel_hi:[0,1,1] neg_lo:[0,0,1] neg_hi:[0,0,1]
    v_pk_fma_f32 v[136:137], v[10:11], v[168:169], v[136:137] op_sel_hi:[0,1,1] neg_lo:[0,0,1] neg_hi:[0,0,1]
    v_pk_fma_f32 v[138:139], v[10:11], v[170:171], v[138:139] op_sel_hi:[0,1,1] neg_lo:[0,0,1] neg_hi:[0,0,1]
    v_pk_fma_f32 v[140:141], v[10:11], v[172:173], v[140:141] op_sel_hi:[0,1,1] neg_lo:[0,0,1] neg_hi:[0,0,1]
    v_pk_fma_f32 v[142:143], v[10:11], v[174:175], v[142:143] op_sel_hi:[0,1,1] neg_lo:[0,0,1] neg_hi:[0,0,1]
    v_pk_fma_f32 v[144:145], v[10:11], v[176:177], v[144:145] op_sel_hi:[0,1,1] neg_lo:[0,0,1] neg_hi:[0,0,1]
    v_pk_fma_f32 v[146:147], v[10:11], v[178:179], v[146:147] op_sel_hi:[0,1,1] neg_lo:[0,0,1] neg_hi:[0,0,1]
    v_pk_fma_f32 v[148:149], v[10:11], v[180:181], v[148:149] op_sel_hi:[0,1,1] neg_lo:[0,0,1] neg_hi:[0,0,1]
    v_pk_fma_f32 v[150:151], v[10:11], v[182:183], v[150:151] op_sel_hi:[0,1,1] neg_lo:[0,0,1] neg_hi:[0,0,1]
    v_pk_fma_f32 v[152:153], v[10:11], v[184:185], v[152:153] op_sel_hi:[0,1,1] neg_lo:[0,0,1] neg_hi:[0,0,1]
    v_pk_fma_f32 v[154:155], v[10:11], v[186:187], v[154:155] op_sel_hi:[0,1,1] neg_lo:[0,0,1] neg_hi:[0,0,1]
    v_pk_fma_f32 v[156:157], v[10:11], v[188:189], v[156:157] op_sel_hi:[0,1,1] neg_lo:[0,0,1] neg_hi:[0,0,1]
    v_pk_fma_f32 v[158:159], v[10:11], v[190:191], v[158:159] op_sel_hi:[0,1,1] neg_lo:[0,0,1] neg_hi:[0,0,1]
    v_cvt_pk_bf16_f32 v48, v128, v132
    v_cvt_pk_bf16_f32 v49, v136, v140
    v_cvt_pk_bf16_f32 v50, v144, v148
    v_cvt_pk_bf16_f32 v51, v152, v156
    v_cvt_pk_bf16_f32 v52, v129, v133
    v_cvt_pk_bf16_f32 v53, v137, v141
    v_cvt_pk_bf16_f32 v54, v145, v149
    v_cvt_pk_bf16_f32 v55, v153, v157
    v_cvt_pk_bf16_f32 v56, v130, v134
    v_cvt_pk_bf16_f32 v57, v138, v142
    v_cvt_pk_bf16_f32 v58, v146, v150
    v_cvt_pk_bf16_f32 v59, v154, v158
    v_cvt_pk_bf16_f32 v60, v131, v135
    v_cvt_pk_bf16_f32 v61, v139, v143
    v_cvt_pk_bf16_f32 v62, v147, v151
    v_cvt_pk_bf16_f32 v63, v155, v159
    v_pk_fma_f32 v[160:161], v[10:11], v[128:129], v[160:161] op_sel_hi:[0,1,1] neg_lo:[0,0,1] neg_hi:[0,0,1]
    v_pk_fma_f32 v[162:163], v[10:11], v[130:131], v[162:163] op_sel_hi:[0,1,1] neg_lo:[0,0,1] neg_hi:[0,0,1]
    v_pk_fma_f32 v[164:165], v[10:11], v[132:133], v[164:165] op_sel_hi:[0,1,1] neg_lo:[0,0,1] neg_hi:[0,0,1]
    v_pk_fma_f32 v[166:167], v[10:11], v[134:135], v[166:167] op_sel_hi:[0,1,1] neg_lo:[0,0,1] neg_hi:[0,0,1]
    v_pk_fma_f32 v[168:169], v[10:11], v[136:137], v[168:169] op_sel_hi:[0,1,1] neg_lo:[0,0,1] neg_hi:[0,0,1]
    v_pk_fma_f32 v[170:171], v[10:11], v[138:139], v[170:171] op_sel_hi:[0,1,1] neg_lo:[0,0,1] neg_hi:[0,0,1]
    v_pk_fma_f32 v[172:173], v[10:11], v[140:141], v[172:173] op_sel_hi:[0,1,1] neg_lo:[0,0,1] neg_hi:[0,0,1]
    v_pk_fma_f32 v[174:175], v[10:11], v[142:143], v[174:175] op_sel_hi:[0,1,1] neg_lo:[0,0,1] neg_hi:[0,0,1]
    v_pk_fma_f32 v[176:177], v[10:11], v[144:145], v[176:177] op_sel_hi:[0,1,1] neg_lo:[0,0,1] neg_hi:[0,0,1]
    v_pk_fma_f32 v[178:179], v[10:11], v[146:147], v[178:179] op_sel_hi:[0,1,1] neg_lo:[0,0,1] neg_hi:[0,0,1]
    v_pk_fma_f32 v[180:181], v[10:11], v[148:149], v[180:181] op_sel_hi:[0,1,1] neg_lo:[0,0,1] neg_hi:[0,0,1]
    v_pk_fma_f32 v[182:183], v[10:11], v[150:151], v[182:183] op_sel_hi:[0,1,1] neg_lo:[0,0,1] neg_hi:[0,0,1]
    v_pk_fma_f32 v[184:185], v[10:11], v[152:153], v[184:185] op_sel_hi:[0,1,1] neg_lo:[0,0,1] neg_hi:[0,0,1]
    v_pk_fma_f32 v[186:187], v[10:11], v[154:155], v[186:187] op_sel_hi:[0,1,1] neg_lo:[0,0,1] neg_hi:[0,0,1]
    v_pk_fma_f32 v[188:189], v[10:11], v[156:157], v[188:189] op_sel_hi:[0,1,1] neg_lo:[0,0,1] neg_hi:[0,0,1]
    v_pk_fma_f32 v[190:191], v[10:11], v[158:159], v[190:191] op_sel_hi:[0,1,1] neg_lo:[0,0,1] neg_hi:[0,0,1]
    v_cvt_pk_bf16_f32 v64, v160, v164
    v_cvt_pk_bf16_f32 v65, v168, v172
    v_cvt_pk_bf16_f32 v66, v176, v180
    v_cvt_pk_bf16_f32 v67, v184, v188
    v_cvt_pk_bf16_f32 v68, v161, v165
    v_cvt_pk_bf16_f32 v69, v169, v173
    v_cvt_pk_bf16_f32 v70, v177, v181
    v_cvt_pk_bf16_f32 v71, v185, v189
    v_cvt_pk_bf16_f32 v72, v162, v166
    v_cvt_pk_bf16_f32 v73, v170, v174
    v_cvt_pk_bf16_f32 v74, v178, v182
    v_cvt_pk_bf16_f32 v75, v186, v190
    v_cvt_pk_bf16_f32 v76, v163, v167
    v_cvt_pk_bf16_f32 v77, v171, v175
    v_cvt_pk_bf16_f32 v78, v179, v183
    v_cvt_pk_bf16_f32 v79, v187, v191
    s_cmp_lg_u32 s3, 3
    s_cbranch_scc1 L_h1_end
    s_mov_b64 exec, 0
    s_branch L_p1_done
L_h1_ret:
    s_mov_b64 exec, -1
L_h1_end:
    s_cmp_eq_u32 s41, 3
    s_cbranch_scc1 L_p1_c
    v_and_b32 v11, 31, v0
    v_lshrrev_b32_e64 v13, 5, v0
    v_bfe_u32 v12, v0, 1, 3
    v_lshlrev_b32 v14, 2, v13
    v_xor_b32 v12, v12, v14
    v_lshlrev_b32_e64 v12, 4, v12
    v_lshl_add_u32 v12, v11, 7, v12
    v_xor_b32 v14, 16, v12
    v_xor_b32 v15, 32, v12
    s_mov_b32 s50, 0x05040100
    s_mov_b32 s51, 0x07060302
    v_bfe_u32 v2, v3, 1, 1
    v_lshlrev_b32 v2, 31, v2
    v_or_b32 v2, 1.0, v2
    v_lshlrev_b32 v10, 31, v3
    v_or_b32 v10, 1.0, v10
    v_cmp_eq_u32 s[46:47], 1, v3
    v_cmp_eq_u32 s[48:49], 0, v3
    v_mov_b32 v5, 0x3f3504f3
    v_cndmask_b32 v4, 1.0, 0, s[46:47]
    v_cndmask_b32 v6, 1.0, -1.0, s[46:47]
    v_cndmask_b32 v8, v10, 1.0, s[46:47]
    v_cndmask_b32 v8, v8, v5, s[48:49]
    v_cndmask_b32 v10, v10, 0, s[48:49]
    s_lshl_b32 s54, s44, 15
    s_lshl_b32 s45, s3, 13
    s_add_u32 s54, s54, s45
    s_mul_i32 s57, s3, 448
    s_lshl_b32 s45, s44, 1
    s_add_u32 s57, s57, s45
    s_lshl_b32 s57, s57, 10
    s_add_u32 s57, s57, 0xc00000
    s_mov_b32 s56, 114688
    s_movk_i32 s55, 256
    s_mov_b32 s36, s28
    s_mov_b32 s37, s29
    s_mov_b32 s39, 0x00020000
    s_cmp_eq_u32 s41, 2
    s_cselect_b32 s38, 0, s30
    s_cmp_eq_u32 s41, 0
    s_cselect_b32 s54, s54, s57
    s_cselect_b32 s55, 1024, s55
    s_cselect_b32 s56, 2048, s56
    s_cselect_b64 vcc, -1, 0
    s_cselect_b32 s42, 1, s3
    s_mov_b32 s32, s28
    s_mov_b32 s33, s29
    s_cmp_eq_u32 s42, 0
    s_cselect_b32 s34, 0, s38
    v_and_b32 v11, 15, v0
    v_bfe_u32 v7, v0, 4, 1
    v_lshlrev_b32_e64 v9, 4, v11
    v_lshl_add_u32 v9, v13, 9, v9
    v_lshl_add_u32 v9, v7, 10, v9
    v_and_b32_e64 v5, 14, v11
    v_add_lshl_u32 v11, v11, v5, 5
    v_lshl_add_u32 v11, v13, 4, v11
    v_lshl_add_u32 v11, v7, 6, v11
    v_cndmask_b32 v11, v9, v11, vcc
    v_xor_b32 v13, 48, v12
    s_waitcnt vmcnt(7)
    s_barrier
    ds_read_b128 v[80:83], v12 offset:0
    ds_read_b128 v[84:87], v14 offset:0
    ds_read_b128 v[88:91], v15 offset:0
    ds_read_b128 v[92:95], v13 offset:0
    ds_read_b128 v[96:99], v12 offset:4096
    ds_read_b128 v[100:103], v14 offset:4096
    ds_read_b128 v[104:107], v15 offset:4096
    ds_read_b128 v[108:111], v13 offset:4096
    s_waitcnt lgkmcnt(4)
    s_nop 0
    v_perm_b32 v112, v82, v80, s50
    v_perm_b32 v113, v86, v84, s50
    v_perm_b32 v114, v90, v88, s50
    v_perm_b32 v115, v94, v92, s50
    v_perm_b32 v116, v82, v80, s51
    v_perm_b32 v117, v86, v84, s51
    v_perm_b32 v118, v90, v88, s51
    v_perm_b32 v119, v94, v92, s51
    v_mfma_f32_32x32x16_bf16 v[128:143], v[112:115], v[16:19], 0
    v_perm_b32 v120, v83, v81, s50
    v_perm_b32 v121, v87, v85, s50
    v_perm_b32 v122, v91, v89, s50
    v_perm_b32 v123, v95, v93, s50
    v_mfma_f32_32x32x16_bf16 v[144:159], v[116:119], v[20:23], 0
    v_perm_b32 v124, v83, v81, s51
    v_perm_b32 v125, v87, v85, s51
    v_perm_b32 v126, v91, v89, s51
    v_perm_b32 v127, v95, v93, s51
    s_waitcnt vmcnt(5)
    s_barrier
    ds_read_b128 v[80:83], v12 offset:8192
    ds_read_b128 v[84:87], v14 offset:8192
    ds_read_b128 v[88:91], v15 offset:8192
    ds_read_b128 v[92:95], v13 offset:8192
    v_mfma_f32_32x32x16_bf16 v[160:175], v[120:123], v[24:27], 0
    s_waitcnt lgkmcnt(4)
    s_nop 0
    v_perm_b32 v112, v98, v96, s50
    v_perm_b32 v113, v102, v100, s50
    v_perm_b32 v114, v106, v104, s50
    v_perm_b32 v115, v110, v108, s50
    v_mfma_f32_32x32x16_bf16 v[176:191], v[124:127], v[28:31], 0
    v_perm_b32 v116, v98, v96, s51
    v_perm_b32 v117, v102, v100, s51
    v_perm_b32 v118, v106, v104, s51
    v_perm_b32 v119, v110, v108, s51
    v_mfma_f32_32x32x16_bf16 v[192:207], v[112:115], v[16:19], 0
    v_perm_b32 v120, v99, v97, s50
    v_perm_b32 v121, v103, v101, s50
    v_perm_b32 v122, v107, v105, s50
    v_perm_b32 v123, v111, v109, s50
    v_mfma_f32_32x32x16_bf16 v[208:223], v[116:119], v[20:23], 0
    v_perm_b32 v124, v99, v97, s51
    v_perm_b32 v125, v103, v101, s51
    v_perm_b32 v126, v107, v105, s51
    v_perm_b32 v127, v111, v109, s51
    ds_read_b128 v[96:99], v12 offset:12288
    ds_read_b128 v[100:103], v14 offset:12288
    ds_read_b128 v[104:107], v15 offset:12288
    ds_read_b128 v[108:111], v13 offset:12288
    v_mfma_f32_32x32x16_bf16 v[224:239], v[120:123], v[24:27], 0
    s_waitcnt lgkmcnt(4)
    s_nop 0
    v_perm_b32 v112, v82, v80, s50
    v_perm_b32 v113, v86, v84, s50
    v_perm_b32 v114, v90, v88, s50
    v_perm_b32 v115, v94, v92, s50
    v_mfma_f32_32x32x16_bf16 v[240:255], v[124:127], v[28:31], 0
    v_perm_b32 v116, v82, v80, s51
    v_perm_b32 v117, v86, v84, s51
    v_perm_b32 v118, v90, v88, s51
    v_perm_b32 v119, v94, v92, s51
    v_mfma_f32_32x32x16_bf16 v[128:143], v[112:115], v[32:35], v[128:143]
    v_perm_b32 v120, v83, v81, s50
    v_perm_b32 v121, v87, v85, s50
    v_perm_b32 v122, v91, v89, s50
    v_perm_b32 v123, v95, v93, s50
    v_mfma_f32_32x32x16_bf16 v[144:159], v[116:119], v[36:39], v[144:159]
    v_perm_b32 v124, v83, v81, s51
    v_perm_b32 v125, v87, v85, s51
    v_perm_b32 v126, v91, v89, s51
    v_perm_b32 v127, v95, v93, s51
    s_waitcnt vmcnt(3)
    s_barrier
    ds_read_b128 v[80:83], v12 offset:16384
    ds_read_b128 v[84:87], v14 offset:16384
    ds_read_b128 v[88:91], v15 offset:16384
    ds_read_b128 v[92:95], v13 offset:16384
    v_mfma_f32_32x32x16_bf16 v[160:175], v[120:123], v[40:43], v[160:175]
    s_waitcnt lgkmcnt(4)
    s_nop 0
    v_perm_b32 v112, v98, v96, s50
    v_perm_b32 v113, v102, v100, s50
    v_perm_b32 v114, v106, v104, s50
    v_perm_b32 v115, v110, v108, s50
    v_mfma_f32_32x32x16_bf16 v[176:191], v[124:127], v[44:47], v[176:191]
    v_perm_b32 v116, v98, v96, s51
    v_perm_b32 v117, v102, v100, s51
    v_perm_b32 v118, v106, v104, s51
    v_perm_b32 v119, v110, v108, s51
    v_mfma_f32_32x32x16_bf16 v[192:207], v[112:115], v[32:35], v[192:207]
    v_perm_b32 v120, v99, v97, s50
    v_perm_b32 v121, v103, v101, s50
    v_perm_b32 v122, v107, v105, s50
    v_perm_b32 v123, v111, v109, s50
    v_mfma_f32_32x32x16_bf16 v[208:223], v[116:119], v[36:39], v[208:223]
    v_perm_b32 v124, v99, v97, s51
    v_perm_b32 v125, v103, v101, s51
    v_perm_b32 v126, v107, v105, s51
    v_perm_b32 v127, v111, v109, s51
    ds_read_b128 v[96:99], v12 offset:20480
    ds_read_b128 v[100:103], v14 offset:20480
    ds_read_b128 v[104:107], v15 offset:20480
    ds_read_b128 v[108:111], v13 offset:20480
    v_mfma_f32_32x32x16_bf16 v[224:239], v[120:123], v[40:43], v[224:239]
    s_waitcnt lgkmcnt(4)
    s_nop 0
    v_perm_b32 v112, v82, v80, s50
    v_perm_b32 v113, v86, v84, s50
    v_perm_b32 v114, v90, v88, s50
    v_perm_b32 v115, v94, v92, s50
    v_mfma_f32_32x32x16_bf16 v[240:255], v[124:127], v[44:47], v[240:255]
    v_perm_b32 v116, v82, v80, s51
    v_perm_b32 v117, v86, v84, s51
    v_perm_b32 v118, v90, v88, s51
    v_perm_b32 v119, v94, v92, s51
    v_mfma_f32_32x32x16_bf16 v[128:143], v[112:115], v[48:51], v[128:143]
    v_perm_b32 v120, v83, v81, s50
    v_perm_b32 v121, v87, v85, s50
    v_perm_b32 v122, v91, v89, s50
    v_perm_b32 v123, v95, v93, s50
    v_mfma_f32_32x32x16_bf16 v[144:159], v[116:119], v[52:55], v[144:159]
    v_perm_b32 v124, v83, v81, s51
    v_perm_b32 v125, v87, v85, s51
    v_perm_b32 v126, v91, v89, s51
    v_perm_b32 v127, v95, v93, s51
    s_waitcnt vmcnt(1)
    s_barrier
    ds_read_b128 v[80:83], v12 offset:24576
    ds_read_b128 v[84:87], v14 offset:24576
    ds_read_b128 v[88:91], v15 offset:24576
    ds_read_b128 v[92:95], v13 offset:24576
    v_mfma_f32_32x32x16_bf16 v[160:175], v[120:123], v[56:59], v[160:175]
    s_waitcnt lgkmcnt(4)
    s_nop 0
    v_perm_b32 v112, v98, v96, s50
    v_perm_b32 v113, v102, v100, s50
    v_perm_b32 v114, v106, v104, s50
    v_perm_b32 v115, v110, v108, s50
    v_mfma_f32_32x32x16_bf16 v[176:191], v[124:127], v[60:63], v[176:191]
    v_perm_b32 v116, v98, v96, s51
    v_perm_b32 v117, v102, v100, s51
    v_perm_b32 v118, v106, v104, s51
    v_perm_b32 v119, v110, v108, s51
    v_mfma_f32_32x32x16_bf16 v[192:207], v[112:115], v[48:51], v[192:207]
    v_perm_b32 v120, v99, v97, s50
    v_perm_b32 v121, v103, v101, s50
    v_perm_b32 v122, v107, v105, s50
    v_perm_b32 v123, v111, v109, s50
    v_mfma_f32_32x32x16_bf16 v[208:223], v[116:119], v[52:55], v[208:223]
    v_perm_b32 v124, v99, v97, s51
    v_perm_b32 v125, v103, v101, s51
    v_perm_b32 v126, v107, v105, s51
    v_perm_b32 v127, v111, v109, s51
    ds_read_b128 v[96:99], v12 offset:28672
    ds_read_b128 v[100:103], v14 offset:28672
    ds_read_b128 v[104:107], v15 offset:28672
    ds_read_b128 v[108:111], v13 offset:28672
    v_mfma_f32_32x32x16_bf16 v[224:239], v[120:123], v[56:59], v[224:239]
    s_waitcnt lgkmcnt(4)
    s_nop 0
    v_perm_b32 v112, v82, v80, s50
    v_perm_b32 v113, v86, v84, s50
    v_perm_b32 v114, v90, v88, s50
    v_perm_b32 v115, v94, v92, s50
    v_mfma_f32_32x32x16_bf16 v[240:255], v[124:127], v[60:63], v[240:255]
    v_perm_b32 v116, v82, v80, s51
    v_perm_b32 v117, v86, v84, s51
    v_perm_b32 v118, v90, v88, s51
    v_perm_b32 v119, v94, v92, s51
    v_mfma_f32_32x32x16_bf16 v[128:143], v[112:115], v[64:67], v[128:143]
    v_perm_b32 v120, v83, v81, s50
    v_perm_b32 v121, v87, v85, s50
    v_perm_b32 v122, v91, v89, s50
    v_perm_b32 v123, v95, v93, s50
    v_mfma_f32_32x32x16_bf16 v[144:159], v[116:119], v[68:71], v[144:159]
    v_perm_b32 v124, v83, v81, s51
    v_perm_b32 v125, v87, v85, s51
    v_perm_b32 v126, v91, v89, s51
    v_perm_b32 v127, v95, v93, s51
    v_mfma_f32_32x32x16_bf16 v[160:175], v[120:123], v[72:75], v[160:175]
    s_waitcnt lgkmcnt(0)
    s_nop 0
    v_perm_b32 v112, v98, v96, s50
    v_perm_b32 v113, v102, v100, s50
    v_perm_b32 v114, v106, v104, s50
    v_perm_b32 v115, v110, v108, s50
    v_mfma_f32_32x32x16_bf16 v[176:191], v[124:127], v[76:79], v[176:191]
    v_perm_b32 v116, v98, v96, s51
    v_perm_b32 v117, v102, v100, s51
    v_perm_b32 v118, v106, v104, s51
    v_perm_b32 v119, v110, v108, s51
    v_mfma_f32_32x32x16_bf16 v[192:207], v[112:115], v[64:67], v[192:207]
    v_perm_b32 v120, v99, v97, s50
    v_perm_b32 v121, v103, v101, s50
    v_perm_b32 v122, v107, v105, s50
    v_perm_b32 v123, v111, v109, s50
    v_mfma_f32_32x32x16_bf16 v[208:223], v[116:119], v[68:71], v[208:223]
    v_perm_b32 v124, v99, v97, s51
    v_perm_b32 v125, v103, v101, s51
    v_perm_b32 v126, v107, v105, s51
    v_perm_b32 v127, v111, v109, s51
    v_mfma_f32_32x32x16_bf16 v[224:239], v[120:123], v[72:75], v[224:239]
    s_nop 0
    s_nop 0
    v_mfma_f32_32x32x16_bf16 v[240:255], v[124:127], v[76:79], v[240:255]
    v_pk_fma_f32 v[128:129], v[2:3], v[192:193], v[128:129] op_sel_hi:[0,1,1]
    v_pk_fma_f32 v[130:131], v[2:3], v[194:195], v[130:131] op_sel_hi:[0,1,1]
    v_pk_fma_f32 v[132:133], v[2:3], v[196:197], v[132:133] op_sel_hi:[0,1,1]
    v_pk_fma_f32 v[134:135], v[2:3], v[198:199], v[134:135] op_sel_hi:[0,1,1]
    v_pk_fma_f32 v[136:137], v[2:3], v[200:201], v[136:137] op_sel_hi:[0,1,1]
    v_pk_fma_f32 v[138:139], v[2:3], v[202:203], v[138:139] op_sel_hi:[0,1,1]
    v_pk_fma_f32 v[140:141], v[2:3], v[204:205], v[140:141] op_sel_hi:[0,1,1]
    v_pk_fma_f32 v[142:143], v[2:3], v[206:207], v[142:143] op_sel_hi:[0,1,1]
    v_pk_fma_f32 v[144:145], v[2:3], v[208:209], v[144:145] op_sel_hi:[0,1,1]
    v_pk_fma_f32 v[146:147], v[2:3], v[210:211], v[146:147] op_sel_hi:[0,1,1]
    v_pk_fma_f32 v[148:149], v[2:3], v[212:213], v[148:149] op_sel_hi:[0,1,1]
    v_pk_fma_f32 v[150:151], v[2:3], v[214:215], v[150:151] op_sel_hi:[0,1,1]
    v_pk_fma_f32 v[152:153], v[2:3], v[216:217], v[152:153] op_sel_hi:[0,1,1]
    v_pk_fma_f32 v[154:155], v[2:3], v[218:219], v[154:155] op_sel_hi:[0,1,1]
    v_pk_fma_f32 v[156:157], v[2:3], v[220:221], v[156:157] op_sel_hi:[0,1,1]
    v_pk_fma_f32 v[158:159], v[2:3], v[222:223], v[158:159] op_sel_hi:[0,1,1]
    v_pk_fma_f32 v[160:161], v[2:3], v[224:225], v[160:161] op_sel_hi:[0,1,1]
    v_pk_fma_f32 v[162:163], v[2:3], v[226:227], v[162:163] op_sel_hi:[0,1,1]
    v_pk_fma_f32 v[164:165], v[2:3], v[228:229], v[164:165] op_sel_hi:[0,1,1]
    v_pk_fma_f32 v[166:167], v[2:3], v[230:231], v[166:167] op_sel_hi:[0,1,1]
    v_pk_fma_f32 v[168:169], v[2:3], v[232:233], v[168:169] op_sel_hi:[0,1,1]
    v_pk_fma_f32 v[170:171], v[2:3], v[234:235], v[170:171] op_sel_hi:[0,1,1]
    v_pk_fma_f32 v[172:173], v[2:3], v[236:237], v[172:173] op_sel_hi:[0,1,1]
    v_pk_fma_f32 v[174:175], v[2:3], v[238:239], v[174:175] op_sel_hi:[0,1,1]
    v_pk_fma_f32 v[176:177], v[2:3], v[240:241], v[176:177] op_sel_hi:[0,1,1]
    v_pk_fma_f32 v[178:179], v[2:3], v[242:243], v[178:179] op_sel_hi:[0,1,1]
    v_pk_fma_f32 v[180:181], v[2:3], v[244:245], v[180:181] op_sel_hi:[0,1,1]
    v_pk_fma_f32 v[182:183], v[2:3], v[246:247], v[182:183] op_sel_hi:[0,1,1]
    v_pk_fma_f32 v[184:185], v[2:3], v[248:249], v[184:185] op_sel_hi:[0,1,1]
    v_pk_fma_f32 v[186:187], v[2:3], v[250:251], v[186:187] op_sel_hi:[0,1,1]
    v_pk_fma_f32 v[188:189], v[2:3], v[252:253], v[188:189] op_sel_hi:[0,1,1]
    v_pk_fma_f32 v[190:191], v[2:3], v[254:255], v[190:191] op_sel_hi:[0,1,1]
    v_pk_fma_f32 v[192:193], v[4:5], v[160:161], v[128:129] op_sel_hi:[0,1,1]
    v_pk_fma_f32 v[224:225], v[6:7], v[176:177], v[144:145] op_sel_hi:[0,1,1]
    v_pk_fma_f32 v[194:195], v[4:5], v[162:163], v[130:131] op_sel_hi:[0,1,1]
    v_pk_fma_f32 v[226:227], v[6:7], v[178:179], v[146:147] op_sel_hi:[0,1,1]
    v_pk_fma_f32 v[196:197], v[4:5], v[164:165], v[132:133] op_sel_hi:[0,1,1]
    v_pk_fma_f32 v[228:229], v[6:7], v[180:181], v[148:149] op_sel_hi:[0,1,1]
    v_pk_fma_f32 v[198:199], v[4:5], v[166:167], v[134:135] op_sel_hi:[0,1,1]
    v_pk_fma_f32 v[230:231], v[6:7], v[182:183], v[150:151] op_sel_hi:[0,1,1]
    v_pk_fma_f32 v[200:201], v[4:5], v[168:169], v[136:137] op_sel_hi:[0,1,1]
    v_pk_fma_f32 v[232:233], v[6:7], v[184:185], v[152:153] op_sel_hi:[0,1,1]
    v_pk_fma_f32 v[202:203], v[4:5], v[170:171], v[138:139] op_sel_hi:[0,1,1]
    v_pk_fma_f32 v[234:235], v[6:7], v[186:187], v[154:155] op_sel_hi:[0,1,1]
    v_pk_fma_f32 v[204:205], v[4:5], v[172:173], v[140:141] op_sel_hi:[0,1,1]
    v_pk_fma_f32 v[236:237], v[6:7], v[188:189], v[156:157] op_sel_hi:[0,1,1]
    v_pk_fma_f32 v[206:207], v[4:5], v[174:175], v[142:143] op_sel_hi:[0,1,1]
    v_pk_fma_f32 v[238:239], v[6:7], v[190:191], v[158:159] op_sel_hi:[0,1,1]
    v_pk_add_f32 v[208:209], v[192:193], v[224:225]
    v_pk_add_f32 v[210:211], v[194:195], v[226:227]
    v_pk_add_f32 v[212:213], v[196:197], v[228:229]
    v_pk_add_f32 v[214:215], v[198:199], v[230:231]
    v_pk_add_f32 v[216:217], v[200:201], v[232:233]
    v_pk_add_f32 v[218:219], v[202:203], v[234:235]
    v_pk_add_f32 v[220:221], v[204:205], v[236:237]
    v_pk_add_f32 v[222:223], v[206:207], v[238:239]
    v_cvt_pk_bf16_f32 v80, v208, v209
    v_cvt_pk_bf16_f32 v81, v210, v211
    v_cvt_pk_bf16_f32 v82, v212, v213
    v_cvt_pk_bf16_f32 v83, v214, v215
    v_cvt_pk_bf16_f32 v84, v216, v217
    v_cvt_pk_bf16_f32 v85, v218, v219
    v_cvt_pk_bf16_f32 v86, v220, v221
    v_cvt_pk_bf16_f32 v87, v222, v223
    v_permlane16_swap_b32 v80, v84
    v_permlane16_swap_b32 v81, v85
    v_permlane16_swap_b32 v82, v86
    v_permlane16_swap_b32 v83, v87
    s_mul_i32 s57, s56, 0
    s_add_u32 s57, s57, s54
    buffer_store_dwordx4 v[80:83], v11, s[32:35], s57 offen sc1
    v_pk_add_f32 v[192:193], v[192:193], v[224:225] neg_lo:[0,1] neg_hi:[0,1]
    v_pk_add_f32 v[194:195], v[194:195], v[226:227] neg_lo:[0,1] neg_hi:[0,1]
    v_pk_add_f32 v[196:197], v[196:197], v[228:229] neg_lo:[0,1] neg_hi:[0,1]
    v_pk_add_f32 v[198:199], v[198:199], v[230:231] neg_lo:[0,1] neg_hi:[0,1]
    v_pk_add_f32 v[200:201], v[200:201], v[232:233] neg_lo:[0,1] neg_hi:[0,1]
    v_pk_add_f32 v[202:203], v[202:203], v[234:235] neg_lo:[0,1] neg_hi:[0,1]
    v_pk_add_f32 v[204:205], v[204:205], v[236:237] neg_lo:[0,1] neg_hi:[0,1]
    v_pk_add_f32 v[206:207], v[206:207], v[238:239] neg_lo:[0,1] neg_hi:[0,1]
    v_pk_mul_f32 v[192:193], v[8:9], v[192:193] op_sel_hi:[0,1]
    v_pk_mul_f32 v[194:195], v[8:9], v[194:195] op_sel_hi:[0,1]
    v_pk_mul_f32 v[196:197], v[8:9], v[196:197] op_sel_hi:[0,1]
    v_pk_mul_f32 v[198:199], v[8:9], v[198:199] op_sel_hi:[0,1]
    v_pk_mul_f32 v[200:201], v[8:9], v[200:201] op_sel_hi:[0,1]
    v_pk_mul_f32 v[202:203], v[8:9], v[202:203] op_sel_hi:[0,1]
    s_add_u32 s57, s57, s55
    s_nop 0
    buffer_store_dwordx4 v[84:87], v11, s[36:39], s57 offen sc1
    v_pk_mul_f32 v[204:205], v[8:9], v[204:205] op_sel_hi:[0,1]
    v_pk_mul_f32 v[206:207], v[8:9], v[206:207] op_sel_hi:[0,1]
    v_cvt_pk_bf16_f32 v96, v192, v193
    v_cvt_pk_bf16_f32 v97, v194, v195
    v_cvt_pk_bf16_f32 v98, v196, v197
    v_cvt_pk_bf16_f32 v99, v198, v199
    v_cvt_pk_bf16_f32 v100, v200, v201
    v_cvt_pk_bf16_f32 v101, v202, v203
    v_cvt_pk_bf16_f32 v102, v204, v205
    v_cvt_pk_bf16_f32 v103, v206, v207
    v_permlane16_swap_b32 v96, v100
    v_permlane16_swap_b32 v97, v101
    v_permlane16_swap_b32 v98, v102
    v_permlane16_swap_b32 v99, v103
    s_mul_i32 s57, s56, 2
    s_add_u32 s57, s57, s54
    buffer_store_dwordx4 v[96:99], v11, s[32:35], s57 offen sc1
    s_or_b64 vcc, s[46:47], s[48:49]
    s_nop 0
    v_pk_fma_f32 v[240:241], v[6:7], v[176:177], v[144:145] op_sel_hi:[0,1,1] neg_lo:[1,0,0] neg_hi:[1,0,0]
    v_pk_fma_f32 v[242:243], v[6:7], v[178:179], v[146:147] op_sel_hi:[0,1,1] neg_lo:[1,0,0] neg_hi:[1,0,0]
    v_pk_fma_f32 v[244:245], v[6:7], v[180:181], v[148:149] op_sel_hi:[0,1,1] neg_lo:[1,0,0] neg_hi:[1,0,0]
    v_pk_fma_f32 v[246:247], v[6:7], v[182:183], v[150:151] op_sel_hi:[0,1,1] neg_lo:[1,0,0] neg_hi:[1,0,0]
    v_pk_fma_f32 v[248:249], v[6:7], v[184:185], v[152:153] op_sel_hi:[0,1,1] neg_lo:[1,0,0] neg_hi:[1,0,0]
    v_pk_fma_f32 v[250:251], v[6:7], v[186:187], v[154:155] op_sel_hi:[0,1,1] neg_lo:[1,0,0] neg_hi:[1,0,0]
    v_pk_fma_f32 v[252:253], v[6:7], v[188:189], v[156:157] op_sel_hi:[0,1,1] neg_lo:[1,0,0] neg_hi:[1,0,0]
    v_pk_fma_f32 v[254:255], v[6:7], v[190:191], v[158:159] op_sel_hi:[0,1,1] neg_lo:[1,0,0] neg_hi:[1,0,0]
    v_pk_fma_f32 v[208:209], v[4:5], v[128:129], v[160:161] op_sel_hi:[0,1,1] neg_lo:[0,0,1] neg_hi:[0,0,1]
    v_pk_fma_f32 v[210:211], v[4:5], v[130:131], v[162:163] op_sel_hi:[0,1,1] neg_lo:[0,0,1] neg_hi:[0,0,1]
    v_pk_fma_f32 v[212:213], v[4:5], v[132:133], v[164:165] op_sel_hi:[0,1,1] neg_lo:[0,0,1] neg_hi:[0,0,1]
    v_pk_fma_f32 v[214:215], v[4:5], v[134:135], v[166:167] op_sel_hi:[0,1,1] neg_lo:[0,0,1] neg_hi:[0,0,1]
    v_pk_fma_f32 v[216:217], v[4:5], v[136:137], v[168:169] op_sel_hi:[0,1,1] neg_lo:[0,0,1] neg_hi:[0,0,1]
    v_pk_fma_f32 v[218:219], v[4:5], v[138:139], v[170:171] op_sel_hi:[0,1,1] neg_lo:[0,0,1] neg_hi:[0,0,1]
    v_pk_fma_f32 v[220:221], v[4:5], v[140:141], v[172:173] op_sel_hi:[0,1,1] neg_lo:[0,0,1] neg_hi:[0,0,1]
    v_pk_fma_f32 v[222:223], v[4:5], v[142:143], v[174:175] op_sel_hi:[0,1,1] neg_lo:[0,0,1] neg_hi:[0,0,1]
    v_cndmask_b32 v176, v240, v240, vcc quad_perm:[1,0,3,2] row_mask:0xf bank_mask:0xf
    v_cndmask_b32 v177, v241, v241, vcc quad_perm:[1,0,3,2] row_mask:0xf bank_mask:0xf
    v_cndmask_b32 v178, v242, v242, vcc quad_perm:[1,0,3,2] row_mask:0xf bank_mask:0xf
    v_cndmask_b32 v179, v243, v243, vcc quad_perm:[1,0,3,2] row_mask:0xf bank_mask:0xf
    v_cndmask_b32 v180, v244, v244, vcc quad_perm:[1,0,3,2] row_mask:0xf bank_mask:0xf
    v_cndmask_b32 v181, v245, v245, vcc quad_perm:[1,0,3,2] row_mask:0xf bank_mask:0xf
    v_cndmask_b32 v182, v246, v246, vcc quad_perm:[1,0,3,2] row_mask:0xf bank_mask:0xf
    v_cndmask_b32 v183, v247, v247, vcc quad_perm:[1,0,3,2] row_mask:0xf bank_mask:0xf
    v_cndmask_b32 v184, v248, v248, vcc quad_perm:[1,0,3,2] row_mask:0xf bank_mask:0xf
    s_add_u32 s57, s57, s55
    s_nop 0
    buffer_store_dwordx4 v[100:103], v11, s[36:39], s57 offen sc1
    v_cndmask_b32 v185, v249, v249, vcc quad_perm:[1,0,3,2] row_mask:0xf bank_mask:0xf
    v_cndmask_b32 v186, v250, v250, vcc quad_perm:[1,0,3,2] row_mask:0xf bank_mask:0xf
    v_cndmask_b32 v187, v251, v251, vcc quad_perm:[1,0,3,2] row_mask:0xf bank_mask:0xf
    v_cndmask_b32 v188, v252, v252, vcc quad_perm:[1,0,3,2] row_mask:0xf bank_mask:0xf
    v_cndmask_b32 v189, v253, v253, vcc quad_perm:[1,0,3,2] row_mask:0xf bank_mask:0xf
    v_cndmask_b32 v190, v254, v254, vcc quad_perm:[1,0,3,2] row_mask:0xf bank_mask:0xf
    v_cndmask_b32 v191, v255, v255, vcc quad_perm:[1,0,3,2] row_mask:0xf bank_mask:0xf
    v_pk_fma_f32 v[144:145], v[10:11], v[176:177], v[208:209] op_sel_hi:[0,1,1]
    v_pk_fma_f32 v[146:147], v[10:11], v[178:179], v[210:211] op_sel_hi:[0,1,1]
    v_pk_fma_f32 v[148:149], v[10:11], v[180:181], v[212:213] op_sel_hi:[0,1,1]
    v_pk_fma_f32 v[150:151], v[10:11], v[182:183], v[214:215] op_sel_hi:[0,1,1]
    v_pk_fma_f32 v[152:153], v[10:11], v[184:185], v[216:217] op_sel_hi:[0,1,1]
    v_pk_fma_f32 v[154:155], v[10:11], v[186:187], v[218:219] op_sel_hi:[0,1,1]
    v_pk_fma_f32 v[156:157], v[10:11], v[188:189], v[220:221] op_sel_hi:[0,1,1]
    v_pk_fma_f32 v[158:159], v[10:11], v[190:191], v[222:223] op_sel_hi:[0,1,1]
    v_cvt_pk_bf16_f32 v88, v144, v145
    v_cvt_pk_bf16_f32 v89, v146, v147
    v_cvt_pk_bf16_f32 v90, v148, v149
    v_cvt_pk_bf16_f32 v91, v150, v151
    v_cvt_pk_bf16_f32 v92, v152, v153
    v_cvt_pk_bf16_f32 v93, v154, v155
    v_cvt_pk_bf16_f32 v94, v156, v157
    v_cvt_pk_bf16_f32 v95, v158, v159
    v_permlane16_swap_b32 v88, v92
    v_permlane16_swap_b32 v89, v93
    v_permlane16_swap_b32 v90, v94
    v_permlane16_swap_b32 v91, v95
    s_mul_i32 s57, s56, 1
    s_add_u32 s57, s57, s54
    buffer_store_dwordx4 v[88:91], v11, s[32:35], s57 offen sc1
    v_pk_fma_f32 v[176:177], v[10:11], v[208:209], v[176:177] op_sel_hi:[0,1,1] neg_lo:[0,0,1] neg_hi:[0,0,1]
    v_pk_fma_f32 v[178:179], v[10:11], v[210:211], v[178:179] op_sel_hi:[0,1,1] neg_lo:[0,0,1] neg_hi:[0,0,1]
    v_pk_fma_f32 v[180:181], v[10:11], v[212:213], v[180:181] op_sel_hi:[0,1,1] neg_lo:[0,0,1] neg_hi:[0,0,1]
    v_pk_fma_f32 v[182:183], v[10:11], v[214:215], v[182:183] op_sel_hi:[0,1,1] neg_lo:[0,0,1] neg_hi:[0,0,1]
    v_pk_fma_f32 v[184:185], v[10:11], v[216:217], v[184:185] op_sel_hi:[0,1,1] neg_lo:[0,0,1] neg_hi:[0,0,1]
    v_pk_fma_f32 v[186:187], v[10:11], v[218:219], v[186:187] op_sel_hi:[0,1,1] neg_lo:[0,0,1] neg_hi:[0,0,1]
    v_pk_fma_f32 v[188:189], v[10:11], v[220:221], v[188:189] op_sel_hi:[0,1,1] neg_lo:[0,0,1] neg_hi:[0,0,1]
    v_pk_fma_f32 v[190:191], v[10:11], v[222:223], v[190:191] op_sel_hi:[0,1,1] neg_lo:[0,0,1] neg_hi:[0,0,1]
    v_cvt_pk_bf16_f32 v104, v176, v177
    v_cvt_pk_bf16_f32 v105, v178, v179
    s_add_u32 s57, s57, s55
    s_nop 0
    buffer_store_dwordx4 v[92:95], v11, s[36:39], s57 offen sc1
    v_cvt_pk_bf16_f32 v106, v180, v181
    v_cvt_pk_bf16_f32 v107, v182, v183
    v_cvt_pk_bf16_f32 v108, v184, v185
    v_cvt_pk_bf16_f32 v109, v186, v187
    v_cvt_pk_bf16_f32 v110, v188, v189
    v_cvt_pk_bf16_f32 v111, v190, v191
    v_permlane16_swap_b32 v104, v108
    v_permlane16_swap_b32 v105, v109
    v_permlane16_swap_b32 v106, v110
    v_permlane16_swap_b32 v107, v111
    s_mul_i32 s57, s56, 3
    s_add_u32 s57, s57, s54
    buffer_store_dwordx4 v[104:107], v11, s[32:35], s57 offen sc1
    s_add_u32 s57, s57, s55
    buffer_store_dwordx4 v[108:111], v11, s[36:39], s57 offen sc1
    s_cmp_lg_u32 s42, 0
    s_cbranch_scc1 L_p1_nosp
    s_mov_b32 s48, 0x00010001
    s_mov_b32 s49, s48
    s_lshl_b64 s[46:47], s[48:49], 1
    s_not_b64 vcc, s[46:47]
    v_cndmask_b32 v112, v104, v88, vcc quad_perm:[1,0,3,2] row_mask:0xf bank_mask:0xf
    v_cndmask_b32 v116, v80, v80, vcc quad_perm:[1,0,3,2] row_mask:0xf bank_mask:0xf
    v_cndmask_b32 v113, v105, v89, vcc quad_perm:[1,0,3,2] row_mask:0xf bank_mask:0xf
    v_cndmask_b32 v117, v81, v81, vcc quad_perm:[1,0,3,2] row_mask:0xf bank_mask:0xf
    v_cndmask_b32 v114, v106, v90, vcc quad_perm:[1,0,3,2] row_mask:0xf bank_mask:0xf
    v_cndmask_b32 v118, v82, v82, vcc quad_perm:[1,0,3,2] row_mask:0xf bank_mask:0xf
    v_cndmask_b32 v115, v107, v91, vcc quad_perm:[1,0,3,2] row_mask:0xf bank_mask:0xf
    v_cndmask_b32 v119, v83, v83, vcc quad_perm:[1,0,3,2] row_mask:0xf bank_mask:0xf
    s_not_b64 vcc, s[48:49]
    s_nop 0
    v_cndmask_b32 v120, v80, v96, vcc quad_perm:[1,0,3,2] row_mask:0xf bank_mask:0xf
    v_cndmask_b32 v104, v96, v104, vcc quad_perm:[1,0,3,2] row_mask:0xf bank_mask:0xf
    v_cndmask_b32 v121, v81, v97, vcc quad_perm:[1,0,3,2] row_mask:0xf bank_mask:0xf
    v_cndmask_b32 v105, v97, v105, vcc quad_perm:[1,0,3,2] row_mask:0xf bank_mask:0xf
    v_cndmask_b32 v122, v82, v98, vcc quad_perm:[1,0,3,2] row_mask:0xf bank_mask:0xf
    v_cndmask_b32 v106, v98, v106, vcc quad_perm:[1,0,3,2] row_mask:0xf bank_mask:0xf
    v_cndmask_b32 v123, v83, v99, vcc quad_perm:[1,0,3,2] row_mask:0xf bank_mask:0xf
    v_cndmask_b32 v107, v99, v107, vcc quad_perm:[1,0,3,2] row_mask:0xf bank_mask:0xf
    v_cndmask_b32 v80, v116, v96, s[48:49]
    v_cndmask_b32 v96, v120, v88, s[46:47]
    v_mov_b32_e64 v88, v112
    v_cndmask_b32 v81, v117, v97, s[48:49]
    v_cndmask_b32 v97, v121, v89, s[46:47]
    v_mov_b32_e64 v89, v113
    v_cndmask_b32 v82, v118, v98, s[48:49]
    v_cndmask_b32 v98, v122, v90, s[46:47]
    v_mov_b32_e64 v90, v114
    v_cndmask_b32 v83, v119, v99, s[48:49]
    v_cndmask_b32 v99, v123, v91, s[46:47]
    v_mov_b32 v91, v115
    buffer_store_dwordx4 v[80:83], v11, s[36:39], s54 offen sc1
    s_add_u32 s54, s54, s56
    buffer_store_dwordx4 v[88:91], v11, s[36:39], s54 offen sc1
    s_add_u32 s54, s54, s56
    buffer_store_dwordx4 v[96:99], v11, s[36:39], s54 offen sc1
    s_add_u32 s54, s54, s56
    buffer_store_dwordx4 v[104:107], v11, s[36:39], s54 offen sc1
    s_add_u32 s54, s54, s56
L_p1_nosp:
    s_cmp_lg_u32 s41, 2
    s_cbranch_scc1 L_p1_done
    s_lshl_b32 s54, s3, 9
    s_add_u32 s54, s54, 0x1080000
    v_lshlrev_b32 v5, 2, v0
    v_lshlrev_b32 v112, 16, v80
    v_lshlrev_b32 v113, 16, v84
    v_lshlrev_b32 v114, 16, v88
    v_lshlrev_b32 v115, 16, v92
    v_lshlrev_b32 v116, 16, v96
    v_lshlrev_b32 v117, 16, v100
    v_lshlrev_b32 v118, 16, v104
    v_lshlrev_b32_e64 v119, 16, v108
    s_mov_b64 exec, 0xffff
    buffer_store_dword v112, v5, s[28:31], s54 offen offset:0 sc1
    buffer_store_dword v113, v5, s[28:31], s54 offen offset:64 sc1
    buffer_store_dword v114, v5, s[28:31], s54 offen offset:128 sc1
    buffer_store_dword v115, v5, s[28:31], s54 offen offset:192 sc1
    buffer_store_dword v116, v5, s[28:31], s54 offen offset:256 sc1
    buffer_store_dword v117, v5, s[28:31], s54 offen offset:320 sc1
    buffer_store_dword v118, v5, s[28:31], s54 offen offset:384 sc1
    buffer_store_dword v119, v5, s[28:31], s54 offen offset:448 sc1
    s_mov_b64 exec, -1
    s_branch L_p1_f
L_p1_c:
    v_lshrrev_b32 v5, 5, v0
    v_lshlrev_b32 v6, 11, v5
    v_bfe_u32 v7, v0, 2, 2
    v_lshl_add_u32 v6, v7, 6, v6
    v_bfe_u32 v7, v0, 4, 1
    v_lshl_add_u32 v6, v7, 5, v6
    v_and_b32 v7, 3, v0
    v_lshl_add_u32 v6, v7, 3, v6
    s_lshl_b32 s54, s44, 2
    s_add_u32 s54, s54, s3
    s_lshl_b32 s54, s54, 13
    s_add_u32 s54, s54, 0xa00000
    s_add_u32 s55, s54, 4096
    s_waitcnt vmcnt(6)
    s_barrier
    ds_read_b64_tr_b16 v[80:81], v6 offset:0
    ds_read_b64_tr_b16 v[82:83], v6 offset:1024
    ds_read_b64_tr_b16 v[84:85], v6 offset:256
    ds_read_b64_tr_b16 v[86:87], v6 offset:1280
    ds_read_b64_tr_b16 v[88:89], v6 offset:512
    ds_read_b64_tr_b16 v[90:91], v6 offset:1536
    ds_read_b64_tr_b16 v[92:93], v6 offset:768
    ds_read_b64_tr_b16 v[94:95], v6 offset:1792
    ds_read_b64_tr_b16 v[96:97], v6 offset:16384
    ds_read_b64_tr_b16 v[98:99], v6 offset:17408
    ds_read_b64_tr_b16 v[100:101], v6 offset:16640
    ds_read_b64_tr_b16 v[102:103], v6 offset:17664
    s_waitcnt lgkmcnt(8)
    s_nop 0
    v_mfma_f32_32x32x16_bf16 v[128:143], v[16:19], v[80:83], 0
    ds_read_b64_tr_b16 v[80:81], v6 offset:16896
    ds_read_b64_tr_b16 v[82:83], v6 offset:17920
    v_mfma_f32_32x32x16_bf16 v[144:159], v[20:23], v[84:87], 0
    ds_read_b64_tr_b16 v[84:85], v6 offset:17152
    ds_read_b64_tr_b16 v[86:87], v6 offset:18176
    s_waitcnt lgkmcnt(8)
    v_mfma_f32_32x32x16_bf16 v[160:175], v[24:27], v[88:91], 0
    s_waitcnt vmcnt(4)
    s_barrier
    ds_read_b64_tr_b16 v[88:89], v6 offset:4096
    ds_read_b64_tr_b16 v[90:91], v6 offset:5120
    v_mfma_f32_32x32x16_bf16 v[176:191], v[28:31], v[92:95], 0
    ds_read_b64_tr_b16 v[92:93], v6 offset:4352
    ds_read_b64_tr_b16 v[94:95], v6 offset:5376
    s_waitcnt lgkmcnt(8)
    v_mfma_f32_32x32x16_bf16 v[192:207], v[16:19], v[96:99], 0
    ds_read_b64_tr_b16 v[96:97], v6 offset:4608
    ds_read_b64_tr_b16 v[98:99], v6 offset:5632
    v_mfma_f32_32x32x16_bf16 v[208:223], v[20:23], v[100:103], 0
    ds_read_b64_tr_b16 v[100:101], v6 offset:4864
    ds_read_b64_tr_b16 v[102:103], v6 offset:5888
    s_waitcnt lgkmcnt(8)
    v_mfma_f32_32x32x16_bf16 v[224:239], v[24:27], v[80:83], 0
    ds_read_b64_tr_b16 v[80:81], v6 offset:20480
    ds_read_b64_tr_b16 v[82:83], v6 offset:21504
    v_mfma_f32_32x32x16_bf16 v[240:255], v[28:31], v[84:87], 0
    ds_read_b64_tr_b16 v[84:85], v6 offset:20736
    ds_read_b64_tr_b16 v[86:87], v6 offset:21760
    s_waitcnt lgkmcnt(8)
    v_mfma_f32_32x32x16_bf16 v[128:143], v[32:35], v[88:91], v[128:143]
    ds_read_b64_tr_b16 v[88:89], v6 offset:20992
    ds_read_b64_tr_b16 v[90:91], v6 offset:22016
    v_mfma_f32_32x32x16_bf16 v[144:159], v[36:39], v[92:95], v[144:159]
    ds_read_b64_tr_b16 v[92:93], v6 offset:21248
    ds_read_b64_tr_b16 v[94:95], v6 offset:22272
    s_waitcnt lgkmcnt(8)
    v_mfma_f32_32x32x16_bf16 v[160:175], v[40:43], v[96:99], v[160:175]
    s_waitcnt vmcnt(2)
    s_barrier
    ds_read_b64_tr_b16 v[96:97], v6 offset:8192
    ds_read_b64_tr_b16 v[98:99], v6 offset:9216
    v_mfma_f32_32x32x16_bf16 v[176:191], v[44:47], v[100:103], v[176:191]
    ds_read_b64_tr_b16 v[100:101], v6 offset:8448
    ds_read_b64_tr_b16 v[102:103], v6 offset:9472
    s_waitcnt lgkmcnt(8)
    v_mfma_f32_32x32x16_bf16 v[192:207], v[32:35], v[80:83], v[192:207]
    ds_read_b64_tr_b16 v[80:81], v6 offset:8704
    ds_read_b64_tr_b16 v[82:83], v6 offset:9728
    v_mfma_f32_32x32x16_bf16 v[208:223], v[36:39], v[84:87], v[208:223]
    ds_read_b64_tr_b16 v[84:85], v6 offset:8960
    ds_read_b64_tr_b16 v[86:87], v6 offset:9984
    s_waitcnt lgkmcnt(8)
    v_mfma_f32_32x32x16_bf16 v[224:239], v[40:43], v[88:91], v[224:239]
    ds_read_b64_tr_b16 v[88:89], v6 offset:24576
    ds_read_b64_tr_b16 v[90:91], v6 offset:25600
    v_mfma_f32_32x32x16_bf16 v[240:255], v[44:47], v[92:95], v[240:255]
    ds_read_b64_tr_b16 v[92:93], v6 offset:24832
    ds_read_b64_tr_b16 v[94:95], v6 offset:25856
    s_waitcnt lgkmcnt(8)
    v_mfma_f32_32x32x16_bf16 v[128:143], v[48:51], v[96:99], v[128:143]
    ds_read_b64_tr_b16 v[96:97], v6 offset:25088
    ds_read_b64_tr_b16 v[98:99], v6 offset:26112
    v_mfma_f32_32x32x16_bf16 v[144:159], v[52:55], v[100:103], v[144:159]
    ds_read_b64_tr_b16 v[100:101], v6 offset:25344
    ds_read_b64_tr_b16 v[102:103], v6 offset:26368
    s_waitcnt lgkmcnt(8)
    v_mfma_f32_32x32x16_bf16 v[160:175], v[56:59], v[80:83], v[160:175]
    s_waitcnt vmcnt(0)
    s_barrier
    ds_read_b64_tr_b16 v[80:81], v6 offset:12288
    ds_read_b64_tr_b16 v[82:83], v6 offset:13312
    v_mfma_f32_32x32x16_bf16 v[176:191], v[60:63], v[84:87], v[176:191]
    ds_read_b64_tr_b16 v[84:85], v6 offset:12544
    ds_read_b64_tr_b16 v[86:87], v6 offset:13568
    s_waitcnt lgkmcnt(8)
    v_mfma_f32_32x32x16_bf16 v[192:207], v[48:51], v[88:91], v[192:207]
    ds_read_b64_tr_b16 v[88:89], v6 offset:12800
    ds_read_b64_tr_b16 v[90:91], v6 offset:13824
    v_mfma_f32_32x32x16_bf16 v[208:223], v[52:55], v[92:95], v[208:223]
    ds_read_b64_tr_b16 v[92:93], v6 offset:13056
    ds_read_b64_tr_b16 v[94:95], v6 offset:14080
    s_waitcnt lgkmcnt(8)
    v_mfma_f32_32x32x16_bf16 v[224:239], v[56:59], v[96:99], v[224:239]
    ds_read_b64_tr_b16 v[96:97], v6 offset:28672
    ds_read_b64_tr_b16 v[98:99], v6 offset:29696
    v_mfma_f32_32x32x16_bf16 v[240:255], v[60:63], v[100:103], v[240:255]
    ds_read_b64_tr_b16 v[100:101], v6 offset:28928
    ds_read_b64_tr_b16 v[102:103], v6 offset:29952
    s_waitcnt lgkmcnt(8)
    v_mfma_f32_32x32x16_bf16 v[128:143], v[64:67], v[80:83], v[128:143]
    ds_read_b64_tr_b16 v[80:81], v6 offset:29184
    ds_read_b64_tr_b16 v[82:83], v6 offset:30208
    v_mfma_f32_32x32x16_bf16 v[144:159], v[68:71], v[84:87], v[144:159]
    ds_read_b64_tr_b16 v[84:85], v6 offset:29440
    ds_read_b64_tr_b16 v[86:87], v6 offset:30464
    s_waitcnt lgkmcnt(8)
    v_mfma_f32_32x32x16_bf16 v[160:175], v[72:75], v[88:91], v[160:175]
    v_mfma_f32_32x32x16_bf16 v[176:191], v[76:79], v[92:95], v[176:191]
    s_waitcnt lgkmcnt(4)
    v_mfma_f32_32x32x16_bf16 v[192:207], v[64:67], v[96:99], v[192:207]
    v_mfma_f32_32x32x16_bf16 v[208:223], v[68:71], v[100:103], v[208:223]
    s_waitcnt lgkmcnt(0)
    v_mfma_f32_32x32x16_bf16 v[224:239], v[72:75], v[80:83], v[224:239]
    v_mfma_f32_32x32x16_bf16 v[240:255], v[76:79], v[84:87], v[240:255]
    s_nop 7
    v_pk_add_f32 v[128:129], v[128:129], v[192:193]
    v_pk_add_f32 v[130:131], v[130:131], v[194:195] neg_lo:[0,1] neg_hi:[0,1]
    v_pk_add_f32 v[132:133], v[132:133], v[196:197]
    v_pk_add_f32 v[134:135], v[134:135], v[198:199] neg_lo:[0,1] neg_hi:[0,1]
    v_pk_add_f32 v[144:145], v[144:145], v[208:209]
    v_pk_add_f32 v[146:147], v[146:147], v[210:211] neg_lo:[0,1] neg_hi:[0,1]
    v_pk_add_f32 v[148:149], v[148:149], v[212:213]
    v_pk_add_f32 v[150:151], v[150:151], v[214:215] neg_lo:[0,1] neg_hi:[0,1]
    v_pk_add_f32 v[160:161], v[160:161], v[224:225]
    v_pk_add_f32 v[162:163], v[162:163], v[226:227] neg_lo:[0,1] neg_hi:[0,1]
    v_pk_add_f32 v[164:165], v[164:165], v[228:229]
    v_pk_add_f32 v[166:167], v[166:167], v[230:231] neg_lo:[0,1] neg_hi:[0,1]
    v_pk_add_f32 v[176:177], v[176:177], v[240:241]
    v_pk_add_f32 v[178:179], v[178:179], v[242:243] neg_lo:[0,1] neg_hi:[0,1]
    v_pk_add_f32 v[180:181], v[180:181], v[244:245]
    v_pk_add_f32 v[182:183], v[182:183], v[246:247] neg_lo:[0,1] neg_hi:[0,1]
    v_pk_add_f32 v[192:193], v[128:129], v[160:161]
    v_pk_add_f32 v[208:209], v[128:129], v[160:161] neg_lo:[0,1] neg_hi:[0,1]
    v_pk_add_f32 v[224:225], v[144:145], v[176:177]
    v_pk_add_f32 v[240:241], v[144:145], v[176:177] neg_lo:[0,1] neg_hi:[0,1]
    v_pk_add_f32 v[194:195], v[130:131], v[162:163]
    v_pk_add_f32 v[210:211], v[130:131], v[162:163] neg_lo:[0,1] neg_hi:[0,1]
    v_pk_add_f32 v[226:227], v[146:147], v[178:179]
    v_pk_add_f32 v[242:243], v[146:147], v[178:179] neg_lo:[0,1] neg_hi:[0,1]
    v_pk_add_f32 v[196:197], v[132:133], v[164:165]
    v_pk_add_f32 v[212:213], v[132:133], v[164:165] neg_lo:[0,1] neg_hi:[0,1]
    v_pk_add_f32 v[228:229], v[148:149], v[180:181]
    v_pk_add_f32 v[244:245], v[148:149], v[180:181] neg_lo:[0,1] neg_hi:[0,1]
    v_pk_add_f32 v[198:199], v[134:135], v[166:167]
    v_pk_add_f32 v[214:215], v[134:135], v[166:167] neg_lo:[0,1] neg_hi:[0,1]
    v_pk_add_f32 v[230:231], v[150:151], v[182:183]
    v_pk_add_f32 v[246:247], v[150:151], v[182:183] neg_lo:[0,1] neg_hi:[0,1]
    v_mov_b32 v8, v129
    v_mov_b32 v9, v161
    v_pk_add_f32 v[128:129], v[192:193], v[224:225]
    v_pk_add_f32 v[160:161], v[192:193], v[224:225] neg_lo:[0,1] neg_hi:[1,0]
    v_pk_add_f32 v[144:145], v[208:209], v[240:241] op_sel:[0,1] op_sel_hi:[1,0] neg_hi:[0,1]
    v_pk_add_f32 v[176:177], v[208:209], v[240:241] op_sel:[0,1] op_sel_hi:[1,0] neg_lo:[0,1] neg_hi:[1,1]
    v_pk_add_f32 v[130:131], v[194:195], v[226:227]
    v_pk_add_f32 v[162:163], v[194:195], v[226:227] neg_lo:[0,1] neg_hi:[1,0]
    v_pk_add_f32 v[146:147], v[210:211], v[242:243] op_sel:[0,1] op_sel_hi:[1,0] neg_hi:[0,1]
    v_pk_add_f32 v[178:179], v[210:211], v[242:243] op_sel:[0,1] op_sel_hi:[1,0] neg_lo:[0,1] neg_hi:[1,1]
    v_pk_add_f32 v[132:133], v[196:197], v[228:229]
    v_pk_add_f32 v[164:165], v[196:197], v[228:229] neg_lo:[0,1] neg_hi:[1,0]
    v_pk_add_f32 v[148:149], v[212:213], v[244:245] op_sel:[0,1] op_sel_hi:[1,0] neg_hi:[0,1]
    v_pk_add_f32 v[180:181], v[212:213], v[244:245] op_sel:[0,1] op_sel_hi:[1,0] neg_lo:[0,1] neg_hi:[1,1]
    v_pk_add_f32 v[134:135], v[198:199], v[230:231]
    v_pk_add_f32 v[166:167], v[198:199], v[230:231] neg_lo:[0,1] neg_hi:[1,0]
    v_pk_add_f32 v[150:151], v[214:215], v[246:247] op_sel:[0,1] op_sel_hi:[1,0] neg_hi:[0,1]
    v_pk_add_f32 v[182:183], v[214:215], v[246:247] op_sel:[0,1] op_sel_hi:[1,0] neg_lo:[0,1] neg_hi:[1,1]
    s_cmp_lg_u32 s3, 0
    s_cbranch_scc1 L_p1_cn
    s_mov_b32 exec_hi, 0
    v_mul_f32 v128, 0x3f3504f3, v160
    v_mov_b32 v129, 0
    v_mov_b32 v144, v208
    v_sub_f32 v145, 0, v240
    v_add_f32_e64 v160, v8, v241
    v_sub_f32 v161, -v9, v225
    v_sub_f32_e64 v176, v8, v241
    v_sub_f32 v177, v9, v225
    s_mov_b64 exec, -1
L_p1_cn:
    v_cvt_pk_bf16_f32 v80, v128, v129
    v_cvt_pk_bf16_f32 v81, v130, v131
    v_cvt_pk_bf16_f32 v82, v132, v133
    v_cvt_pk_bf16_f32 v83, v134, v135
    buffer_store_dwordx4 v[80:83], v1, s[28:31], s54 offen offset:0 sc1
    v_cvt_pk_bf16_f32 v88, v144, v145
    v_cvt_pk_bf16_f32 v89, v146, v147
    v_cvt_pk_bf16_f32 v90, v148, v149
    v_cvt_pk_bf16_f32 v91, v150, v151
    buffer_store_dwordx4 v[88:91], v1, s[28:31], s54 offen offset:2048 sc1
    v_cvt_pk_bf16_f32 v96, v160, v161
    v_cvt_pk_bf16_f32 v97, v162, v163
    v_cvt_pk_bf16_f32 v98, v164, v165
    v_cvt_pk_bf16_f32 v99, v166, v167
    buffer_store_dwordx4 v[96:99], v1, s[28:31], s55 offen offset:0 sc1
    v_cvt_pk_bf16_f32 v104, v176, v177
    v_cvt_pk_bf16_f32 v105, v178, v179
    v_cvt_pk_bf16_f32 v106, v180, v181
    v_cvt_pk_bf16_f32 v107, v182, v183
    buffer_store_dwordx4 v[104:107], v1, s[28:31], s55 offen offset:2048 sc1
    v_pk_add_f32 v[136:137], v[136:137], v[200:201]
    v_pk_add_f32 v[138:139], v[138:139], v[202:203] neg_lo:[0,1] neg_hi:[0,1]
    v_pk_add_f32 v[140:141], v[140:141], v[204:205]
    v_pk_add_f32 v[142:143], v[142:143], v[206:207] neg_lo:[0,1] neg_hi:[0,1]
    v_pk_add_f32 v[152:153], v[152:153], v[216:217]
    v_pk_add_f32 v[154:155], v[154:155], v[218:219] neg_lo:[0,1] neg_hi:[0,1]
    v_pk_add_f32 v[156:157], v[156:157], v[220:221]
    v_pk_add_f32 v[158:159], v[158:159], v[222:223] neg_lo:[0,1] neg_hi:[0,1]
    v_pk_add_f32 v[168:169], v[168:169], v[232:233]
    v_pk_add_f32 v[170:171], v[170:171], v[234:235] neg_lo:[0,1] neg_hi:[0,1]
    v_pk_add_f32 v[172:173], v[172:173], v[236:237]
    v_pk_add_f32 v[174:175], v[174:175], v[238:239] neg_lo:[0,1] neg_hi:[0,1]
    v_pk_add_f32 v[184:185], v[184:185], v[248:249]
    v_pk_add_f32 v[186:187], v[186:187], v[250:251] neg_lo:[0,1] neg_hi:[0,1]
    v_pk_add_f32 v[188:189], v[188:189], v[252:253]
    v_pk_add_f32 v[190:191], v[190:191], v[254:255] neg_lo:[0,1] neg_hi:[0,1]
    v_pk_add_f32 v[200:201], v[136:137], v[168:169]
    v_pk_add_f32 v[216:217], v[136:137], v[168:169] neg_lo:[0,1] neg_hi:[0,1]
    v_pk_add_f32 v[232:233], v[152:153], v[184:185]
    v_pk_add_f32 v[248:249], v[152:153], v[184:185] neg_lo:[0,1] neg_hi:[0,1]
    v_pk_add_f32 v[202:203], v[138:139], v[170:171]
    v_pk_add_f32 v[218:219], v[138:139], v[170:171] neg_lo:[0,1] neg_hi:[0,1]
    v_pk_add_f32 v[234:235], v[154:155], v[186:187]
    v_pk_add_f32 v[250:251], v[154:155], v[186:187] neg_lo:[0,1] neg_hi:[0,1]
    v_pk_add_f32 v[204:205], v[140:141], v[172:173]
    v_pk_add_f32 v[220:221], v[140:141], v[172:173] neg_lo:[0,1] neg_hi:[0,1]
    v_pk_add_f32 v[236:237], v[156:157], v[188:189]
    v_pk_add_f32 v[252:253], v[156:157], v[188:189] neg_lo:[0,1] neg_hi:[0,1]
    v_pk_add_f32 v[206:207], v[142:143], v[174:175]
    v_pk_add_f32 v[222:223], v[142:143], v[174:175] neg_lo:[0,1] neg_hi:[0,1]
    v_pk_add_f32 v[238:239], v[158:159], v[190:191]
    v_pk_add_f32 v[254:255], v[158:159], v[190:191] neg_lo:[0,1] neg_hi:[0,1]
    v_pk_add_f32 v[136:137], v[200:201], v[232:233]
    v_pk_add_f32 v[168:169], v[200:201], v[232:233] neg_lo:[0,1] neg_hi:[1,0]
    v_pk_add_f32 v[152:153], v[216:217], v[248:249] op_sel:[0,1] op_sel_hi:[1,0] neg_hi:[0,1]
    v_pk_add_f32 v[184:185], v[216:217], v[248:249] op_sel:[0,1] op_sel_hi:[1,0] neg_lo:[0,1] neg_hi:[1,1]
    v_pk_add_f32 v[138:139], v[202:203], v[234:235]
    v_pk_add_f32 v[170:171], v[202:203], v[234:235] neg_lo:[0,1] neg_hi:[1,0]
    v_pk_add_f32 v[154:155], v[218:219], v[250:251] op_sel:[0,1] op_sel_hi:[1,0] neg_hi:[0,1]
    v_pk_add_f32 v[186:187], v[218:219], v[250:251] op_sel:[0,1] op_sel_hi:[1,0] neg_lo:[0,1] neg_hi:[1,1]
    v_pk_add_f32 v[140:141], v[204:205], v[236:237]
    v_pk_add_f32 v[172:173], v[204:205], v[236:237] neg_lo:[0,1] neg_hi:[1,0]
    v_pk_add_f32 v[156:157], v[220:221], v[252:253] op_sel:[0,1] op_sel_hi:[1,0] neg_hi:[0,1]
    v_pk_add_f32 v[188:189], v[220:221], v[252:253] op_sel:[0,1] op_sel_hi:[1,0] neg_lo:[0,1] neg_hi:[1,1]
    v_pk_add_f32 v[142:143], v[206:207], v[238:239]
    v_pk_add_f32 v[174:175], v[206:207], v[238:239] neg_lo:[0,1] neg_hi:[1,0]
    v_pk_add_f32 v[158:159], v[222:223], v[254:255] op_sel:[0,1] op_sel_hi:[1,0] neg_hi:[0,1]
    v_pk_add_f32 v[190:191], v[222:223], v[254:255] op_sel:[0,1] op_sel_hi:[1,0] neg_lo:[0,1] neg_hi:[1,1]
    v_cvt_pk_bf16_f32 v84, v136, v137
    v_cvt_pk_bf16_f32 v85, v138, v139
    v_cvt_pk_bf16_f32 v86, v140, v141
    v_cvt_pk_bf16_f32 v87, v142, v143
    buffer_store_dwordx4 v[84:87], v1, s[28:31], s54 offen offset:1024 sc1
    v_cvt_pk_bf16_f32 v92, v152, v153
    v_cvt_pk_bf16_f32 v93, v154, v155
    v_cvt_pk_bf16_f32 v94, v156, v157
    v_cvt_pk_bf16_f32 v95, v158, v159
    buffer_store_dwordx4 v[92:95], v1, s[28:31], s54 offen offset:3072 sc1
    v_cvt_pk_bf16_f32 v100, v168, v169
    v_cvt_pk_bf16_f32 v101, v170, v171
    v_cvt_pk_bf16_f32 v102, v172, v173
    v_cvt_pk_bf16_f32 v103, v174, v175
    buffer_store_dwordx4 v[100:103], v1, s[28:31], s55 offen offset:1024 sc1
    v_cvt_pk_bf16_f32 v108, v184, v185
    v_cvt_pk_bf16_f32 v109, v186, v187
    v_cvt_pk_bf16_f32 v110, v188, v189
    v_cvt_pk_bf16_f32 v111, v190, v191
    buffer_store_dwordx4 v[108:111], v1, s[28:31], s55 offen offset:3072 sc1
    s_branch L_p1_done
L_p1_b:
    s_cmp_ge_u32 s27, 30
    s_cbranch_scc1 L_p1_misc
    s_lshl_b32 s44, s26, 3
    s_add_u32 s44, s44, s27
    s_sub_u32 s44, s44, 22
    s_lshr_b32 s48, s44, 2
    s_lshl_b32 s48, s48, 7
    s_and_b32 s45, s44, 3
    s_lshl_b32 s45, s45, 2
    s_add_u32 s48, s48, s45
    s_add_u32 s48, s48, s3
    s_lshl_b32 s48, s48, 10
    s_and_b32 s51, s44, 7
    s_lshr_b32 s52, s44, 3
    s_lshl_b32 s53, s51, 3
    s_lshl_b32 s45, s52, 8
    s_add_u32 s53, s53, s45
    s_mul_i32 s53, s53, 514
    s_lshl_b32 s45, s3, 7
    s_add_u32 s53, s53, s45
    s_add_u32 s53, s53, 2
    v_lshrrev_b32 v2, 3, v0
    v_and_b32_e64 v3, 7, v0
    v_mul_u32_u24 v4, 514, v2
    v_lshl_add_u32 v4, v3, 4, v4
    s_waitcnt lgkmcnt(0)
    s_mov_b32 s32, s6
    s_and_b32 s33, s7, 0xffff
    s_mov_b32 s34, 0x101000
    s_mov_b32 s35, 0x00020000
    s_mov_b32 s36, s8
    s_and_b32 s37, s9, 0xffff
    s_mov_b32 s38, 0x101000
    s_mov_b32 s39, 0x00020000
    s_lshl_b32 s56, s3, 13
    s_add_u32 s56, s56, 40960
    s_add_u32 m0, s56, 0
    s_nop 0
    buffer_load_dwordx4 v4, s[32:35], s53 offen lds
    s_add_u32 m0, s56, 4096
    s_nop 0
    buffer_load_dwordx4 v4, s[36:39], s53 offen lds
    s_add_u32 s53, s53, 32896
    s_add_u32 m0, s56, 1024
    s_nop 0
    buffer_load_dwordx4 v4, s[32:35], s53 offen lds
    s_add_u32 m0, s56, 5120
    s_nop 0
    buffer_load_dwordx4 v4, s[36:39], s53 offen lds
    s_add_u32 s53, s53, 32896
    s_add_u32 m0, s56, 2048
    s_nop 0
    buffer_load_dwordx4 v4, s[32:35], s53 offen lds
    s_add_u32 m0, s56, 6144
    s_nop 0
    buffer_load_dwordx4 v4, s[36:39], s53 offen lds
    s_add_u32 s53, s53, 32896
    s_add_u32 m0, s56, 3072
    s_nop 0
    buffer_load_dwordx4 v4, s[32:35], s53 offen lds
    s_add_u32 m0, s56, 7168
    s_nop 0
    buffer_load_dwordx4 v4, s[36:39], s53 offen lds
    s_add_u32 s53, s53, 32896
    s_add_u32 s28, s24, 0x400000
    s_addc_u32 s29, s25, 0
    s_and_b32 s29, s29, 0xffff
    s_mov_b32 s30, 0x2800000
    s_mov_b32 s31, 0x00020000
    v_lshlrev_b32_e64 v11, 16, v2
    v_lshl_add_u32 v11, v3, 4, v11
    v_lshlrev_b32_e64 v12, 7, v3
    v_lshl_add_u32 v12, v2, 4, v12
    v_add_u32_e64 v12, s56, v12
    s_lshl_b32 s58, s3, 19
    s_lshr_b32 s45, s51, 1
    s_lshl_b32 s45, s45, 11
    s_add_u32 s58, s58, s45
    s_and_b32 s45, s51, 1
    s_lshl_b32 s45, s45, 7
    s_add_u32 s58, s58, s45
    s_lshl_b32 s45, s52, 8
    s_add_u32 s58, s58, s45
    s_add_u32 s58, s58, 0x800000
    s_mov_b32 s50, 0x05040100
    s_mov_b32 s51, 0x07060302
    s_waitcnt vmcnt(0)
    ds_read_b128 v[64:67], v12 offset:0
    ds_read_b128 v[68:71], v12 offset:1024
    ds_read_b128 v[72:75], v12 offset:2048
    ds_read_b128 v[76:79], v12 offset:3072
    ds_read_b128 v[80:83], v12 offset:4096
    ds_read_b128 v[84:87], v12 offset:5120
    ds_read_b128 v[88:91], v12 offset:6144
    ds_read_b128 v[92:95], v12 offset:7168
    s_mov_b32 s32, s4
    s_and_b32 s33, s5, 0xffff
    s_mov_b32 s34, 0x200000
    s_mov_b32 s35, 0x00020000
    s_add_u32 s45, s48, 0
    buffer_load_dwordx4 v[16:19], v1, s[32:35], s45 offen
    s_add_u32 s45, s48, 32768
    buffer_load_dwordx4 v[20:23], v1, s[32:35], s45 offen
    s_add_u32 s45, s48, 65536
    buffer_load_dwordx4 v[24:27], v1, s[32:35], s45 offen
    s_add_u32 s45, s48, 98304
    buffer_load_dwordx4 v[28:31], v1, s[32:35], s45 offen
    s_add_u32 s45, s48, 16384
    buffer_load_dwordx4 v[32:35], v1, s[32:35], s45 offen
    s_add_u32 s45, s48, 49152
    buffer_load_dwordx4 v[36:39], v1, s[32:35], s45 offen
    s_add_u32 s45, s48, 81920
    buffer_load_dwordx4 v[40:43], v1, s[32:35], s45 offen
    s_add_u32 s45, s48, 114688
    buffer_load_dwordx4 v[44:47], v1, s[32:35], s45 offen
    s_waitcnt lgkmcnt(0)
    v_mov_b32 v9, 0x3f803f80
    s_waitcnt vmcnt(0)
    v_dot2_f32_bf16 v48, v16, v9, 0
    v_dot2_f32_bf16 v56, v16, v16, 0
    v_dot2_f32_bf16 v49, v20, v9, 0
    v_dot2_f32_bf16 v57, v20, v20, 0
    v_dot2_f32_bf16 v50, v24, v9, 0
    v_dot2_f32_bf16 v58, v24, v24, 0
    v_dot2_f32_bf16 v51, v28, v9, 0
    v_dot2_f32_bf16 v59, v28, v28, 0
    v_dot2_f32_bf16 v52, v32, v9, 0
    v_dot2_f32_bf16 v60, v32, v32, 0
    v_perm_b32 v96, v80, v64, s50
    v_perm_b32 v97, v84, v68, s50
    v_perm_b32 v98, v88, v72, s50
    v_perm_b32 v99, v92, v76, s50
    buffer_store_dwordx4 v[96:99], v11, s[28:31], s58 offen sc1
    s_add_u32 s58, s58, 8192
    v_dot2_f32_bf16 v53, v36, v9, 0
    v_dot2_f32_bf16 v61, v36, v36, 0
    v_dot2_f32_bf16 v54, v40, v9, 0
    v_dot2_f32_bf16 v62, v40, v40, 0
    v_dot2_f32_bf16 v55, v44, v9, 0
    v_dot2_f32_bf16 v63, v44, v44, 0
    v_dot2_f32_bf16 v48, v17, v9, v48
    v_dot2_f32_bf16 v56, v17, v17, v56
    v_dot2_f32_bf16 v49, v21, v9, v49
    v_dot2_f32_bf16 v57, v21, v21, v57
    v_dot2_f32_bf16 v50, v25, v9, v50
    v_dot2_f32_bf16 v58, v25, v25, v58
    v_dot2_f32_bf16 v51, v29, v9, v51
    v_perm_b32 v100, v80, v64, s51
    v_perm_b32 v101, v84, v68, s51
    v_perm_b32 v102, v88, v72, s51
    v_perm_b32 v103, v92, v76, s51
    buffer_store_dwordx4 v[100:103], v11, s[28:31], s58 offen sc1
    s_add_u32 s58, s58, 8192
    v_dot2_f32_bf16 v59, v29, v29, v59
    v_dot2_f32_bf16 v52, v33, v9, v52
    v_dot2_f32_bf16 v60, v33, v33, v60
    v_dot2_f32_bf16 v53, v37, v9, v53
    v_dot2_f32_bf16 v61, v37, v37, v61
    v_dot2_f32_bf16 v54, v41, v9, v54
    v_dot2_f32_bf16 v62, v41, v41, v62
    v_dot2_f32_bf16 v55, v45, v9, v55
    v_dot2_f32_bf16 v63, v45, v45, v63
    v_dot2_f32_bf16 v48, v18, v9, v48
    v_dot2_f32_bf16 v56, v18, v18, v56
    v_dot2_f32_bf16 v49, v22, v9, v49
    v_dot2_f32_bf16 v57, v22, v22, v57
    v_dot2_f32_bf16 v50, v26, v9, v50
    v_perm_b32 v104, v81, v65, s50
    v_perm_b32 v105, v85, v69, s50
    v_perm_b32 v106, v89, v73, s50
    v_perm_b32 v107, v93, v77, s50
    buffer_store_dwordx4 v[104:107], v11, s[28:31], s58 offen sc1
    s_add_u32 s58, s58, 8192
    v_dot2_f32_bf16 v58, v26, v26, v58
    v_dot2_f32_bf16 v51, v30, v9, v51
    v_dot2_f32_bf16 v59, v30, v30, v59
    v_dot2_f32_bf16 v52, v34, v9, v52
    v_dot2_f32_bf16 v60, v34, v34, v60
    v_dot2_f32_bf16 v53, v38, v9, v53
    v_dot2_f32_bf16 v61, v38, v38, v61
    v_dot2_f32_bf16 v54, v42, v9, v54
    v_dot2_f32_bf16 v62, v42, v42, v62
    v_dot2_f32_bf16 v55, v46, v9, v55
    v_dot2_f32_bf16 v63, v46, v46, v63
    v_dot2_f32_bf16 v48, v19, v9, v48
    v_dot2_f32_bf16 v56, v19, v19, v56
    v_dot2_f32_bf16 v49, v23, v9, v49
    v_perm_b32 v108, v81, v65, s51
    v_perm_b32 v109, v85, v69, s51
    v_perm_b32 v110, v89, v73, s51
    v_perm_b32 v111, v93, v77, s51
    buffer_store_dwordx4 v[108:111], v11, s[28:31], s58 offen sc1
    s_add_u32 s58, s58, 8192
    v_dot2_f32_bf16 v57, v23, v23, v57
    v_dot2_f32_bf16 v50, v27, v9, v50
    v_dot2_f32_bf16 v58, v27, v27, v58
    v_dot2_f32_bf16 v51, v31, v9, v51
    v_dot2_f32_bf16 v59, v31, v31, v59
    v_dot2_f32_bf16 v52, v35, v9, v52
    v_dot2_f32_bf16 v60, v35, v35, v60
    v_dot2_f32_bf16 v53, v39, v9, v53
    v_dot2_f32_bf16 v61, v39, v39, v61
    v_dot2_f32_bf16 v54, v43, v9, v54
    v_dot2_f32_bf16 v62, v43, v43, v62
    v_dot2_f32_bf16 v55, v47, v9, v55
    v_dot2_f32_bf16 v63, v47, v47, v63
    v_add_f32 v48, v48, v48 row_ror:8 row_mask:0xf bank_mask:0x3
    v_perm_b32 v112, v82, v66, s50
    v_perm_b32 v113, v86, v70, s50
    v_perm_b32 v114, v90, v74, s50
    v_perm_b32 v115, v94, v78, s50
    buffer_store_dwordx4 v[112:115], v11, s[28:31], s58 offen sc1
    s_add_u32 s58, s58, 8192
    v_add_f32 v56, v56, v56 row_ror:8 row_mask:0xf bank_mask:0x3
    v_add_f32 v49, v49, v49 row_ror:8 row_mask:0xf bank_mask:0x3
    v_add_f32 v57, v57, v57 row_ror:8 row_mask:0xf bank_mask:0x3
    v_add_f32 v50, v50, v50 row_ror:8 row_mask:0xf bank_mask:0x3
    v_add_f32 v58, v58, v58 row_ror:8 row_mask:0xf bank_mask:0x3
    v_add_f32 v51, v51, v51 row_ror:8 row_mask:0xf bank_mask:0x3
    v_add_f32 v59, v59, v59 row_ror:8 row_mask:0xf bank_mask:0x3
    v_add_f32 v48, v52, v52 row_ror:8 row_mask:0xf bank_mask:0xc
    v_add_f32 v56, v60, v60 row_ror:8 row_mask:0xf bank_mask:0xc
    v_add_f32 v49, v53, v53 row_ror:8 row_mask:0xf bank_mask:0xc
    v_add_f32 v57, v61, v61 row_ror:8 row_mask:0xf bank_mask:0xc
    v_add_f32 v50, v54, v54 row_ror:8 row_mask:0xf bank_mask:0xc
    v_add_f32 v58, v62, v62 row_ror:8 row_mask:0xf bank_mask:0xc
    v_perm_b32 v116, v82, v66, s51
    v_perm_b32 v117, v86, v70, s51
    v_perm_b32 v118, v90, v74, s51
    v_perm_b32 v119, v94, v78, s51
    buffer_store_dwordx4 v[116:119], v11, s[28:31], s58 offen sc1
    s_add_u32 s58, s58, 8192
    v_add_f32 v51, v55, v55 row_ror:8 row_mask:0xf bank_mask:0xc
    v_add_f32 v59, v63, v63 row_ror:8 row_mask:0xf bank_mask:0xc
    v_add_f32 v48, v48, v48 row_half_mirror row_mask:0xf bank_mask:0x5
    v_add_f32 v56, v56, v56 row_half_mirror row_mask:0xf bank_mask:0x5
    v_add_f32 v49, v49, v49 row_half_mirror row_mask:0xf bank_mask:0x5
    v_add_f32 v57, v57, v57 row_half_mirror row_mask:0xf bank_mask:0x5
    v_add_f32 v48, v50, v50 row_half_mirror row_mask:0xf bank_mask:0xa
    v_add_f32 v56, v58, v58 row_half_mirror row_mask:0xf bank_mask:0xa
    v_add_f32 v49, v51, v51 row_half_mirror row_mask:0xf bank_mask:0xa
    v_add_f32 v57, v59, v59 row_half_mirror row_mask:0xf bank_mask:0xa
    v_add_f32 v48, v48, v48 quad_perm:[1,0,3,2] row_mask:0xf bank_mask:0xf
    v_add_f32 v56, v56, v56 quad_perm:[1,0,3,2] row_mask:0xf bank_mask:0xf
    v_add_f32 v49, v49, v49 quad_perm:[1,0,3,2] row_mask:0xf bank_mask:0xf
    v_add_f32 v57, v57, v57 quad_perm:[1,0,3,2] row_mask:0xf bank_mask:0xf
    v_perm_b32 v120, v83, v67, s50
    v_perm_b32 v121, v87, v71, s50
    v_perm_b32 v122, v91, v75, s50
    v_perm_b32 v123, v95, v79, s50
    buffer_store_dwordx4 v[120:123], v11, s[28:31], s58 offen sc1
    s_add_u32 s58, s58, 8192
    v_add_f32 v48, v48, v48 quad_perm:[2,3,0,1] row_mask:0xf bank_mask:0xf
    v_add_f32 v56, v56, v56 quad_perm:[2,3,0,1] row_mask:0xf bank_mask:0xf
    v_add_f32 v49, v49, v49 quad_perm:[2,3,0,1] row_mask:0xf bank_mask:0xf
    v_add_f32 v57, v57, v57 quad_perm:[2,3,0,1] row_mask:0xf bank_mask:0xf
    s_nop 0
    v_permlane16_swap_b32 v48, v49
    v_permlane16_swap_b32 v56, v57
    v_add_f32 v48, v48, v49
    v_add_f32 v56, v56, v57
    s_nop 1
    v_permlane32_swap_b32 v48, v56
    v_add_f32 v48, v48, v56
    v_mov_b32 v56, v48
    s_nop 1
    v_permlane32_swap_b32 v48, v56
    v_mul_f32 v48, v48, v48
    v_fmamk_f32 v48, v48, 0xbb000000, v56
    v_perm_b32 v124, v83, v67, s51
    v_perm_b32 v125, v87, v71, s51
    v_perm_b32 v126, v91, v75, s51
    v_perm_b32 v127, v95, v79, s51
    buffer_store_dwordx4 v[124:127], v11, s[28:31], s58 offen sc1
    s_add_u32 s58, s58, 8192
    v_max_f32_e64 v48, 0, v48
    v_bfe_u32 v9, v0, 4, 1
    v_bfe_u32 v10, v0, 2, 2
    v_lshl_add_u32 v9, v10, 1, v9
    s_lshl_b32 s45, s3, 3
    v_add_lshl_u32 v9, v9, s45, 2
    ds_write_b32 v9, v48
    s_lshr_b32 s59, s44, 4
    s_lshl_b32 s59, s59, 11
    s_and_b32 s45, s44, 15
    s_lshl_b32 s45, s45, 6
    s_add_u32 s59, s59, s45
    s_add_u32 s59, s59, 0x1084000
    v_lshlrev_b32_e64 v9, 2, v0
    s_waitcnt lgkmcnt(0)
    s_barrier
    s_cmp_lg_u32 s3, 0
    s_cbranch_scc1 L_p1_noss
    v_and_b32 v9, 0x7c, v9
    ds_read_b32 v10, v9
    v_and_b32_e64 v9, 12, v9
    v_bfe_u32 v8, v0, 3, 2
    v_lshl_add_u32 v9, v8, 4, v9
    v_bfe_u32 v8, v0, 2, 1
    v_lshl_add_u32 v9, v8, 10, v9
    v_lshrrev_b32 v8, 5, v0
    v_lshl_add_u32 v9, v8, 13, v9
    s_waitcnt lgkmcnt(0)
    buffer_store_dword v10, v9, s[28:31], s59 offen sc1
L_p1_noss:
    s_branch L_p1_done
L_p1_misc:
    s_waitcnt lgkmcnt(0)
    s_add_u32 s28, s24, 0x400000
    s_addc_u32 s29, s25, 0
    s_and_b32 s29, s29, 0xffff
    s_mov_b32 s30, 0x2800000
    s_mov_b32 s31, 0x00020000
    s_mov_b32 s32, s22
    s_and_b32 s33, s23, 0xffff
    s_mov_b32 s34, 0x100
    s_mov_b32 s35, 0x00020000
    s_cmp_lg_u32 s2, 255
    s_cbranch_scc1 L_p1_f
    v_lshrrev_b32 v10, 2, v0
    v_and_b32 v11, 3, v0
    v_lshlrev_b32 v10, 8, v10
    v_lshl_add_u32 v10, v11, 4, v10
    v_mov_b32 v16, 0
    v_mov_b32 v17, 0
    v_mov_b32_e64 v18, 0
    v_mov_b32 v19, 0
    s_mul_i32 s45, s3, 16384
    s_add_u32 s45, s45, s62
    buffer_store_dwordx4 v[16:19], v10, s[28:31], s45 offen sc1
    s_add_u32 s45, s45, 4096
    buffer_store_dwordx4 v[16:19], v10, s[28:31], s45 offen sc1
    s_add_u32 s45, s45, 4096
    buffer_store_dwordx4 v[16:19], v10, s[28:31], s45 offen sc1
    s_add_u32 s45, s45, 4096
    buffer_store_dwordx4 v[16:19], v10, s[28:31], s45 offen sc1
    s_add_u32 s45, s45, 4096
    s_waitcnt vmcnt(0)
    s_barrier
    s_cmp_ge_u32 s3, 2
    s_cbranch_scc1 L_p1_z2
    s_cmp_lg_u32 s3, 0
    s_cbranch_scc1 L_p1_z1
    v_mov_b32 v13, 1
    s_mov_b64 exec, 1
    buffer_store_dword v13, off, s[32:35], 0 sc1
    s_mov_b64 exec, -1
    s_branch L_p1_f
L_p1_z1:
    s_mov_b32 s45, 0x1090000
    buffer_store_dwordx4 v[16:19], v1, s[28:31], s45 offen offset:0 sc1
    buffer_store_dwordx4 v[16:19], v1, s[28:31], s45 offen offset:1024 sc1
    buffer_store_dwordx4 v[16:19], v1, s[28:31], s45 offen offset:2048 sc1
    buffer_store_dwordx4 v[16:19], v1, s[28:31], s45 offen offset:3072 sc1
    s_mov_b32 s45, 0x1092000
    buffer_store_dwordx4 v[16:19], v1, s[28:31], s45 offen offset:0 sc1
    buffer_store_dwordx4 v[16:19], v1, s[28:31], s45 offen offset:1024 sc1
    buffer_store_dwordx4 v[16:19], v1, s[28:31], s45 offen offset:2048 sc1
    buffer_store_dwordx4 v[16:19], v1, s[28:31], s45 offen offset:3072 sc1
    s_mov_b32 s45, 0x1094000
    buffer_store_dwordx4 v[16:19], v1, s[28:31], s45 offen offset:0 sc1
    buffer_store_dwordx4 v[16:19], v1, s[28:31], s45 offen offset:1024 sc1
    buffer_store_dwordx4 v[16:19], v1, s[28:31], s45 offen offset:2048 sc1
    buffer_store_dwordx4 v[16:19], v1, s[28:31], s45 offen offset:3072 sc1
    s_mov_b32 s45, 0x1096000
    buffer_store_dwordx4 v[16:19], v1, s[28:31], s45 offen offset:0 sc1
    buffer_store_dwordx4 v[16:19], v1, s[28:31], s45 offen offset:1024 sc1
    buffer_store_dwordx4 v[16:19], v1, s[28:31], s45 offen offset:2048 sc1
    buffer_store_dwordx4 v[16:19], v1, s[28:31], s45 offen offset:3072 sc1
    s_branch L_p1_f
L_p1_z2:
    s_lshl_b32 s45, s3, 13
    s_add_u32 s45, s45, 0x1084000
    buffer_store_dwordx4 v[16:19], v1, s[28:31], s45 offen sc1
    s_add_u32 s45, s45, 1024
    buffer_store_dwordx4 v[16:19], v1, s[28:31], s45 offen sc1
    s_add_u32 s45, s45, 1024
    buffer_store_dwordx4 v[16:19], v1, s[28:31], s45 offen sc1
    s_add_u32 s45, s45, 1024
    buffer_store_dwordx4 v[16:19], v1, s[28:31], s45 offen sc1
    s_add_u32 s45, s45, 1024
    buffer_store_dwordx4 v[16:19], v1, s[28:31], s45 offen sc1
    s_add_u32 s45, s45, 1024
    buffer_store_dwordx4 v[16:19], v1, s[28:31], s45 offen sc1
    s_add_u32 s45, s45, 1024
    buffer_store_dwordx4 v[16:19], v1, s[28:31], s45 offen sc1
    s_add_u32 s45, s45, 1024
    buffer_store_dwordx4 v[16:19], v1, s[28:31], s45 offen sc1
    s_add_u32 s45, s45, 1024
L_p1_f:
    v_lshlrev_b32 v2, 7, v0
    s_mov_b32 s36, s14
    s_and_b32 s37, s15, 0xffff
    s_mov_b32 s38, 0xe00
    s_mov_b32 s39, 0x00020000
    buffer_load_dword a252, v2, s[36:39], 0 offen
    s_mov_b32 s36, s18
    s_and_b32 s37, s19, 0xffff
    s_mov_b32 s38, 0x400
    s_mov_b32 s39, 0x00020000
    buffer_load_dword a252, v2, s[36:39], 0 offen
    s_cmp_lg_u32 s27, 30
    s_cbranch_scc1 L_p1_done
    v_and_b32 v32, 0x33, v0
    v_bfe_u32 v33, v0, 2, 1
    v_lshl_or_b32 v32, v33, 3, v32
    v_bfe_u32 v33, v0, 3, 1
    v_lshl_or_b32 v32, v33, 2, v32
    v_lshlrev_b32_e64 v32, 4, v32
    v_bfe_u32 v32, v32, 4, 5
    s_and_b32 s46, s2, 7
    s_lshl_b32 s45, s46, 5
    v_add_u32 v32, s45, v32
    v_cvt_f32_u32 v32, v32
    v_mul_f32 v32, 0x3b000000, v32
    v_lshrrev_b32 v33, 5, v0
    s_lshl_b32 s45, s3, 4
    v_lshl_add_u32 v33, v33, 1, s45
    v_cmp_eq_u32 vcc, 0, v33
    v_cvt_f32_u32 v33, v33
    s_mul_i32 s46, s46, 144
    s_lshl_b32 s45, s3, 3
    s_add_u32 s46, s46, s45
    s_add_u32 s46, s46, 112
    s_lshl_b32 s46, s46, 10
    s_add_u32 s46, s46, 0xe00000
    v_add_f32 v36, 0x00000000, v33
    v_add_f32 v37, 0x3f800000, v33
    v_add_f32 v38, 0x40800000, v33
    v_add_f32 v39, 0x40a00000, v33
    v_mov_b32 v34, 0x43800000
    v_cndmask_b32 v36, v36, v34, vcc
    v_mul_f32 v36, v36, v32
    v_mul_f32 v37, v37, v32
    v_mul_f32 v38, v38, v32
    v_mul_f32 v39, v39, v32
    v_fract_f32 v36, v36
    v_fract_f32 v37, v37
    v_fract_f32 v38, v38
    v_fract_f32 v39, v39
    v_cos_f32 v40, v36
    v_sin_f32 v44, v36
    v_cos_f32 v41, v37
    v_sin_f32 v45, v37
    v_cos_f32 v42, v38
    v_sin_f32 v46, v38
    v_cos_f32 v43, v39
    v_sin_f32 v47, v39
    v_mul_f32 v34, 0x3f3504f3, v40
    v_cndmask_b32 v40, v40, v34, vcc
    v_cndmask_b32 v44, v44, -0.5, vcc
    v_mul_f32 v40, 0x3d800000, v40
    v_mul_f32 v44, 0xbd800000, v44
    v_mul_f32 v41, 0x3d800000, v41
    v_mul_f32 v45, 0xbd800000, v45
    v_mul_f32 v42, 0x3d800000, v42
    v_mul_f32 v46, 0xbd800000, v46
    v_mul_f32 v43, 0x3d800000, v43
    v_mul_f32 v47, 0xbd800000, v47
    v_cvt_pk_bf16_f32 v48, v40, v44
    v_cvt_pk_bf16_f32 v49, v41, v45
    v_cvt_pk_bf16_f32 v50, v42, v46
    v_cvt_pk_bf16_f32 v51, v43, v47
    buffer_store_dwordx4 v[48:51], v1, s[28:31], s46 offen offset:0 sc1
    v_add_f32 v36, 0x41000000, v33
    v_add_f32 v37, 0x41100000, v33
    v_add_f32 v38, 0x41400000, v33
    v_add_f32 v39, 0x41500000, v33
    v_mul_f32 v36, v36, v32
    v_mul_f32 v37, v37, v32
    v_mul_f32 v38, v38, v32
    v_mul_f32 v39, v39, v32
    v_fract_f32 v36, v36
    v_fract_f32 v37, v37
    v_fract_f32 v38, v38
    v_fract_f32 v39, v39
    v_cos_f32 v40, v36
    v_sin_f32 v44, v36
    v_cos_f32 v41, v37
    v_sin_f32 v45, v37
    v_cos_f32 v42, v38
    v_sin_f32 v46, v38
    v_cos_f32 v43, v39
    v_sin_f32 v47, v39
    v_mul_f32 v40, 0x3d800000, v40
    v_mul_f32 v44, 0xbd800000, v44
    v_mul_f32 v41, 0x3d800000, v41
    v_mul_f32 v45, 0xbd800000, v45
    v_mul_f32 v42, 0x3d800000, v42
    v_mul_f32 v46, 0xbd800000, v46
    v_mul_f32 v43, 0x3d800000, v43
    v_mul_f32 v47, 0xbd800000, v47
    v_cvt_pk_bf16_f32 v52, v40, v44
    v_cvt_pk_bf16_f32 v53, v41, v45
    v_cvt_pk_bf16_f32 v54, v42, v46
    v_cvt_pk_bf16_f32 v55, v43, v47
    buffer_store_dwordx4 v[52:55], v1, s[28:31], s46 offen offset:1024 sc1
    v_add_f32 v36, 0x43000000, v33
    v_add_f32 v37, 0x43010000, v33
    v_add_f32 v38, 0x43040000, v33
    v_add_f32 v39, 0x43050000, v33
    v_mul_f32 v36, v36, v32
    v_mul_f32 v37, v37, v32
    v_mul_f32 v38, v38, v32
    v_mul_f32 v39, v39, v32
    v_fract_f32 v36, v36
    v_fract_f32 v37, v37
    v_fract_f32 v38, v38
    v_fract_f32 v39, v39
    v_cos_f32 v40, v36
    v_sin_f32 v44, v36
    v_cos_f32 v41, v37
    v_sin_f32 v45, v37
    v_cos_f32 v42, v38
    v_sin_f32 v46, v38
    v_cos_f32 v43, v39
    v_sin_f32 v47, v39
    v_mul_f32 v40, 0x3d800000, v40
    v_mul_f32 v44, 0xbd800000, v44
    v_mul_f32 v41, 0x3d800000, v41
    v_mul_f32 v45, 0xbd800000, v45
    v_mul_f32 v42, 0x3d800000, v42
    v_mul_f32 v46, 0xbd800000, v46
    v_mul_f32 v43, 0x3d800000, v43
    v_mul_f32 v47, 0xbd800000, v47
    v_cvt_pk_bf16_f32 v56, v40, v44
    v_cvt_pk_bf16_f32 v57, v41, v45
    v_cvt_pk_bf16_f32 v58, v42, v46
    v_cvt_pk_bf16_f32 v59, v43, v47
    buffer_store_dwordx4 v[56:59], v1, s[28:31], s46 offen offset:2048 sc1
    v_add_f32 v36, 0x43080000, v33
    v_add_f32 v37, 0x43090000, v33
    v_add_f32 v38, 0x430c0000, v33
    v_add_f32 v39, 0x430d0000, v33
    v_mul_f32 v36, v36, v32
    v_mul_f32 v37, v37, v32
    v_mul_f32 v38, v38, v32
    v_mul_f32 v39, v39, v32
    v_fract_f32 v36, v36
    v_fract_f32 v37, v37
    v_fract_f32 v38, v38
    v_fract_f32 v39, v39
    v_cos_f32 v40, v36
    v_sin_f32 v44, v36
    v_cos_f32 v41, v37
    v_sin_f32 v45, v37
    v_cos_f32 v42, v38
    v_sin_f32 v46, v38
    v_cos_f32 v43, v39
    v_sin_f32 v47, v39
    v_mul_f32 v40, 0x3d800000, v40
    v_mul_f32 v44, 0xbd800000, v44
    v_mul_f32 v41, 0x3d800000, v41
    v_mul_f32 v45, 0xbd800000, v45
    v_mul_f32 v42, 0x3d800000, v42
    v_mul_f32 v46, 0xbd800000, v46
    v_mul_f32 v43, 0x3d800000, v43
    v_mul_f32 v47, 0xbd800000, v47
    v_cvt_pk_bf16_f32 v60, v40, v44
    v_cvt_pk_bf16_f32 v61, v41, v45
    v_cvt_pk_bf16_f32 v62, v42, v46
    v_cvt_pk_bf16_f32 v63, v43, v47
    buffer_store_dwordx4 v[60:63], v1, s[28:31], s46 offen offset:3072 sc1
    v_sub_f32 v36, 0x43800000, v33
    v_sub_f32 v37, 0x437f0000, v33
    v_sub_f32 v38, 0x437c0000, v33
    v_sub_f32 v39, 0x437b0000, v33
    v_mov_b32 v34, 0x42800000
    v_cndmask_b32 v36, v36, v34, vcc
    v_mul_f32 v36, v36, v32
    v_mul_f32 v37, v37, v32
    v_mul_f32 v38, v38, v32
    v_mul_f32 v39, v39, v32
    v_fract_f32 v36, v36
    v_fract_f32 v37, v37
    v_fract_f32 v38, v38
    v_fract_f32 v39, v39
    v_cos_f32 v40, v36
    v_sin_f32 v44, v36
    v_cos_f32 v41, v37
    v_sin_f32 v45, v37
    v_cos_f32 v42, v38
    v_sin_f32 v46, v38
    v_cos_f32 v43, v39
    v_sin_f32_e64 v47, v39
    v_mul_f32 v40, 0x3d800000, v40
    v_mul_f32 v44, 0xbd800000, v44
    v_mul_f32 v41, 0x3d800000, v41
    v_mul_f32 v45, 0xbd800000, v45
    v_mul_f32 v42, 0x3d800000, v42
    v_mul_f32 v46, 0xbd800000, v46
    v_mul_f32 v43, 0x3d800000, v43
    v_mul_f32 v47, 0xbd800000, v47
    v_cvt_pk_bf16_f32 v64, v40, v44
    v_cvt_pk_bf16_f32 v65, v41, v45
    v_cvt_pk_bf16_f32 v66, v42, v46
    v_cvt_pk_bf16_f32 v67, v43, v47
    s_add_u32 s46, s46, 4096
    buffer_store_dwordx4 v[64:67], v1, s[28:31], s46 offen offset:0 sc1
    v_sub_f32 v36, 0x43780000, v33
    v_sub_f32 v37, 0x43770000, v33
    v_sub_f32 v38, 0x43740000, v33
    v_sub_f32 v39, 0x43730000, v33
    v_mul_f32 v36, v36, v32
    v_mul_f32 v37, v37, v32
    v_mul_f32 v38, v38, v32
    v_mul_f32 v39, v39, v32
    v_fract_f32 v36, v36
    v_fract_f32 v37, v37
    v_fract_f32 v38, v38
    v_fract_f32 v39, v39
    v_cos_f32 v40, v36
    v_sin_f32 v44, v36
    v_cos_f32 v41, v37
    v_sin_f32 v45, v37
    v_cos_f32 v42, v38
    v_sin_f32 v46, v38
    v_cos_f32 v43, v39
    v_sin_f32 v47, v39
    v_mul_f32 v40, 0x3d800000, v40
    v_mul_f32 v44, 0xbd800000, v44
    v_mul_f32 v41, 0x3d800000, v41
    v_mul_f32 v45, 0xbd800000, v45
    v_mul_f32 v42, 0x3d800000, v42
    v_mul_f32 v46, 0xbd800000, v46
    v_mul_f32 v43, 0x3d800000, v43
    v_mul_f32 v47, 0xbd800000, v47
    v_cvt_pk_bf16_f32 v68, v40, v44
    v_cvt_pk_bf16_f32 v69, v41, v45
    v_cvt_pk_bf16_f32 v70, v42, v46
    v_cvt_pk_bf16_f32 v71, v43, v47
    buffer_store_dwordx4 v[68:71], v1, s[28:31], s46 offen offset:1024 sc1
    v_sub_f32 v36, 0x43000000, v33
    v_sub_f32 v37, 0x42fe0000, v33
    v_sub_f32 v38, 0x42f80000, v33
    v_sub_f32 v39, 0x42f60000, v33
    v_mov_b32 v34, 0x43400000
    v_cndmask_b32 v36, v36, v34, vcc
    v_mul_f32 v36, v36, v32
    v_mul_f32 v37, v37, v32
    v_mul_f32 v38, v38, v32
    v_mul_f32 v39, v39, v32
    v_fract_f32 v36, v36
    v_fract_f32 v37, v37
    v_fract_f32 v38, v38
    v_fract_f32 v39, v39
    v_cos_f32 v40, v36
    v_sin_f32 v44, v36
    v_cos_f32 v41, v37
    v_sin_f32 v45, v37
    v_cos_f32 v42, v38
    v_sin_f32 v46, v38
    v_cos_f32 v43, v39
    v_sin_f32_e64 v47, v39
    v_mul_f32 v40, 0x3d800000, v40
    v_mul_f32 v44, 0xbd800000, v44
    v_mul_f32 v41, 0x3d800000, v41
    v_mul_f32 v45, 0xbd800000, v45
    v_mul_f32 v42, 0x3d800000, v42
    v_mul_f32 v46, 0xbd800000, v46
    v_mul_f32 v43, 0x3d800000, v43
    v_mul_f32 v47, 0xbd800000, v47
    v_cvt_pk_bf16_f32 v72, v40, v44
    v_cvt_pk_bf16_f32 v73, v41, v45
    v_cvt_pk_bf16_f32 v74, v42, v46
    v_cvt_pk_bf16_f32 v75, v43, v47
    buffer_store_dwordx4 v[72:75], v1, s[28:31], s46 offen offset:2048 sc1
    v_sub_f32 v36, 0x42f00000, v33
    v_sub_f32 v37, 0x42ee0000, v33
    v_sub_f32 v38, 0x42e80000, v33
    v_sub_f32 v39, 0x42e60000, v33
    v_mul_f32 v36, v36, v32
    v_mul_f32 v37, v37, v32
    v_mul_f32 v38, v38, v32
    v_mul_f32 v39, v39, v32
    v_fract_f32 v36, v36
    v_fract_f32 v37, v37
    v_fract_f32 v38, v38
    v_fract_f32 v39, v39
    v_cos_f32 v40, v36
    v_sin_f32 v44, v36
    v_cos_f32 v41, v37
    v_sin_f32 v45, v37
    v_cos_f32 v42, v38
    v_sin_f32 v46, v38
    v_cos_f32 v43, v39
    v_sin_f32 v47, v39
    v_mul_f32 v40, 0x3d800000, v40
    v_mul_f32 v44, 0xbd800000, v44
    v_mul_f32 v41, 0x3d800000, v41
    v_mul_f32 v45, 0xbd800000, v45
    v_mul_f32 v42, 0x3d800000, v42
    v_mul_f32 v46, 0xbd800000, v46
    v_mul_f32 v43, 0x3d800000, v43
    v_mul_f32 v47, 0xbd800000, v47
    v_cvt_pk_bf16_f32 v76, v40, v44
    v_cvt_pk_bf16_f32 v77, v41, v45
    v_cvt_pk_bf16_f32 v78, v42, v46
    v_cvt_pk_bf16_f32 v79, v43, v47
    buffer_store_dwordx4 v[76:79], v1, s[28:31], s46 offen offset:3072 sc1
    s_branch L_p1_done
L_exit:
    s_endpgm
.p2align 12
L_p1_done:
    s_cbranch_execz L_h1_ret
    s_mov_b32 s32, s22
    s_and_b32 s33, s23, 0xffff
    s_mov_b32 s34, 0x100
    s_mov_b32 s35, 0x00020000
    v_min_u32 v15, 5, v0
    v_lshlrev_b32 v15, 2, v15
    buffer_load_dword v13, v15, s[32:35], 0 offen sc1
    s_lshr_b32 s46, s2, 4
    s_and_b32 s47, s2, 15
    s_lshr_b32 s63, s46, 1
    s_lshl_b32 s63, s63, 14
    s_and_b32 s45, s46, 1
    s_lshl_b32 s45, s45, 12
    s_add_u32 s63, s63, s45
    s_lshr_b32 s45, s46, 3
    s_lshl_b32 s45, s45, 13
    s_add_u32 s63, s63, s45
    s_lshl_b32 s45, s47, 8
    s_add_u32 s63, s63, s45
    s_add_u32 s63, s63, 0x10c0000
    s_cmp_lg_u32 s3, 0
    s_cbranch_scc1 Lfl_1
    v_mov_b32 v9, 0
    v_lshlrev_b32 v11, 2, v0
    s_mov_b64 exec, 0xffff
    buffer_store_dword v9, v11, s[28:31], s63 offen sc1
    s_mov_b64 exec, -1
Lfl_1:
    s_and_b32 s45, s2, 31
    s_lshl_b32 s45, s45, 8
    v_lshl_add_u32 v14, v0, 13, s45
    v_and_b32 v3, 15, v0
    v_lshrrev_b32 v7, 4, v0
    v_lshlrev_b32 v8, 2, v7
    v_cvt_f32_u32 v8, v8
    s_lshl_b32 s45, s3, 4
    v_add_u32 v9, s45, v3
    v_cvt_f32_u32 v10, v9
    v_cvt_f32_u32 v11, v3
    v_mul_f32 v224, v10, v8
    v_mul_f32_e64 v225, v11, v8
    v_mul_f32 v226, 0x3c800000, v224
    v_mul_f32 v225, 0x3d000000, v225
    v_mul_f32 v224, 0x3a000000, v224
    v_and_b32_e64 v9, 1, v9
    s_mov_b32 s46, 0x80008000
    v_mul_lo_u32 v9, v9, s46
    v_fmamk_f32 v200, v10, 0x00000000, v226
    v_fmamk_f32 v201, v10, 0x3c800000, v226
    v_fmamk_f32 v202, v10, 0x3d000000, v226
    v_fmamk_f32 v203, v10, 0x3d400000, v226
    v_fmamk_f32 v204, v10, 0x3e800000, v226
    v_fmamk_f32 v205, v10, 0x3e880000, v226
    v_fmamk_f32 v206, v10, 0x3e900000, v226
    v_fmamk_f32 v207, v10, 0x3e980000, v226
    v_cos_f32 v208, v200
    v_sin_f32 v216, v200
    v_cos_f32 v209, v201
    v_sin_f32 v217, v201
    v_cos_f32 v210, v202
    v_sin_f32 v218, v202
    v_cos_f32 v211, v203
    v_sin_f32 v219, v203
    v_cos_f32 v212, v204
    v_sin_f32 v220, v204
    v_cos_f32 v213, v205
    v_sin_f32 v221, v205
    v_cos_f32 v214, v206
    v_sin_f32 v222, v206
    v_cos_f32 v215, v207
    v_sin_f32 v223, v207
    v_cvt_pk_bf16_f32 v16, v208, v209
    v_cvt_pk_bf16_f32 v24, v216, v217
    v_cvt_pk_bf16_f32 v17, v210, v211
    v_cvt_pk_bf16_f32 v25, v218, v219
    v_cvt_pk_bf16_f32 v18, v212, v213
    v_cvt_pk_bf16_f32 v26, v220, v221
    v_cvt_pk_bf16_f32 v19, v214, v215
    v_cvt_pk_bf16_f32 v27, v222, v223
    v_xor_b32 v32, s46, v24
    v_xor_b32 v20, v9, v16
    v_xor_b32 v28, v9, v24
    v_xor_b32 v36, v9, v32
    v_xor_b32 v33, s46, v25
    v_xor_b32 v21, v9, v17
    v_xor_b32 v29, v9, v25
    v_xor_b32 v37, v9, v33
    v_xor_b32 v34, s46, v26
    v_xor_b32 v22, v9, v18
    v_xor_b32 v30, v9, v26
    v_xor_b32 v38, v9, v34
    v_xor_b32 v35, s46, v27
    v_xor_b32 v23, v9, v19
    v_xor_b32 v31, v9, v27
    v_xor_b32 v39, v9, v35
    v_fmamk_f32 v200, v11, 0x00000000, v225
    v_fmamk_f32 v201, v11, 0x3d000000, v225
    v_fmamk_f32 v202, v11, 0x3d800000, v225
    v_fmamk_f32 v203, v11, 0x3dc00000, v225
    v_fmamk_f32 v204, v11, 0x3f000000, v225
    v_fmamk_f32 v205, v11, 0x3f080000, v225
    v_fmamk_f32 v206, v11, 0x3f100000, v225
    v_fmamk_f32 v207, v11, 0x3f180000, v225
    v_cos_f32 v208, v200
    v_sin_f32 v216, v200
    v_cos_f32 v209, v201
    v_sin_f32 v217, v201
    v_cos_f32 v210, v202
    v_sin_f32 v218, v202
    v_cos_f32 v211, v203
    v_sin_f32 v219, v203
    v_cos_f32 v212, v204
    v_sin_f32 v220, v204
    s_waitcnt vmcnt(0)
    v_cmp_gt_u32 vcc, 1, v13
    s_nop 0
    s_and_b64 vcc, vcc, 1
    s_mov_b32 s60, 0
    s_cbranch_vccz Lok_3
Lretry_4:
    buffer_load_dword v13, v15, s[32:35], 0 offen sc1
    s_waitcnt vmcnt(0)
    v_cmp_gt_u32 vcc, 1, v13
    s_nop 0
    s_and_b64 vcc, vcc, 1
    s_add_u32 s60, s60, 1
    s_cbranch_vccz Lok_3
    s_sleep 8
    s_cmp_lt_u32 s60, s61
    s_cbranch_scc1 Lretry_4
    s_mov_b32 s61, 1
Lok_3:
    s_barrier
    s_cmp_lg_u32 s3, 0
    s_cbranch_scc1 Larr_2
    v_mov_b32 v6, 1
    s_mov_b64 exec, 0xff
    buffer_atomic_add v6, v14, s[28:31], s62 offen offset:0 sc1
    s_mov_b64 exec, -1
Larr_2:
    v_cos_f32 v213, v205
    v_sin_f32 v221, v205
    v_cos_f32 v214, v206
    v_sin_f32 v222, v206
    v_cos_f32 v215, v207
    v_sin_f32_e64 v223, v207
    v_cvt_pk_bf16_f32 v40, v208, v209
    v_cvt_pk_bf16_f32 v48, v216, v217
    v_cvt_pk_bf16_f32 v41, v210, v211
    v_cvt_pk_bf16_f32 v49, v218, v219
    v_cvt_pk_bf16_f32 v42, v212, v213
    v_cvt_pk_bf16_f32 v50, v220, v221
    v_cvt_pk_bf16_f32 v43, v214, v215
    v_cvt_pk_bf16_f32 v51, v222, v223
    s_mov_b32 s47, 0x80000000
    v_xor_b32 v56, s46, v48
    v_xor_b32 v44, s47, v40
    v_xor_b32 v52, s47, v48
    v_xor_b32 v60, s47, v56
    v_xor_b32 v57, s46, v49
    v_xor_b32 v45, s47, v41
    v_xor_b32 v53, s47, v49
    v_xor_b32 v61, s47, v57
    v_xor_b32 v58, s46, v50
    v_xor_b32 v46, s47, v42
    v_xor_b32 v54, s47, v50
    v_xor_b32 v62, s47, v58
    v_xor_b32 v59, s46, v51
    v_xor_b32 v47, s47, v43
    v_xor_b32 v55, s47, v51
    v_xor_b32 v63, s47, v59
    v_fmamk_f32 v200, v10, 0x00000000, v224
    v_fmamk_f32 v201, v10, 0x3a000000, v224
    v_fmamk_f32 v202, v10, 0x3a800000, v224
    v_fmamk_f32 v203, v10, 0x3ac00000, v224
    v_fmamk_f32 v204, v10, 0x3c000000, v224
    v_fmamk_f32 v205, v10, 0x3c080000, v224
    v_fmamk_f32 v206, v10, 0x3c100000, v224
    v_fmamk_f32 v207, v10, 0x3c180000, v224
    v_cos_f32 v64, v200
    v_sin_f32 v72, v200
    v_cos_f32 v65, v201
    v_sin_f32 v73, v201
    v_cos_f32 v66, v202
    v_sin_f32 v74, v202
    v_cos_f32 v67, v203
    v_sin_f32 v75, v203
    v_cos_f32 v68, v204
    v_sin_f32 v76, v204
    v_cos_f32 v69, v205
    v_sin_f32 v77, v205
    v_cos_f32 v70, v206
    v_sin_f32 v78, v206
    v_cos_f32_e64 v71, v207
    v_sin_f32 v79, v207
    v_cmp_gt_u32 vcc, 1, v13
    s_mov_b32 s60, 0
    s_cbranch_vccz Lok_5
Lretry_6:
    buffer_load_dword v13, v15, s[32:35], 0 offen sc1
    s_waitcnt vmcnt(0)
    v_cmp_gt_u32 vcc, 1, v13
    s_add_u32 s60, s60, 1
    s_cbranch_vccz Lok_5
    s_sleep 8
    s_cmp_lt_u32 s60, s61
    s_cbranch_scc1 Lretry_6
    s_mov_b32 s61, 1
Lok_5:
    v_readlane_b32 s45, v13, 1
    v_cmp_le_u32 vcc, 24, v13
    s_add_u32 s26, s45, s2
    s_and_b32 s26, s26, 7
    s_and_b32 s45, vcc_lo, 0x3e
    s_bcnt1_i32_b32 s45, s45
    s_cmp_ge_u32 s45, 3
    s_cselect_b32 s45, 4, 0
    s_xor_b32 s26, s26, s45
    s_and_b32 s45, s26, 3
    s_lshl_b32 s45, s45, 1
    s_lshr_b32 s46, s26, 2
    s_or_b32 s45, s45, s46
    s_lshl_b32 s45, s45, 13
    v_min_u32_e64 v15, 31, v0
    v_lshl_add_u32 v15, v15, 8, s45
    s_and_b32 s43, s26, 1
    s_lshr_b32 s41, s26, 2
    s_lshl_b32 s41, s41, 3
    s_and_b32 s45, s27, 7
    s_add_u32 s41, s41, s45
    s_lshr_b32 s46, s27, 3
    s_and_b32 s44, s26, 2
    s_lshl_b32 s44, s44, 1
    s_add_u32 s44, s44, s46
    s_and_b32 s45, s26, 3
    s_mul_i32 s100, s45, 3
    s_add_u32 s100, s100, s46
    s_lshl_b32 s45, s27, 1
    s_xor_b32 s45, s45, s26
    s_and_b32 s45, s45, 2
    s_add_u32 s45, s45, s43
    s_add_u32 s45, s45, 12
    s_cmp_eq_u32 s46, 3
    s_cselect_b32 s100, s45, s100
    s_add_u32 s43, s43, s41
    s_add_u32 s43, s43, s41
    s_min_u32 s42, s100, 13
    s_lshl_b32 s42, s42, 2
    s_add_u32 s42, s42, s3
    s_add_u32 s45, s3, 0
    s_and_b32 s45, s45, 3
    s_lshl_b32 s45, s45, 13
    s_lshl_b32 s50, s42, 15
    s_add_u32 s50, s50, s45
    s_add_u32 s50, s50, 0xa00000
    s_add_u32 s45, s3, 1
    s_and_b32 s45, s45, 3
    s_lshl_b32 s45, s45, 13
    s_lshl_b32 s51, s42, 15
    s_add_u32 s51, s51, s45
    s_add_u32 s51, s51, 0xa00000
    s_add_u32 s45, s3, 2
    s_and_b32 s45, s45, 3
    s_lshl_b32 s45, s45, 13
    s_lshl_b32 s52, s42, 15
    s_add_u32 s52, s52, s45
    s_add_u32 s52, s52, 0xa00000
    s_add_u32 s45, s3, 3
    s_and_b32 s45, s45, 3
    s_lshl_b32 s45, s45, 13
    s_lshl_b32 s53, s42, 15
    s_add_u32 s53, s53, s45
    s_add_u32 s53, s53, 0xa00000
    s_lshr_b32 s63, s41, 1
    s_lshl_b32 s63, s63, 14
    s_and_b32 s45, s41, 1
    s_lshl_b32 s45, s45, 12
    s_add_u32 s63, s63, s45
    s_lshr_b32 s45, s41, 3
    s_lshl_b32 s45, s45, 13
    s_add_u32 s63, s63, s45
    s_lshl_b32 s45, s100, 8
    s_add_u32 s63, s63, s45
    s_add_u32 s63, s63, 0x10c0000
    s_lshl_b32 s54, s44, 1
    s_lshr_b32 s45, s3, 1
    s_add_u32 s54, s54, s45
    s_xor_b32 s55, s54, 1
    s_mul_i32 s45, s3, 28
    s_mul_i32 s54, s54, 112
    s_add_u32 s54, s54, s45
    s_lshl_b32 s54, s54, 10
    s_add_u32 s54, s54, 0xc00000
    s_mul_i32 s55, s55, 112
    s_add_u32 s55, s55, s45
    s_lshl_b32 s55, s55, 10
    s_add_u32 s55, s55, 0xc00000
    v_mov_b32_e64 v12, v1
    s_add_u32 s45, s54, 12288
    s_cmp_ge_u32 s100, 14
    s_cselect_b32 s50, s45, s50
    s_add_u32 s45, s55, 12288
    s_cmp_ge_u32 s100, 14
    s_cselect_b32 s51, s45, s51
    s_add_u32 s45, s54, 20480
    s_cmp_ge_u32 s100, 14
    s_cselect_b32 s52, s45, s52
    s_add_u32 s45, s55, 20480
    s_cmp_ge_u32 s100, 14
    s_cselect_b32 s53, s45, s53
    v_lshrrev_b32 v4, 5, v0
    v_lshlrev_b32 v4, 3, v4
    s_lshl_b32 s45, s42, 6
    s_mov_b32 s36, s14
    s_and_b32 s37, s15, 0xffff
    s_mov_b32 s38, 0xe00
    s_mov_b32 s39, 0x00020000
    buffer_load_dwordx2 v[232:233], v4, s[36:39], s45 offen offset:0
    buffer_load_dwordx2 v[234:235], v4, s[36:39], s45 offen offset:16
    buffer_load_dwordx2 v[236:237], v4, s[36:39], s45 offen offset:32
    buffer_load_dwordx2 v[238:239], v4, s[36:39], s45 offen offset:48
    s_lshr_b32 s45, s3, 1
    s_lshl_b32 s45, s45, 10
    s_and_b32 s46, s3, 1
    s_lshl_b32 s46, s46, 3
    s_add_u32 s45, s45, s46
    v_add_u32 v8, s45, v1
    v_lshrrev_b32 v9, 2, v3
    v_xor_b32 v9, v9, v7
    v_lshlrev_b32 v9, 3, v9
    v_lshl_add_u32 v9, v3, 5, v9
    s_lshl_b32 s45, s3, 9
    s_add_u32 s45, s45, 8192
    v_add_u32 v9, s45, v9
    v_and_b32 v10, 3, v0
    v_xor_b32 v10, v10, v7
    v_lshlrev_b32 v10, 3, v10
    v_lshrrev_b32_e64 v11, 2, v0
    v_lshl_add_u32 v10, v11, 5, v10
    v_add_u32 v10, 8192, v10
    v_lshrrev_b32 v11, 5, v0
    v_lshlrev_b32 v2, 5, v11
    v_and_b32_e64 v11, 1, v0
    v_lshl_add_u32 v2, v11, 4, v2
    v_bfe_u32 v11, v0, 1, 1
    v_lshl_add_u32 v5, v11, 6, v2
    v_bfe_u32 v11, v0, 2, 3
    v_lshl_add_u32 v5, v11, 15, v5
    v_bfe_u32 v11, v0, 1, 4
    v_lshl_add_u32 v2, v11, 15, v2
    s_and_b32 s46, s26, 1
    s_lshr_b32 s45, s26, 2
    s_lshl_b32 s45, s45, 1
    s_add_u32 s46, s46, s45
    s_and_b32 s45, s26, 2
    s_lshl_b32 s45, s45, 1
    s_add_u32 s46, s46, s45
    s_lshl_b32 s46, s46, 5
    s_add_u32 s46, s46, s27
    s_lshl_b32 s12, s3, 19
    s_add_u32 s12, s12, 0x0
    s_lshl_b32 s45, s3, 11
    s_lshr_b32 s49, s46, 6
    s_lshl_b32 s49, s49, 4
    s_and_b32 s57, s46, 15
    s_add_u32 s49, s49, s57
    s_bfe_u32 s57, s46, 0x10004
    s_lshl_b32 s57, s57, 7
    s_add_u32 s49, s49, s57
    s_sub_u32 s57, 256, s49
    s_bitcmp1_b32 s46, 5
    s_cselect_b32 s49, s57, s49
    s_cmp_eq_u32 s46, 0
    s_cselect_b32 s49, 256, s49
    s_cmp_eq_u32 s46, 32
    s_cselect_b32 s49, 64, s49
    s_cmp_eq_u32 s46, 48
    s_cselect_b32 s49, 192, s49
    s_sub_u32 s49, s49, 1
    s_lshl_b32 s49, s49, 13
    s_add_u32 s49, s49, s45
    s_add_u32 s49, s49, 0x800000
    s_lshl_b32 s57, s46, 7
    s_mov_b32 s58, s57
    s_cmp_eq_u32 s46, 0
    s_cselect_b32 s57, 4096, s57
    s_cselect_b32 s58, -32, s58
    s_cmp_eq_u32 s46, 16
    s_cselect_b32 s57, 2048, s57
    s_cselect_b32 s58, 6112, s58
    s_cmp_eq_u32 s46, 32
    s_cselect_b32 s57, 32, s57
    s_cselect_b32 s58, 2048, s58
    s_cmp_eq_u32 s46, 48
    s_cselect_b32 s57, 4128, s57
    s_cselect_b32 s58, 6144, s58
    v_mov_b32_e64 v6, s57
    v_mov_b32 v11, s58
    v_cmp_lt_u32 vcc, 31, v0
    s_nop 1
    v_cndmask_b32 v6, v6, v11, vcc
    v_add_u32 v5, v5, v6
    s_add_u32 s13, s12, 262144
    s_cmp_eq_u32 s46, 0
    s_cselect_b32 s58, 0, 1.0
    s_mov_b32 s59, s58
    v_mov_b32 v11, 0x4227c5ac
    s_lshr_b32 s57, s26, 2
    s_lshl_b32 s57, s57, 13
    s_add_u32 s57, s57, s45
    s_add_u32 s57, s57, 0x1084000
    s_and_b32 s47, s3, 1
    s_lshl_b32 s47, s47, 20
    s_lshr_b32 s45, s3, 1
    s_xor_b32 s45, s45, 1
    s_lshl_b32 s45, s45, 13
    s_add_u32 s47, s47, s45
    s_lshr_b32 s45, s46, 7
    s_lshl_b32 s45, s45, 14
    s_add_u32 s47, s47, s45
    s_and_b32 s45, s46, 127
    s_lshl_b32 s45, s45, 6
    s_add_u32 s47, s47, s45
    s_add_u32 s47, s47, 0x200000
    s_add_u32 s48, s47, 524288
    s_cmp_eq_u32 s3, 0
    s_cbranch_scc1 HOPEND_0
    s_mov_b64 exec, 0
    s_cmp_eq_u32 s3, 1
    s_cbranch_scc1 L_hop2
    s_cmp_eq_u32 s3, 2
    s_cbranch_scc1 L_hop1
    s_branch L_hop0
HOPRET_0:
    s_mov_b64 exec, -1
HOPEND_0:
    s_cmp_lg_u32 s3, 0
    s_cbranch_scc1 Lskip_7
    s_mov_b32 s60, 0
Lpoll_8:
    buffer_load_dword v13, v15, s[28:31], s62 offen offset:0 sc1
    s_waitcnt vmcnt(0)
    v_cmp_ne_u32 vcc, 8, v13
    s_add_u32 s60, s60, 1
    s_cbranch_vccz Lskip_7
    s_cmp_lt_u32 s60, s61
    s_cbranch_scc1 Lpoll_8
    s_mov_b32 s61, 1
Lskip_7:
    s_barrier
    buffer_load_dwordx4 v[184:187], v5, s[28:31], s12 offen sc1
    buffer_load_dwordx4 v[188:191], v5, s[28:31], s13 offen sc1
    buffer_load_dwordx4 v[112:115], v1, s[28:31], s57 offen sc1
    buffer_load_dwordx4 v[116:119], v1, s[28:31], s57 offen offset:1024 sc1
    s_mov_b64 exec, 0
    s_cmp_eq_u32 s3, 0
    s_cbranch_scc1 L_hop6
    s_cmp_eq_u32 s3, 1
    s_cbranch_scc1 L_hop5
    s_cmp_eq_u32 s3, 2
    s_cbranch_scc1 L_hop4
    s_branch L_hop3
HOPRET_1:
    s_mov_b64 exec, -1
HOPEND_1:
    s_waitcnt vmcnt(2)
    s_waitcnt vmcnt(0)
    s_nop 0
    buffer_load_dwordx4 v[192:195], v1, s[28:31], s49 offen sc1
    buffer_load_dwordx4 v[196:199], v1, s[28:31], s49 offen offset:1024 sc1
    v_fmamk_f32 v112, v112, 0x46000000, v11
    v_fmamk_f32 v113, v113, 0x46000000, v11
    v_fmamk_f32 v114, v114, 0x46000000, v11
    v_fmamk_f32 v115, v115, 0x46000000, v11
    v_fmamk_f32 v116, v116, 0x46000000, v11
    v_fmamk_f32 v117, v117, 0x46000000, v11
    v_fmamk_f32 v118, v118, 0x46000000, v11
    v_fmamk_f32 v119, v119, 0x46000000, v11
    v_rsq_f32 v112, v112
    v_rsq_f32 v113, v113
    v_rsq_f32 v114, v114
    v_rsq_f32 v115, v115
    v_rsq_f32 v116, v116
    v_rsq_f32 v117, v117
    v_rsq_f32 v118, v118
    v_rsq_f32 v119, v119
    v_pk_mul_f32 v[120:121], v[112:113], s[58:59]
    v_pk_mul_f32 v[122:123], v[114:115], s[58:59]
    v_pk_mul_f32 v[124:125], v[116:117], s[58:59]
    v_pk_mul_f32 v[126:127], v[118:119], s[58:59]
    s_waitcnt vmcnt(4)
    v_permlane32_swap_b32 v184, v188
    v_permlane32_swap_b32 v185, v189
    v_permlane32_swap_b32 v186, v190
    v_permlane32_swap_b32 v187, v191
    v_lshlrev_b32 v96, 16, v184
    v_and_b32 v97, 0xffff0000, v184
    v_lshlrev_b32_e64 v98, 16, v185
    v_and_b32 v99, 0xffff0000, v185
    v_pk_mul_f32 v[160:161], v[96:97], v[112:113]
    v_pk_mul_f32 v[162:163], v[98:99], v[114:115]
    v_cvt_pk_bf16_f32 v176, v160, v161
    v_cvt_pk_bf16_f32 v177, v162, v163
    ds_write_b64 v8, v[176:177] offset:0
    v_lshlrev_b32_e64 v100, 16, v186
    v_and_b32 v101, 0xffff0000, v186
    v_lshlrev_b32_e64 v102, 16, v187
    v_and_b32 v103, 0xffff0000, v187
    v_pk_mul_f32 v[164:165], v[100:101], v[116:117]
    v_pk_mul_f32 v[166:167], v[102:103], v[118:119]
    v_cvt_pk_bf16_f32 v178, v164, v165
    v_cvt_pk_bf16_f32 v179, v166, v167
    ds_write_b64 v8, v[178:179] offset:2048
    v_lshlrev_b32_e64 v104, 16, v188
    v_and_b32 v105, 0xffff0000, v188
    v_lshlrev_b32_e64 v106, 16, v189
    v_and_b32 v107, 0xffff0000, v189
    v_pk_mul_f32 v[168:169], v[104:105], v[120:121]
    v_pk_mul_f32 v[170:171], v[106:107], v[122:123]
    v_cvt_pk_bf16_f32 v180, v168, v169
    v_cvt_pk_bf16_f32 v181, v170, v171
    ds_write_b64 v8, v[180:181] offset:4096
    v_lshlrev_b32_e64 v108, 16, v190
    v_and_b32 v109, 0xffff0000, v190
    v_lshlrev_b32_e64 v110, 16, v191
    v_and_b32 v111, 0xffff0000, v191
    v_pk_mul_f32 v[172:173], v[108:109], v[124:125]
    v_pk_mul_f32 v[174:175], v[110:111], v[126:127]
    v_cvt_pk_bf16_f32 v182, v172, v173
    v_cvt_pk_bf16_f32 v183, v174, v175
    ds_write_b64 v8, v[182:183] offset:6144
    s_waitcnt lgkmcnt(0)
    s_barrier
    buffer_load_dwordx4 a[0:3], v1, s[28:31], s50 offen offset:0 sc1
    ds_read_b128 v[112:115], v1 offset:0
    ds_read_b128 v[116:119], v1 offset:4096
    ds_read_b128 v[120:123], v1 offset:1024
    ds_read_b128 v[124:127], v1 offset:5120
    ds_read_b128 v[128:131], v1 offset:2048
    ds_read_b128 v[132:135], v1 offset:6144
    ds_read_b128 v[136:139], v1 offset:3072
    buffer_load_dwordx4 a[4:7], v1, s[28:31], s50 offen offset:1024 sc1
    ds_read_b128 v[140:143], v1 offset:7168
    s_waitcnt lgkmcnt(6)
    v_mfma_f32_16x16x32_bf16 v[144:147], v[112:115], v[16:19], 0
    v_mfma_f32_16x16x32_bf16 v[152:155], v[116:119], v[16:19], 0
    v_mfma_f32_16x16x32_bf16 v[144:147], v[116:119], v[24:27], v[144:147]
    v_mfma_f32_16x16x32_bf16 v[152:155], v[112:115], v[32:35], v[152:155]
    s_waitcnt lgkmcnt(4)
    buffer_load_dwordx4 a[8:11], v1, s[28:31], s50 offen offset:2048 sc1
    v_mfma_f32_16x16x32_bf16 v[144:147], v[120:123], v[20:23], v[144:147]
    v_mfma_f32_16x16x32_bf16 v[152:155], v[124:127], v[20:23], v[152:155]
    v_mfma_f32_16x16x32_bf16 v[144:147], v[124:127], v[28:31], v[144:147]
    v_mfma_f32_16x16x32_bf16 v[152:155], v[120:123], v[36:39], v[152:155]
    s_waitcnt lgkmcnt(2)
    v_mfma_f32_16x16x32_bf16 v[148:151], v[128:131], v[16:19], 0
    v_mfma_f32_16x16x32_bf16 v[156:159], v[132:135], v[16:19], 0
    buffer_load_dwordx4 a[12:15], v1, s[28:31], s50 offen offset:3072 sc1
    v_mfma_f32_16x16x32_bf16 v[148:151], v[132:135], v[24:27], v[148:151]
    v_mfma_f32_16x16x32_bf16 v[156:159], v[128:131], v[32:35], v[156:159]
    s_waitcnt lgkmcnt(0)
    v_mfma_f32_16x16x32_bf16 v[148:151], v[136:139], v[20:23], v[148:151]
    v_mfma_f32_16x16x32_bf16 v[156:159], v[140:143], v[20:23], v[156:159]
    v_mfma_f32_16x16x32_bf16 v[148:151], v[140:143], v[28:31], v[148:151]
    v_mfma_f32_16x16x32_bf16 v[156:159], v[136:139], v[36:39], v[156:159]
    s_add_u32 s50, s50, 4096
    buffer_load_dwordx4 a[16:19], v1, s[28:31], s50 offen offset:0 sc1
    v_pk_mul_f32 v[160:161], v[144:145], v[64:65]
    v_pk_mul_f32 v[168:169], v[152:153], v[64:65]
    v_pk_fma_f32 v[160:161], v[152:153], v[72:73], v[160:161]
    v_pk_fma_f32 v[168:169], v[144:145], v[72:73], v[168:169] neg_lo:[0,1,0] neg_hi:[0,1,0]
    v_cvt_pk_bf16_f32 v176, v160, v161
    v_cvt_pk_bf16_f32 v180, v168, v169
    v_pk_mul_f32 v[162:163], v[146:147], v[66:67]
    buffer_load_dwordx4 a[20:23], v1, s[28:31], s50 offen offset:1024 sc1
    v_pk_mul_f32 v[170:171], v[154:155], v[66:67]
    v_pk_fma_f32 v[162:163], v[154:155], v[74:75], v[162:163]
    v_pk_fma_f32 v[170:171], v[146:147], v[74:75], v[170:171] neg_lo:[0,1,0] neg_hi:[0,1,0]
    v_cvt_pk_bf16_f32 v177, v162, v163
    v_cvt_pk_bf16_f32 v181, v170, v171
    v_pk_mul_f32 v[164:165], v[148:149], v[68:69]
    v_pk_mul_f32 v[172:173], v[156:157], v[68:69]
    buffer_load_dwordx4 a[24:27], v1, s[28:31], s50 offen offset:2048 sc1
    v_pk_fma_f32 v[164:165], v[156:157], v[76:77], v[164:165]
    v_pk_fma_f32 v[172:173], v[148:149], v[76:77], v[172:173] neg_lo:[0,1,0] neg_hi:[0,1,0]
    v_cvt_pk_bf16_f32 v178, v164, v165
    v_cvt_pk_bf16_f32 v182, v172, v173
    v_pk_mul_f32 v[166:167], v[150:151], v[70:71]
    v_pk_mul_f32 v[174:175], v[158:159], v[70:71]
    v_pk_fma_f32 v[166:167], v[158:159], v[78:79], v[166:167]
    buffer_load_dwordx4 a[28:31], v1, s[28:31], s50 offen offset:3072 sc1
    v_pk_fma_f32 v[174:175], v[150:151], v[78:79], v[174:175] neg_lo:[0,1,0] neg_hi:[0,1,0]
    v_cvt_pk_bf16_f32 v179, v166, v167
    v_cvt_pk_bf16_f32 v183, v174, v175
    s_nop 0
    v_mfma_f32_16x16x32_bf16 v[144:147], v[40:43], v[176:179], 0
    s_waitcnt vmcnt(8)
    v_lshlrev_b32_e64 v80, 16, v192
    v_and_b32 v88, 0xffff0000, v192
    buffer_load_dwordx4 a[32:35], v1, s[28:31], s51 offen offset:0 sc1
    v_mfma_f32_16x16x32_bf16 v[152:155], v[40:43], v[180:183], 0
    v_lshlrev_b32_e64 v81, 16, v193
    v_and_b32 v89, 0xffff0000, v193
    v_mfma_f32_16x16x32_bf16 v[144:147], v[48:51], v[180:183], v[144:147]
    v_lshlrev_b32_e64 v82, 16, v194
    v_and_b32 v90, 0xffff0000, v194
    v_mfma_f32_16x16x32_bf16 v[152:155], v[56:59], v[176:179], v[152:155]
    buffer_load_dwordx4 a[36:39], v1, s[28:31], s51 offen offset:1024 sc1
    v_lshlrev_b32_e64 v83, 16, v195
    v_and_b32 v91, 0xffff0000, v195
    v_mfma_f32_16x16x32_bf16 v[148:151], v[44:47], v[176:179], 0
    v_lshlrev_b32_e64 v84, 16, v196
    v_and_b32 v92, 0xffff0000, v196
    v_mfma_f32_16x16x32_bf16 v[156:159], v[44:47], v[180:183], 0
    v_lshlrev_b32_e64 v85, 16, v197
    buffer_load_dwordx4 a[40:43], v1, s[28:31], s51 offen offset:2048 sc1
    v_and_b32 v93, 0xffff0000, v197
    v_mfma_f32_16x16x32_bf16 v[148:151], v[52:55], v[180:183], v[148:151]
    v_lshlrev_b32_e64 v86, 16, v198
    v_and_b32 v94, 0xffff0000, v198
    v_mfma_f32_16x16x32_bf16 v[156:159], v[60:63], v[176:179], v[156:159]
    v_lshlrev_b32_e64 v87, 16, v199
    v_and_b32 v95, 0xffff0000, v199
    buffer_load_dwordx4 a[44:47], v1, s[28:31], s51 offen offset:3072 sc1
    v_pk_mul_f32 v[160:161], v[144:145], v[80:81]
    v_pk_mul_f32 v[168:169], v[152:153], v[80:81]
    v_pk_fma_f32 v[160:161], v[152:153], v[88:89], v[160:161] neg_lo:[0,1,0] neg_hi:[0,1,0]
    v_pk_fma_f32 v[168:169], v[144:145], v[88:89], v[168:169]
    v_cvt_pk_bf16_f32 v176, v160, v161
    v_cvt_pk_bf16_f32 v180, v168, v169
    v_pk_mul_f32 v[162:163], v[146:147], v[82:83]
    s_add_u32 s51, s51, 4096
    buffer_load_dwordx4 a[48:51], v1, s[28:31], s51 offen offset:0 sc1
    v_pk_mul_f32 v[170:171], v[154:155], v[82:83]
    v_pk_fma_f32 v[162:163], v[154:155], v[90:91], v[162:163] neg_lo:[0,1,0] neg_hi:[0,1,0]
    v_pk_fma_f32 v[170:171], v[146:147], v[90:91], v[170:171]
    v_cvt_pk_bf16_f32 v177, v162, v163
    v_cvt_pk_bf16_f32 v181, v170, v171
    v_pk_mul_f32 v[164:165], v[148:149], v[84:85]
    v_pk_mul_f32 v[172:173], v[156:157], v[84:85]
    buffer_load_dwordx4 a[52:55], v1, s[28:31], s51 offen offset:1024 sc1
    v_pk_fma_f32 v[164:165], v[156:157], v[92:93], v[164:165] neg_lo:[0,1,0] neg_hi:[0,1,0]
    v_pk_fma_f32 v[172:173], v[148:149], v[92:93], v[172:173]
    v_cvt_pk_bf16_f32 v178, v164, v165
    v_cvt_pk_bf16_f32 v182, v172, v173
    v_pk_mul_f32 v[166:167], v[150:151], v[86:87]
    v_pk_mul_f32 v[174:175], v[158:159], v[86:87]
    v_pk_fma_f32 v[166:167], v[158:159], v[94:95], v[166:167] neg_lo:[0,1,0] neg_hi:[0,1,0]
    buffer_load_dwordx4 a[56:59], v1, s[28:31], s51 offen offset:2048 sc1
    v_pk_fma_f32 v[174:175], v[150:151], v[94:95], v[174:175]
    v_cvt_pk_bf16_f32 v179, v166, v167
    v_cvt_pk_bf16_f32 v183, v174, v175
    s_nop 0
    v_mfma_f32_16x16x32_bf16 v[144:147], v[40:43], v[176:179], 0
    v_mfma_f32_16x16x32_bf16 v[152:155], v[40:43], v[180:183], 0
    v_mfma_f32_16x16x32_bf16 v[144:147], v[56:59], v[180:183], v[144:147]
    v_mfma_f32_16x16x32_bf16 v[152:155], v[48:51], v[176:179], v[152:155]
    buffer_load_dwordx4 a[60:63], v1, s[28:31], s51 offen offset:3072 sc1
    v_mfma_f32_16x16x32_bf16 v[148:151], v[44:47], v[176:179], 0
    v_mfma_f32_16x16x32_bf16 v[156:159], v[44:47], v[180:183], 0
    v_mfma_f32_16x16x32_bf16 v[148:151], v[60:63], v[180:183], v[148:151]
    v_mfma_f32_16x16x32_bf16 v[156:159], v[52:55], v[176:179], v[156:159]
    s_nop 1
    v_pk_mul_f32 v[160:161], v[144:145], v[64:65]
    v_pk_mul_f32 v[168:169], v[152:153], v[64:65]
    v_pk_fma_f32 v[160:161], v[152:153], v[72:73], v[160:161] neg_lo:[0,1,0] neg_hi:[0,1,0]
    buffer_load_dwordx4 a[64:67], v1, s[28:31], s52 offen offset:0 sc1
    v_pk_fma_f32 v[168:169], v[144:145], v[72:73], v[168:169]
    v_cvt_pk_bf16_f32 v176, v160, v161
    v_cvt_pk_bf16_f32 v180, v168, v169
    v_pk_mul_f32 v[162:163], v[146:147], v[66:67]
    v_pk_mul_f32 v[170:171], v[154:155], v[66:67]
    v_pk_fma_f32 v[162:163], v[154:155], v[74:75], v[162:163] neg_lo:[0,1,0] neg_hi:[0,1,0]
    v_pk_fma_f32 v[170:171], v[146:147], v[74:75], v[170:171]
    buffer_load_dwordx4 a[68:71], v1, s[28:31], s52 offen offset:1024 sc1
    v_cvt_pk_bf16_f32 v177, v162, v163
    v_cvt_pk_bf16_f32 v181, v170, v171
    v_pk_mul_f32 v[164:165], v[148:149], v[68:69]
    v_pk_mul_f32 v[172:173], v[156:157], v[68:69]
    v_pk_fma_f32 v[164:165], v[156:157], v[76:77], v[164:165] neg_lo:[0,1,0] neg_hi:[0,1,0]
    v_pk_fma_f32 v[172:173], v[148:149], v[76:77], v[172:173]
    v_cvt_pk_bf16_f32 v178, v164, v165
    buffer_load_dwordx4 a[72:75], v1, s[28:31], s52 offen offset:2048 sc1
    v_cvt_pk_bf16_f32 v182, v172, v173
    v_pk_mul_f32 v[166:167], v[150:151], v[70:71]
    v_pk_mul_f32 v[174:175], v[158:159], v[70:71]
    v_pk_fma_f32 v[166:167], v[158:159], v[78:79], v[166:167] neg_lo:[0,1,0] neg_hi:[0,1,0]
    v_pk_fma_f32 v[174:175], v[150:151], v[78:79], v[174:175]
    v_cvt_pk_bf16_f32 v179, v166, v167
    v_cvt_pk_bf16_f32 v183, v174, v175
    buffer_load_dwordx4 a[76:79], v1, s[28:31], s52 offen offset:3072 sc1
    ds_write_b64 v9, v[176:177] offset:0
    ds_write_b64 v9, v[178:179] offset:2048
    ds_write_b64 v9, v[180:181] offset:4096
    ds_write_b64 v9, v[182:183] offset:6144
    s_waitcnt lgkmcnt(0)
    s_barrier
    ds_read_b64_tr_b16 v[112:113], v10 offset:0
    s_add_u32 s52, s52, 4096
    buffer_load_dwordx4 a[80:83], v1, s[28:31], s52 offen offset:0 sc1
    ds_read_b64_tr_b16 v[114:115], v10 offset:512
    ds_read_b64_tr_b16 v[116:117], v10 offset:4096
    ds_read_b64_tr_b16 v[118:119], v10 offset:4608
L_hop0:
    s_cbranch_execz HOPRET_0
    s_nop 0
    ds_read_b64_tr_b16 v[120:121], v10 offset:1024
    ds_read_b64_tr_b16 v[122:123], v10 offset:1536
    ds_read_b64_tr_b16 v[124:125], v10 offset:5120
    ds_read_b64_tr_b16 v[126:127], v10 offset:5632
    buffer_load_dwordx4 a[84:87], v1, s[28:31], s52 offen offset:1024 sc1
    ds_read_b64_tr_b16 v[128:129], v10 offset:2048
    ds_read_b64_tr_b16 v[130:131], v10 offset:2560
    ds_read_b64_tr_b16 v[132:133], v10 offset:6144
    ds_read_b64_tr_b16 v[134:135], v10 offset:6656
    s_waitcnt lgkmcnt(8)
    s_nop 0
    v_mfma_f32_16x16x32_bf16 v[96:99], v[16:19], v[112:115], v[96:99]
    v_mfma_f32_16x16x32_bf16 v[104:107], v[16:19], v[116:119], v[104:107]
    ds_read_b64_tr_b16 v[136:137], v10 offset:3072
    ds_read_b64_tr_b16 v[138:139], v10 offset:3584
    ds_read_b64_tr_b16 v[140:141], v10 offset:7168
    ds_read_b64_tr_b16 v[142:143], v10 offset:7680
    v_mfma_f32_16x16x32_bf16 v[96:99], v[32:35], v[116:119], v[96:99]
    v_mfma_f32_16x16x32_bf16 v[104:107], v[24:27], v[112:115], v[104:107]
    s_waitcnt lgkmcnt(8)
    v_mfma_f32_16x16x32_bf16 v[96:99], v[20:23], v[120:123], v[96:99]
    v_mfma_f32_16x16x32_bf16 v[104:107], v[20:23], v[124:127], v[104:107]
    v_mfma_f32_16x16x32_bf16 v[96:99], v[36:39], v[124:127], v[96:99]
    v_mfma_f32_16x16x32_bf16 v[104:107], v[28:31], v[120:123], v[104:107]
    s_waitcnt lgkmcnt(4)
    v_mfma_f32_16x16x32_bf16 v[100:103], v[16:19], v[128:131], v[100:103]
    v_mfma_f32_16x16x32_bf16 v[108:111], v[16:19], v[132:135], v[108:111]
    v_mfma_f32_16x16x32_bf16 v[100:103], v[32:35], v[132:135], v[100:103]
    v_mfma_f32_16x16x32_bf16 v[108:111], v[24:27], v[128:131], v[108:111]
    s_waitcnt lgkmcnt(0)
    v_mfma_f32_16x16x32_bf16 v[100:103], v[20:23], v[136:139], v[100:103]
    v_mfma_f32_16x16x32_bf16 v[108:111], v[20:23], v[140:143], v[108:111]
    v_mfma_f32_16x16x32_bf16 v[100:103], v[36:39], v[140:143], v[100:103]
    v_mfma_f32_16x16x32_bf16 v[108:111], v[28:31], v[136:139], v[108:111]
    v_cvt_pk_bf16_f32 v176, v96, v97
    v_cvt_pk_bf16_f32 v177, v98, v99
    s_nop 4
    v_cvt_pk_bf16_f32 v178, v100, v101
    v_cvt_pk_bf16_f32 v179, v102, v103
    v_cvt_pk_bf16_f32 v180, v104, v105
    v_cvt_pk_bf16_f32 v181, v106, v107
    v_cvt_pk_bf16_f32 v182, v108, v109
    v_cvt_pk_bf16_f32 v183, v110, v111
    s_cmp_lg_u32 s46, 0
    s_cbranch_scc1 Lnodc_10
    v_mov_b32 v180, v188
    v_mov_b32 v181, v189
    v_mov_b32 v182, v190
    v_mov_b32 v183, v191
Lnodc_10:
    v_permlane32_swap_b32 v176, v180
    v_permlane32_swap_b32 v177, v181
    v_permlane32_swap_b32 v178, v182
    v_permlane32_swap_b32 v179, v183
    buffer_store_dwordx4 v[176:179], v2, s[28:31], s47 offen sc1
    buffer_store_dwordx4 v[180:183], v2, s[28:31], s48 offen sc1
    v_lshrrev_b32_e64 v4, 5, v0
    v_bfe_u32 v5, v0, 2, 2
    v_lshl_add_u32 v5, v4, 2, v5
    v_lshlrev_b32 v5, 5, v5
    v_and_b32 v6, 3, v0
    v_lshl_add_u32 v5, v6, 3, v5
    v_bfe_u32 v6, v0, 4, 1
    v_mul_u32_u24 v6, 16512, v6
    v_add_u32 v5, v5, v6
    s_add_u32 s45, s3, 0
    s_and_b32 s45, s45, 3
    s_lshl_b32 s45, s45, 12
    v_add_u32 v16, s45, v5
    s_add_u32 s45, s3, 1
    s_and_b32 s45, s45, 3
    s_lshl_b32 s45, s45, 12
    v_add_u32 v17, s45, v5
    s_add_u32 s45, s3, 2
    s_and_b32 s45, s45, 3
    s_lshl_b32 s45, s45, 12
    v_add_u32 v18, s45, v5
    s_add_u32 s45, s3, 3
    s_and_b32 s45, s45, 3
    s_lshl_b32 s45, s45, 12
    v_add_u32 v19, s45, v5
    v_and_b32 v20, 0x33, v0
    v_bfe_u32 v6, v0, 2, 1
    v_lshl_or_b32 v20, v6, 3, v20
    v_bfe_u32 v6, v0, 3, 1
    v_lshl_or_b32 v20, v6, 2, v20
    v_lshlrev_b32 v20, 4, v20
    s_cmp_eq_u32 s3, 0
    s_cselect_b32 s45, 0, 2
    v_cmp_eq_u32 vcc, s45, v4
    v_mov_b32 v6, 0xffff
    v_and_b32 v22, 31, v0
    v_cndmask_b32 v21, -1, v6, vcc
    v_lshlrev_b32 v22, 4, v22
    v_add_u32 v22, 132096, v22
    s_lshl_b32 s45, s3, 2
    v_add_u32 v23, s45, v22
    s_lshl_b32 s45, s3, 12
    s_add_u32 s45, s45, 134144
    v_add_u32_e64 v9, s45, v1
    ds_write_b128 v9, v[232:235]
    ds_write_b128 v9, v[236:239] offset:1024
    ds_write_b128 v9, v[192:195] offset:2048
    ds_write_b128 v9, v[196:199] offset:3072
    s_lshl_b32 s46, s3, 12
    s_and_b32 s47, s41, 7
    s_lshl_b32 s47, s47, 18
    s_lshr_b32 s45, s41, 3
    s_xor_b32 s45, s45, 1
    s_lshl_b32 s45, s45, 13
    s_add_u32 s47, s47, s45
    s_lshr_b32 s45, s3, 1
    s_lshl_b32 s45, s45, 14
    s_add_u32 s47, s47, s45
    s_and_b32 s45, s3, 1
    s_lshl_b32 s45, s45, 12
    s_add_u32 s47, s47, s45
    s_add_u32 s47, s47, 0x200000
    s_and_b32 s13, s41, 7
    s_lshl_b32 s13, s13, 20
    s_lshr_b32 s45, s13, 18
    s_xor_b32 s45, s45, s41
    s_and_b32 s45, s45, 8
    s_lshl_b32 s45, s45, 10
    s_add_u32 s13, s13, s45
    s_add_u32 s13, s13, 0x1400000
    s_lshr_b32 s48, s42, 2
    s_lshl_b32 s48, s48, 14
    s_lshl_b32 s45, s3, 11
    s_add_u32 s48, s48, s45
    s_add_u32 s48, s48, s13
    s_mov_b32 s58, 0x3eeff558
    s_mov_b32 s59, s58
    v_mov_b32 v6, 0x409d30fc
    v_mov_b32 v7, v6
    s_and_b32 s40, s63, 0xfffff000
    s_and_b32 s49, s41, 7
    s_lshl_b32 s49, s49, 9
    s_lshr_b32 s45, s41, 3
    s_lshl_b32 s45, s45, 13
    s_add_u32 s49, s49, s45
    s_add_u32 s49, s49, 0x1090000
    s_mul_i32 s45, s3, 7
    s_lshr_b32 s45, s45, 1
    v_min_u32 v10, 3, v0
    v_add_u32 v10, s45, v10
    v_lshlrev_b32 v10, 8, v10
    s_lshr_b32 s10, s43, 1
    s_and_b32 s11, s43, 1
    s_lshl_b32 s12, s10, 2
    s_add_u32 s12, s12, s11
    v_and_b32 v8, 31, v0
    v_lshrrev_b32_e64 v11, 5, v0
    v_lshlrev_b32 v3, 5, v8
    v_lshl_add_u32 v3, v11, 4, v3
    s_and_b32 s11, s3, 1
    s_lshl_b32 s8, s12, 1
    s_add_u32 s8, s8, s11
    s_lshl_b32 s9, s44, 1
    s_lshr_b32 s45, s3, 1
    s_add_u32 s9, s9, s45
    s_lshl_b32 s6, s12, 15
    s_lshl_b32 s45, s11, 6
    s_add_u32 s6, s6, s45
    s_lshl_b32 s45, s9, 11
    s_add_u32 s6, s6, s45
    s_add_u32 s6, s6, 0x400000
    s_add_u32 s7, s6, 65536
    s_and_b32 s25, s8, 63
    s_lshl_b32 s25, s25, 15
    s_lshr_b32 s45, s8, 6
    s_xor_b32 s45, s45, 1
    s_lshl_b32 s45, s45, 13
    s_add_u32 s25, s25, s45
    s_lshr_b32 s45, s9, 3
    s_lshl_b32 s45, s45, 14
    s_add_u32 s25, s25, s45
    s_and_b32 s45, s9, 7
    s_lshl_b32 s45, s45, 10
    s_add_u32 s25, s25, s45
    v_lshl_add_u32 v8, s9, 5, v8
    v_cmp_eq_u32 vcc, 1, v8
    s_nop 1
    v_cndmask_b32 v155, 1.0, 0, vcc
    v_lshlrev_b32_e64 v152, 2, v8
    s_mov_b32 s9, 0x1080000
    v_bfe_u32 v4, v0, 4, 1
    v_lshl_add_u32 v4, v11, 2, v4
    v_bfe_u32 v8, v0, 2, 1
    v_lshl_add_u32 v4, v8, 1, v4
    v_bfe_u32 v8, v0, 3, 1
    v_lshl_add_u32 v4, v8, 8, v4
    v_lshlrev_b32_e64 v4, 2, v4
    s_and_b32 s45, s8, 96
    s_add_u32 s8, s8, s45
    s_lshl_b32 s8, s8, 5
    s_add_u32 s8, s8, 0x1088000
    s_add_u32 s24, s8, 8192
    s_lshl_b32 s45, s11, 8
    v_xor_b32 v2, s45, v1
    s_and_b32 s4, s10, 7
    s_lshl_b32 s4, s4, 20
    s_lshr_b32 s45, s4, 18
    s_xor_b32 s45, s45, s10
    s_and_b32 s45, s45, 8
    s_lshl_b32 s45, s45, 10
    s_add_u32 s4, s4, s45
    s_add_u32 s4, s4, 0x1400000
    s_and_b32 s45, s43, 1
    s_lshl_b32 s45, s45, 18
    s_add_u32 s4, s4, s45
    s_mul_i32 s12, s3, 7
    s_lshr_b32 s12, s12, 1
    s_lshl_b32 s12, s12, 14
    s_and_b32 s45, s3, 1
    s_lshl_b32 s22, s45, 13
    s_lshl_b32 s45, s45, 12
    s_add_u32 s12, s12, s45
    s_add_u32 s4, s4, s12
    s_add_u32 s5, s4, 524288
    s_sub_u32 s23, 12288, s22
    s_add_u32 s22, s22, 4096
    s_mul_i32 s45, s3, 6144
    v_add_u32_e64 v5, s45, v1
    s_mov_b32 s10, 0x11111111
    s_mov_b32 s11, s10
    s_waitcnt vmcnt(0)
    s_barrier
    s_cmp_lg_u32 s3, 0
    s_cbranch_scc1 Larr_11
    v_mov_b32 v13, 1
    s_mov_b64 exec, 0xff
    buffer_atomic_add v13, v14, s[28:31], s62 offen offset:4 sc1
    s_mov_b64 exec, -1
Larr_11:
    s_barrier
    buffer_load_dwordx4 a[88:91], v1, s[28:31], s52 offen offset:2048 sc1
    buffer_load_dwordx4 a[92:95], v1, s[28:31], s52 offen offset:3072 sc1
    buffer_load_dwordx4 a[96:99], v1, s[28:31], s53 offen offset:0 sc1
    buffer_load_dwordx4 a[100:103], v1, s[28:31], s53 offen offset:1024 sc1
    buffer_load_dwordx4 a[104:107], v1, s[28:31], s53 offen offset:2048 sc1
    buffer_load_dwordx4 a[108:111], v1, s[28:31], s53 offen offset:3072 sc1
    s_add_u32 s53, s53, 4096
    buffer_load_dwordx4 a[112:115], v1, s[28:31], s53 offen offset:0 sc1
    buffer_load_dwordx4 a[116:119], v1, s[28:31], s53 offen offset:1024 sc1
    buffer_load_dwordx4 a[120:123], v1, s[28:31], s53 offen offset:2048 sc1
    buffer_load_dwordx4 a[124:127], v1, s[28:31], s53 offen offset:3072 sc1
    s_cmp_ge_u32 s100, 14
    s_cbranch_scc1 L_g1_spare0
    s_cmp_lg_u32 s3, 0
    s_cbranch_scc1 Lskip_12
    s_mov_b32 s60, 0
Lpoll_13:
    s_nop 0
    buffer_load_dword v13, v15, s[28:31], s62 offen offset:4 sc1
    s_waitcnt vmcnt(0)
    v_cmp_ne_u32 vcc, 8, v13
    s_add_u32 s60, s60, 1
    s_cbranch_vccz Lskip_12
    s_cmp_lt_u32 s60, s61
    s_cbranch_scc1 Lpoll_13
    s_mov_b32 s61, 1
Lskip_12:
    s_barrier
    s_add_u32 m0, s46, 0
    s_add_u32 s57, s47, 0
    buffer_load_dwordx4 v1, s[28:31], s57 offen offset:0 sc1 lds
    buffer_load_dwordx4 v1, s[28:31], s57 offen offset:1024 sc1 lds
    buffer_load_dwordx4 v1, s[28:31], s57 offen offset:2048 sc1 lds
    buffer_load_dwordx4 v1, s[28:31], s57 offen offset:3072 sc1 lds
    s_add_u32 m0, s46, 16512
    s_add_u32 s57, s47, 32768
    buffer_load_dwordx4 v1, s[28:31], s57 offen offset:0 sc1 lds
    buffer_load_dwordx4 v1, s[28:31], s57 offen offset:1024 sc1 lds
    buffer_load_dwordx4 v1, s[28:31], s57 offen offset:2048 sc1 lds
    buffer_load_dwordx4 v1, s[28:31], s57 offen offset:3072 sc1 lds
    s_add_u32 m0, s46, 33024
    s_add_u32 s57, s47, 65536
    buffer_load_dwordx4 v1, s[28:31], s57 offen offset:0 sc1 lds
    buffer_load_dwordx4 v1, s[28:31], s57 offen offset:1024 sc1 lds
    buffer_load_dwordx4 v1, s[28:31], s57 offen offset:2048 sc1 lds
    buffer_load_dwordx4 v1, s[28:31], s57 offen offset:3072 sc1 lds
    s_add_u32 m0, s46, 49536
    s_add_u32 s57, s47, 98304
    buffer_load_dwordx4 v1, s[28:31], s57 offen offset:0 sc1 lds
    buffer_load_dwordx4 v1, s[28:31], s57 offen offset:1024 sc1 lds
    buffer_load_dwordx4 v1, s[28:31], s57 offen offset:2048 sc1 lds
    buffer_load_dwordx4 v1, s[28:31], s57 offen offset:3072 sc1 lds
    s_waitcnt vmcnt(8)
    s_nop 0
    ds_read_b64_tr_b16 v[64:65], v16 offset:0
    ds_read_b64_tr_b16 v[66:67], v16 offset:256
    ds_read_b64_tr_b16 v[68:69], v16 offset:512
    ds_read_b64_tr_b16 v[70:71], v16 offset:768
    ds_read_b64_tr_b16 v[72:73], v16 offset:1024
    ds_read_b64_tr_b16 v[74:75], v16 offset:1280
    ds_read_b64_tr_b16 v[76:77], v16 offset:1536
    ds_read_b64_tr_b16 v[78:79], v16 offset:1792
    ds_read_b64_tr_b16 v[80:81], v16 offset:2048
    ds_read_b64_tr_b16 v[82:83], v16 offset:2304
    ds_read_b64_tr_b16 v[84:85], v16 offset:2560
    ds_read_b64_tr_b16 v[86:87], v16 offset:2816
    ds_read_b64_tr_b16 v[88:89], v16 offset:3072
    ds_read_b64_tr_b16 v[90:91], v16 offset:3328
    ds_read_b64_tr_b16 v[92:93], v16 offset:3584
    ds_read_b64_tr_b16 v[94:95], v16 offset:3840
    s_barrier
    s_waitcnt lgkmcnt(8)
    v_and_b32_e64 v8, v21, v64
    v_dot2_f32_bf16 v28, v8, v8, 0
    v_dot2_f32_bf16 v29, v65, v65, 0
    v_dot2_f32_bf16 v30, v66, v66, 0
    v_dot2_f32_bf16 v31, v67, v67, 0
    v_dot2_f32_bf16 v28, v68, v68, v28
    v_dot2_f32_bf16 v29, v69, v69, v29
    v_dot2_f32_bf16 v30, v70, v70, v30
    v_dot2_f32_bf16 v31, v71, v71, v31
    v_dot2_f32_bf16 v28, v72, v72, v28
    v_dot2_f32_bf16 v29, v73, v73, v29
    v_dot2_f32_bf16 v30, v74, v74, v30
    v_dot2_f32_bf16 v31, v75, v75, v31
    v_dot2_f32_bf16 v28, v76, v76, v28
    v_dot2_f32_bf16 v29, v77, v77, v29
    v_dot2_f32_bf16 v30, v78, v78, v30
    v_dot2_f32_bf16 v31, v79, v79, v31
    s_waitcnt lgkmcnt(0)
    s_nop 0
    v_dot2_f32_bf16 v28, v80, v80, v28
    v_dot2_f32_bf16 v29, v81, v81, v29
    v_dot2_f32_bf16 v30, v82, v82, v30
    v_dot2_f32_bf16 v31, v83, v83, v31
    v_dot2_f32_bf16 v28, v84, v84, v28
    v_dot2_f32_bf16 v29, v85, v85, v29
    v_dot2_f32_bf16 v30, v86, v86, v30
    v_dot2_f32_bf16 v31, v87, v87, v31
    v_dot2_f32_bf16 v28, v88, v88, v28
    v_dot2_f32_bf16 v29, v89, v89, v29
    v_dot2_f32_bf16 v30, v90, v90, v30
    v_dot2_f32_bf16 v31, v91, v91, v31
    v_dot2_f32_bf16 v28, v92, v92, v28
    v_dot2_f32_bf16 v29, v93, v93, v29
    v_dot2_f32_bf16 v30, v94, v94, v30
    v_dot2_f32_bf16 v31, v95, v95, v31
    v_mfma_f32_32x32x16_bf16 v[32:47], a[0:3], v[64:67], 0
    ds_read_b64_tr_b16 v[64:65], v17 offset:0
    ds_read_b64_tr_b16 v[66:67], v17 offset:256
    v_add_f32_e64 v28, v28, v29
    s_add_u32 m0, s46, 66048
    s_add_u32 s57, s47, 131072
    buffer_load_dwordx4 v1, s[28:31], s57 offen offset:0 sc1 lds
    v_mfma_f32_32x32x16_bf16 v[32:47], a[4:7], v[68:71], v[32:47]
    ds_read_b64_tr_b16 v[68:69], v17 offset:512
    ds_read_b64_tr_b16 v[70:71], v17 offset:768
    v_add_f32_e64 v30, v30, v31
    buffer_load_dwordx4 v1, s[28:31], s57 offen offset:1024 sc1 lds
    v_mfma_f32_32x32x16_bf16 v[32:47], a[8:11], v[72:75], v[32:47]
    ds_read_b64_tr_b16 v[72:73], v17 offset:1024
    ds_read_b64_tr_b16 v[74:75], v17 offset:1280
    v_add_f32 v28, v28, v30
    v_lshlrev_b32 v96, 16, v232
    v_and_b32 v97, 0xffff0000, v232
    v_mfma_f32_32x32x16_bf16 v[32:47], a[12:15], v[76:79], v[32:47]
    ds_read_b64_tr_b16 v[76:77], v17 offset:1536
    ds_read_b64_tr_b16 v[78:79], v17 offset:1792
    v_mov_b32_e64 v29, v28
    buffer_load_dwordx4 v1, s[28:31], s57 offen offset:2048 sc1 lds
    v_mul_f32_e64 v96, s58, v96
    v_mfma_f32_32x32x16_bf16 v[32:47], a[16:19], v[80:83], v[32:47]
    ds_read_b64_tr_b16 v[80:81], v17 offset:2048
    ds_read_b64_tr_b16 v[82:83], v17 offset:2304
    v_permlane32_swap_b32 v28, v29
    buffer_load_dwordx4 v1, s[28:31], s57 offen offset:3072 sc1 lds
    v_mul_f32 v97, s58, v97
    v_mfma_f32_32x32x16_bf16 v[32:47], a[20:23], v[84:87], v[32:47]
    ds_read_b64_tr_b16 v[84:85], v17 offset:2560
    ds_read_b64_tr_b16 v[86:87], v17 offset:2816
    v_add_f32 v28, v28, v29
    v_lshlrev_b32 v98, 16, v233
    v_and_b32 v99, 0xffff0000, v233
    v_mfma_f32_32x32x16_bf16 v[32:47], a[24:27], v[88:91], v[32:47]
    ds_read_b64_tr_b16 v[88:89], v17 offset:3072
    ds_read_b64_tr_b16 v[90:91], v17 offset:3328
    ds_write_b32 v23, v28 offset:0
    s_add_u32 m0, s46, 82560
    s_add_u32 s57, s47, 163840
    buffer_load_dwordx4 v1, s[28:31], s57 offen offset:0 sc1 lds
    v_mfma_f32_32x32x16_bf16 v[32:47], a[28:31], v[92:95], v[32:47]
    ds_read_b64_tr_b16 v[92:93], v17 offset:3584
    ds_read_b64_tr_b16 v[94:95], v17 offset:3840
    v_mul_f32 v98, s58, v98
    s_waitcnt lgkmcnt(9)
    v_mfma_f32_32x32x16_bf16 v[32:47], a[32:35], v[64:67], v[32:47]
    ds_read_b64_tr_b16 v[64:65], v18 offset:0
    ds_read_b64_tr_b16 v[66:67], v18 offset:256
    buffer_load_dwordx4 v1, s[28:31], s57 offen offset:1024 sc1 lds
    v_mul_f32 v99, s58, v99
    v_lshlrev_b32 v100, 16, v234
    v_mfma_f32_32x32x16_bf16 v[32:47], a[36:39], v[68:71], v[32:47]
    ds_read_b64_tr_b16 v[68:69], v18 offset:512
    ds_read_b64_tr_b16 v[70:71], v18 offset:768
    buffer_load_dwordx4 v1, s[28:31], s57 offen offset:2048 sc1 lds
    v_and_b32 v101, 0xffff0000, v234
    v_mul_f32_e64 v100, s58, v100
    v_mfma_f32_32x32x16_bf16 v[32:47], a[40:43], v[72:75], v[32:47]
    ds_read_b64_tr_b16 v[72:73], v18 offset:1024
    ds_read_b64_tr_b16 v[74:75], v18 offset:1280
    v_mul_f32 v101, s58, v101
    v_lshlrev_b32 v102, 16, v235
    v_and_b32 v103, 0xffff0000, v235
    v_mfma_f32_32x32x16_bf16 v[32:47], a[44:47], v[76:79], v[32:47]
    ds_read_b64_tr_b16 v[76:77], v18 offset:1536
    ds_read_b64_tr_b16 v[78:79], v18 offset:1792
    buffer_load_dwordx4 v1, s[28:31], s57 offen offset:3072 sc1 lds
    v_mul_f32 v102, s58, v102
    s_waitcnt lgkmcnt(8)
    v_mfma_f32_32x32x16_bf16 v[32:47], a[48:51], v[80:83], v[32:47]
    ds_read_b64_tr_b16 v[80:81], v18 offset:2048
    ds_read_b64_tr_b16 v[82:83], v18 offset:2304
    s_add_u32 m0, s46, 99072
    s_add_u32 s57, s47, 196608
    buffer_load_dwordx4 v1, s[28:31], s57 offen offset:0 sc1 lds
    v_mfma_f32_32x32x16_bf16 v[32:47], a[52:55], v[84:87], v[32:47]
    ds_read_b64_tr_b16 v[84:85], v18 offset:2560
    ds_read_b64_tr_b16 v[86:87], v18 offset:2816
    v_mul_f32 v103, s58, v103
    v_lshlrev_b32 v104, 16, v236
    v_and_b32 v105, 0xffff0000, v236
    v_mfma_f32_32x32x16_bf16 v[32:47], a[56:59], v[88:91], v[32:47]
    ds_read_b64_tr_b16 v[88:89], v18 offset:3072
    ds_read_b64_tr_b16 v[90:91], v18 offset:3328
    buffer_load_dwordx4 v1, s[28:31], s57 offen offset:1024 sc1 lds
    v_mul_f32_e64 v104, s58, v104
    v_mul_f32 v105, s58, v105
    v_mfma_f32_32x32x16_bf16 v[32:47], a[60:63], v[92:95], v[32:47]
    ds_read_b64_tr_b16 v[92:93], v18 offset:3584
    ds_read_b64_tr_b16 v[94:95], v18 offset:3840
    s_waitcnt lgkmcnt(8)
    s_waitcnt vmcnt(10)
    s_barrier
    v_mfma_f32_32x32x16_bf16 v[32:47], a[64:67], v[64:67], v[32:47]
    ds_read_b128 v[28:31], v22 offset:0
    ds_read_b64_tr_b16 v[64:65], v19 offset:0
    ds_read_b64_tr_b16 v[66:67], v19 offset:256
    buffer_load_dwordx4 v1, s[28:31], s57 offen offset:2048 sc1 lds
    v_mfma_f32_32x32x16_bf16 v[32:47], a[68:71], v[68:71], v[32:47]
    ds_read_b64_tr_b16 v[68:69], v19 offset:512
    ds_read_b64_tr_b16 v[70:71], v19 offset:768
    buffer_load_dwordx4 v1, s[28:31], s57 offen offset:3072 sc1 lds
    v_lshlrev_b32_e64 v106, 16, v237
    v_and_b32 v107, 0xffff0000, v237
    v_mfma_f32_32x32x16_bf16 v[32:47], a[72:75], v[72:75], v[32:47]
    ds_read_b64_tr_b16 v[72:73], v19 offset:1024
    ds_read_b64_tr_b16 v[74:75], v19 offset:1280
    v_mul_f32 v106, s58, v106
    v_mul_f32 v107, s58, v107
    v_lshlrev_b32_e64 v108, 16, v238
    v_mfma_f32_32x32x16_bf16 v[32:47], a[76:79], v[76:79], v[32:47]
    ds_read_b64_tr_b16 v[76:77], v19 offset:1536
    ds_read_b64_tr_b16 v[78:79], v19 offset:1792
    s_waitcnt lgkmcnt(8)
    s_add_u32 m0, s46, 115584
    s_add_u32 s57, s47, 229376
    buffer_load_dwordx4 v1, s[28:31], s57 offen offset:0 sc1 lds
    s_waitcnt lgkmcnt(9)
    v_mfma_f32_32x32x16_bf16 v[32:47], a[80:83], v[80:83], v[32:47]
    ds_read_b64_tr_b16 v[80:81], v19 offset:2048
    ds_read_b64_tr_b16 v[82:83], v19 offset:2304
    v_add_f32_e64 v28, v28, v29
    buffer_load_dwordx4 v1, s[28:31], s57 offen offset:1024 sc1 lds
    v_mfma_f32_32x32x16_bf16 v[32:47], a[84:87], v[84:87], v[32:47]
    ds_read_b64_tr_b16 v[84:85], v19 offset:2560
    ds_read_b64_tr_b16 v[86:87], v19 offset:2816
    v_add_f32_e64 v30, v30, v31
    v_and_b32 v109, 0xffff0000, v238
    v_mfma_f32_32x32x16_bf16 v[32:47], a[88:91], v[88:91], v[32:47]
    ds_read_b64_tr_b16 v[88:89], v19 offset:3072
    ds_read_b64_tr_b16 v[90:91], v19 offset:3328
    v_add_f32_e64 v28, v28, v30
    buffer_load_dwordx4 v1, s[28:31], s57 offen offset:2048 sc1 lds
    v_mul_f32_e64 v108, s58, v108
    v_mfma_f32_32x32x16_bf16 v[32:47], a[92:95], v[92:95], v[32:47]
    ds_read_b64_tr_b16 v[92:93], v19 offset:3584
    ds_read_b64_tr_b16 v[94:95], v19 offset:3840
    v_mul_f32 v28, 0x3b000000, v28
    v_mul_f32 v109, s58, v109
    s_waitcnt lgkmcnt(8)
    v_mfma_f32_32x32x16_bf16 v[32:47], a[96:99], v[64:67], v[32:47]
    ds_read_b64_tr_b16 v[64:65], v16 offset:33024
    ds_read_b64_tr_b16 v[66:67], v16 offset:33280
    v_add_f32 v29, 0x3727c5ac, v28
    buffer_load_dwordx4 v1, s[28:31], s57 offen offset:3072 sc1 lds
    v_lshlrev_b32_e64 v110, 16, v239
    v_mfma_f32_32x32x16_bf16 v[32:47], a[100:103], v[68:71], v[32:47]
    ds_read_b64_tr_b16 v[68:69], v16 offset:33536
    ds_read_b64_tr_b16 v[70:71], v16 offset:33792
    v_rsq_f32_e64 v29, v29
    s_add_u32 s45, s25, 0x200000
    buffer_load_dwordx4 v[144:147], v3, s[28:31], s45 offen sc1
    v_mfma_f32_32x32x16_bf16 v[32:47], a[104:107], v[72:75], v[32:47]
    ds_read_b64_tr_b16 v[72:73], v16 offset:34048
    ds_read_b64_tr_b16 v[74:75], v16 offset:34304
    v_mul_f32_e64 v28, v28, v29
    v_and_b32 v111, 0xffff0000, v239
    v_mfma_f32_32x32x16_bf16 v[32:47], a[108:111], v[76:79], v[32:47]
    ds_read_b64_tr_b16 v[76:77], v16 offset:34560
    ds_read_b64_tr_b16 v[78:79], v16 offset:34816
    v_fmaak_f32 v28, v28, v29, 0x3727c5ac
    s_add_u32 s45, s25, 0x220000
    buffer_load_dwordx4 v[148:151], v3, s[28:31], s45 offen sc1
    s_waitcnt lgkmcnt(8)
    v_mfma_f32_32x32x16_bf16 v[32:47], a[112:115], v[80:83], v[32:47]
    ds_read_b64_tr_b16 v[80:81], v16 offset:35072
    ds_read_b64_tr_b16 v[82:83], v16 offset:35328
    v_rsq_f32 v28, v28
    buffer_load_dword v152, v152, s[28:31], s9 offen sc1
    v_mfma_f32_32x32x16_bf16 v[32:47], a[116:119], v[84:87], v[32:47]
    ds_read_b64_tr_b16 v[84:85], v16 offset:35584
    ds_read_b64_tr_b16 v[86:87], v16 offset:35840
    v_mul_f32 v29, s58, v29
    v_mul_f32 v110, s58, v110
    v_mfma_f32_32x32x16_bf16 v[32:47], a[120:123], v[88:91], v[32:47]
    ds_read_b64_tr_b16 v[88:89], v16 offset:36096
    ds_read_b64_tr_b16 v[90:91], v16 offset:36352
    v_mul_f32_e64 v24, v28, v29
    s_sub_u32 s45, s8, 0x4000
    buffer_load_dword v153, v4, s[28:31], s45 offen offset:0 sc1
    buffer_load_dword v154, v4, s[28:31], s45 offen offset:128 sc1
    v_mfma_f32_32x32x16_bf16 v[32:47], a[124:127], v[92:95], v[32:47]
    ds_read_b64_tr_b16 v[92:93], v16 offset:36608
    ds_read_b64_tr_b16 v[94:95], v16 offset:36864
    v_add_u32 v16, 66048, v16
    v_mul_f32 v111, s58, v111
    s_waitcnt lgkmcnt(8)
    v_and_b32_e64 v8, v21, v64
    v_dot2_f32_bf16 v28, v8, v8, 0
    v_dot2_f32_bf16 v29, v65, v65, 0
    v_dot2_f32_bf16 v30, v66, v66, 0
    v_dot2_f32_bf16 v31, v67, v67, 0
    v_dot2_f32_bf16 v28, v68, v68, v28
    v_dot2_f32_bf16 v29, v69, v69, v29
    v_dot2_f32_bf16 v30, v70, v70, v30
    v_dot2_f32_bf16 v31, v71, v71, v31
    v_dot2_f32_bf16 v28, v72, v72, v28
    v_dot2_f32_bf16 v29, v73, v73, v29
    v_dot2_f32_bf16 v30, v74, v74, v30
    v_dot2_f32_bf16 v31, v75, v75, v31
    v_dot2_f32_bf16 v28, v76, v76, v28
    v_dot2_f32_bf16 v29, v77, v77, v29
    v_dot2_f32_bf16 v30, v78, v78, v30
    v_dot2_f32_bf16 v31, v79, v79, v31
    s_waitcnt lgkmcnt(0)
    s_nop 0
    v_dot2_f32_bf16 v28, v80, v80, v28
    v_dot2_f32_bf16 v29, v81, v81, v29
    v_dot2_f32_bf16 v30, v82, v82, v30
    v_dot2_f32_bf16 v31, v83, v83, v31
    v_dot2_f32_bf16 v28, v84, v84, v28
    v_dot2_f32_bf16 v29, v85, v85, v29
    v_dot2_f32_bf16 v30, v86, v86, v30
    v_dot2_f32_bf16 v31, v87, v87, v31
    v_dot2_f32_bf16 v28, v88, v88, v28
    v_dot2_f32_bf16 v29, v89, v89, v29
    v_dot2_f32_bf16 v30, v90, v90, v30
    v_dot2_f32_bf16 v31, v91, v91, v31
    v_dot2_f32_bf16 v28, v92, v92, v28
    v_dot2_f32_bf16 v29, v93, v93, v29
    v_dot2_f32_bf16 v30, v94, v94, v30
    v_dot2_f32_bf16 v31, v95, v95, v31
    v_pk_fma_f32 v[32:33], v[32:33], v[24:25], v[96:97] op_sel_hi:[1,0,1]
    v_pk_fma_f32 v[34:35], v[34:35], v[24:25], v[98:99] op_sel_hi:[1,0,1]
    v_pk_fma_f32 v[36:37], v[36:37], v[24:25], v[100:101] op_sel_hi:[1,0,1]
    v_pk_fma_f32 v[38:39], v[38:39], v[24:25], v[102:103] op_sel_hi:[1,0,1]
    v_pk_fma_f32 v[40:41], v[40:41], v[24:25], v[104:105] op_sel_hi:[1,0,1]
    v_pk_fma_f32 v[42:43], v[42:43], v[24:25], v[106:107] op_sel_hi:[1,0,1]
    v_pk_fma_f32 v[44:45], v[44:45], v[24:25], v[108:109] op_sel_hi:[1,0,1]
    v_pk_fma_f32 v[46:47], v[46:47], v[24:25], v[110:111] op_sel_hi:[1,0,1]
    v_pk_fma_f32 v[112:113], v[32:33], v[32:33], v[6:7]
    v_pk_fma_f32 v[114:115], v[34:35], v[34:35], v[6:7]
    v_pk_fma_f32 v[116:117], v[36:37], v[36:37], v[6:7]
    v_pk_fma_f32 v[118:119], v[38:39], v[38:39], v[6:7]
    v_pk_fma_f32 v[120:121], v[40:41], v[40:41], v[6:7]
    v_pk_fma_f32 v[122:123], v[42:43], v[42:43], v[6:7]
    v_pk_fma_f32 v[124:125], v[44:45], v[44:45], v[6:7]
    v_pk_fma_f32 v[126:127], v[46:47], v[46:47], v[6:7]
    v_pk_mul_f32 v[112:113], v[112:113], v[32:33] neg_lo:[1,0] neg_hi:[1,0]
    v_pk_mul_f32 v[114:115], v[114:115], v[34:35] neg_lo:[1,0] neg_hi:[1,0]
    v_pk_mul_f32 v[116:117], v[116:117], v[36:37] neg_lo:[1,0] neg_hi:[1,0]
    v_pk_mul_f32 v[118:119], v[118:119], v[38:39] neg_lo:[1,0] neg_hi:[1,0]
    v_pk_mul_f32 v[120:121], v[120:121], v[40:41] neg_lo:[1,0] neg_hi:[1,0]
    v_pk_mul_f32 v[122:123], v[122:123], v[42:43] neg_lo:[1,0] neg_hi:[1,0]
    v_pk_mul_f32 v[124:125], v[124:125], v[44:45] neg_lo:[1,0] neg_hi:[1,0]
    v_pk_mul_f32 v[126:127], v[126:127], v[46:47] neg_lo:[1,0] neg_hi:[1,0]
    v_mfma_f32_32x32x16_bf16 v[48:63], a[0:3], v[64:67], 0
    ds_read_b64_tr_b16 v[64:65], v17 offset:33024
    ds_read_b64_tr_b16 v[66:67], v17 offset:33280
    v_add_f32_e64 v28, v28, v29
    buffer_load_dwordx4 a[128:131], v12, s[28:31], s54 offen offset:0 sc1
    v_exp_f32 v112, v112
    s_nop 0
    v_fma_f32 v112, v112, s58, s58
    v_mfma_f32_32x32x16_bf16 v[48:63], a[4:7], v[68:71], v[48:63]
    ds_read_b64_tr_b16 v[68:69], v17 offset:33536
    ds_read_b64_tr_b16 v[70:71], v17 offset:33792
    v_add_f32_e64 v30, v30, v31
    buffer_load_dwordx4 a[132:135], v12, s[28:31], s55 offen offset:0 sc1
    v_exp_f32 v113, v113
    v_rcp_f32 v112, v112
    v_mfma_f32_32x32x16_bf16 v[48:63], a[8:11], v[72:75], v[48:63]
    ds_read_b64_tr_b16 v[72:73], v17 offset:34048
    ds_read_b64_tr_b16 v[74:75], v17 offset:34304
    v_add_f32_e64 v28, v28, v30
    v_fma_f32 v113, v113, s58, s58
    v_exp_f32_e64 v114, v114
    v_mfma_f32_32x32x16_bf16 v[48:63], a[12:15], v[76:79], v[48:63]
    ds_read_b64_tr_b16 v[76:77], v17 offset:34560
    ds_read_b64_tr_b16 v[78:79], v17 offset:34816
    v_mov_b32_e64 v29, v28
L_hop1:
    s_cbranch_execz HOPRET_0
    buffer_load_dwordx4 a[136:139], v12, s[28:31], s54 offen offset:1024 sc1
    v_mul_f32_e64 v112, v112, v32
    v_rcp_f32 v113, v113
    v_mfma_f32_32x32x16_bf16 v[48:63], a[16:19], v[80:83], v[48:63]
    ds_read_b64_tr_b16 v[80:81], v17 offset:35072
    ds_read_b64_tr_b16 v[82:83], v17 offset:35328
    v_permlane32_swap_b32 v28, v29
    v_fma_f32 v114, v114, s58, s58
    v_exp_f32 v115, v115
    v_mul_f32_e64 v113, v113, v33
    v_mfma_f32_32x32x16_bf16 v[48:63], a[20:23], v[84:87], v[48:63]
    ds_read_b64_tr_b16 v[84:85], v17 offset:35584
    ds_read_b64_tr_b16 v[86:87], v17 offset:35840
    v_add_f32_e64 v28, v28, v29
    buffer_load_dwordx4 a[140:143], v12, s[28:31], s55 offen offset:1024 sc1
    v_cvt_pk_bf16_f32 v128, v112, v113
    v_rcp_f32_e64 v114, v114
    v_mfma_f32_32x32x16_bf16 v[48:63], a[24:27], v[88:91], v[48:63]
    ds_read_b64_tr_b16 v[88:89], v17 offset:36096
    ds_read_b64_tr_b16 v[90:91], v17 offset:36352
    ds_write_b32 v23, v28 offset:512
    buffer_load_dwordx4 a[144:147], v12, s[28:31], s54 offen offset:2048 sc1
    v_fma_f32 v115, v115, s58, s58
    v_exp_f32_e64 v116, v116
    v_mfma_f32_32x32x16_bf16 v[48:63], a[28:31], v[92:95], v[48:63]
    ds_read_b64_tr_b16 v[92:93], v17 offset:36608
    ds_read_b64_tr_b16 v[94:95], v17 offset:36864
    v_add_u32 v17, 66048, v17
    v_mul_f32_e64 v114, v114, v34
    v_rcp_f32 v115, v115
    v_fma_f32 v116, v116, s58, s58
    s_waitcnt lgkmcnt(9)
    v_mfma_f32_32x32x16_bf16 v[48:63], a[32:35], v[64:67], v[48:63]
    ds_read_b64_tr_b16 v[64:65], v18 offset:33024
    ds_read_b64_tr_b16 v[66:67], v18 offset:33280
    buffer_load_dwordx4 a[148:151], v12, s[28:31], s55 offen offset:2048 sc1
    v_exp_f32 v117, v117
    v_mul_f32 v115, v115, v35
    v_cvt_pk_bf16_f32 v129, v114, v115
    v_mfma_f32_32x32x16_bf16 v[48:63], a[36:39], v[68:71], v[48:63]
    ds_read_b64_tr_b16 v[68:69], v18 offset:33536
    ds_read_b64_tr_b16 v[70:71], v18 offset:33792
    v_rcp_f32_e64 v116, v116
    v_fma_f32 v117, v117, s58, s58
    v_exp_f32_e64 v118, v118
    v_mfma_f32_32x32x16_bf16 v[48:63], a[40:43], v[72:75], v[48:63]
    ds_read_b64_tr_b16 v[72:73], v18 offset:34048
    ds_read_b64_tr_b16 v[74:75], v18 offset:34304
    buffer_load_dwordx4 a[152:155], v12, s[28:31], s54 offen offset:3072 sc1
    v_mul_f32 v116, v116, v36
    v_rcp_f32 v117, v117
    v_fma_f32 v118, v118, s58, s58
    v_mfma_f32_32x32x16_bf16 v[48:63], a[44:47], v[76:79], v[48:63]
    ds_read_b64_tr_b16 v[76:77], v18 offset:34560
    ds_read_b64_tr_b16 v[78:79], v18 offset:34816
    buffer_load_dwordx4 a[156:159], v12, s[28:31], s55 offen offset:3072 sc1
    v_exp_f32_e64 v119, v119
    v_mul_f32 v117, v117, v37
    s_waitcnt lgkmcnt(8)
    v_mfma_f32_32x32x16_bf16 v[48:63], a[48:51], v[80:83], v[48:63]
    ds_read_b64_tr_b16 v[80:81], v18 offset:35072
    ds_read_b64_tr_b16 v[82:83], v18 offset:35328
    v_cvt_pk_bf16_f32 v130, v116, v117
    v_rcp_f32_e64 v118, v118
    v_fma_f32 v119, v119, s58, s58
    v_mfma_f32_32x32x16_bf16 v[48:63], a[52:55], v[84:87], v[48:63]
    ds_read_b64_tr_b16 v[84:85], v18 offset:35584
    ds_read_b64_tr_b16 v[86:87], v18 offset:35840
    s_add_u32 s54, s54, 4096
    buffer_load_dwordx4 a[160:163], v12, s[28:31], s54 offen offset:0 sc1
    v_exp_f32 v120, v120
    v_mul_f32 v118, v118, v38
    v_mfma_f32_32x32x16_bf16 v[48:63], a[56:59], v[88:91], v[48:63]
    ds_read_b64_tr_b16 v[88:89], v18 offset:36096
    ds_read_b64_tr_b16 v[90:91], v18 offset:36352
    v_rcp_f32_e64 v119, v119
    v_fma_f32 v120, v120, s58, s58
    v_exp_f32 v121, v121
    v_mul_f32 v119, v119, v39
    v_mfma_f32_32x32x16_bf16 v[48:63], a[60:63], v[92:95], v[48:63]
    ds_read_b64_tr_b16 v[92:93], v18 offset:36608
    ds_read_b64_tr_b16 v[94:95], v18 offset:36864
    v_add_u32 v18, 66048, v18
    s_add_u32 s55, s55, 4096
    buffer_load_dwordx4 a[164:167], v12, s[28:31], s55 offen offset:0 sc1
    s_waitcnt lgkmcnt(8)
    s_waitcnt vmcnt(23)
    s_barrier
    s_nop 0
    v_mfma_f32_32x32x16_bf16 v[48:63], a[64:67], v[64:67], v[48:63]
    ds_read_b128 v[28:31], v22 offset:512
    ds_read_b64_tr_b16 v[64:65], v19 offset:33024
    ds_read_b64_tr_b16 v[66:67], v19 offset:33280
    buffer_load_dwordx4 a[168:171], v12, s[28:31], s54 offen offset:1024 sc1
    v_cvt_pk_bf16_f32 v131, v118, v119
    v_rcp_f32_e64 v120, v120
    v_mfma_f32_32x32x16_bf16 v[48:63], a[68:71], v[68:71], v[48:63]
    ds_read_b64_tr_b16 v[68:69], v19 offset:33536
    ds_read_b64_tr_b16 v[70:71], v19 offset:33792
    v_fma_f32 v121, v121, s58, s58
    buffer_store_dwordx4 v[128:131], v20, s[28:31], s48 offen offset:0 sc1
    v_exp_f32_e64 v122, v122
    v_mfma_f32_32x32x16_bf16 v[48:63], a[72:75], v[72:75], v[48:63]
    ds_read_b64_tr_b16 v[72:73], v19 offset:34048
    ds_read_b64_tr_b16 v[74:75], v19 offset:34304
    buffer_load_dwordx4 a[172:175], v12, s[28:31], s55 offen offset:1024 sc1
    v_mul_f32 v120, v120, v40
    v_rcp_f32 v121, v121
    v_fma_f32 v122, v122, s58, s58
    v_mfma_f32_32x32x16_bf16 v[48:63], a[76:79], v[76:79], v[48:63]
    ds_read_b64_tr_b16 v[76:77], v19 offset:34560
    ds_read_b64_tr_b16 v[78:79], v19 offset:34816
    s_waitcnt lgkmcnt(8)
    v_exp_f32 v123, v123
    v_mul_f32 v121, v121, v41
    s_waitcnt lgkmcnt(9)
    v_mfma_f32_32x32x16_bf16 v[48:63], a[80:83], v[80:83], v[48:63]
    ds_read_b64_tr_b16 v[80:81], v19 offset:35072
    ds_read_b64_tr_b16 v[82:83], v19 offset:35328
    v_add_f32_e64 v28, v28, v29
    buffer_load_dwordx4 a[176:179], v12, s[28:31], s54 offen offset:2048 sc1
    v_cvt_pk_bf16_f32 v132, v120, v121
    v_rcp_f32_e64 v122, v122
    v_mfma_f32_32x32x16_bf16 v[48:63], a[84:87], v[84:87], v[48:63]
    ds_read_b64_tr_b16 v[84:85], v19 offset:35584
    ds_read_b64_tr_b16 v[86:87], v19 offset:35840
    v_add_f32_e64 v30, v30, v31
    buffer_load_dwordx4 a[180:183], v12, s[28:31], s55 offen offset:2048 sc1
    v_fma_f32 v123, v123, s58, s58
    v_exp_f32_e64 v124, v124
    v_mfma_f32_32x32x16_bf16 v[48:63], a[88:91], v[88:91], v[48:63]
    ds_read_b64_tr_b16 v[88:89], v19 offset:36096
    ds_read_b64_tr_b16 v[90:91], v19 offset:36352
    v_add_f32 v28, v28, v30
    v_mul_f32 v122, v122, v42
    v_rcp_f32_e64 v123, v123
    v_fma_f32 v124, v124, s58, s58
    v_mfma_f32_32x32x16_bf16 v[48:63], a[92:95], v[92:95], v[48:63]
    ds_read_b64_tr_b16 v[92:93], v19 offset:36608
    ds_read_b64_tr_b16 v[94:95], v19 offset:36864
    v_add_u32 v19, 66048, v19
    v_mul_f32 v28, 0x3b000000, v28
    buffer_load_dwordx4 a[184:187], v12, s[28:31], s54 offen offset:3072 sc1
    v_exp_f32 v125, v125
    s_waitcnt lgkmcnt(8)
    v_mfma_f32_32x32x16_bf16 v[48:63], a[96:99], v[64:67], v[48:63]
    ds_read_b64_tr_b16 v[64:65], v16 offset:0
    ds_read_b64_tr_b16 v[66:67], v16 offset:256
    v_add_f32 v29, 0x3727c5ac, v28
    v_mul_f32_e64 v123, v123, v43
    v_cvt_pk_bf16_f32 v133, v122, v123
    v_rcp_f32_e64 v124, v124
    v_mfma_f32_32x32x16_bf16 v[48:63], a[100:103], v[68:71], v[48:63]
    ds_read_b64_tr_b16 v[68:69], v16 offset:512
    ds_read_b64_tr_b16 v[70:71], v16 offset:768
    v_rsq_f32_e64 v29, v29
    buffer_load_dwordx4 a[188:191], v12, s[28:31], s55 offen offset:3072 sc1
    v_fma_f32 v125, v125, s58, s58
    v_mfma_f32_32x32x16_bf16 v[48:63], a[104:107], v[72:75], v[48:63]
    ds_read_b64_tr_b16 v[72:73], v16 offset:1024
    ds_read_b64_tr_b16 v[74:75], v16 offset:1280
    v_mul_f32_e64 v28, v28, v29
    s_add_u32 s54, s54, 4096
    buffer_load_dwordx4 a[192:195], v12, s[28:31], s54 offen offset:0 sc1
    v_exp_f32 v126, v126
    v_mul_f32 v124, v124, v44
    v_mfma_f32_32x32x16_bf16 v[48:63], a[108:111], v[76:79], v[48:63]
    ds_read_b64_tr_b16 v[76:77], v16 offset:1536
    ds_read_b64_tr_b16 v[78:79], v16 offset:1792
    v_fmaak_f32 v28, v28, v29, 0x3727c5ac
    v_rcp_f32 v125, v125
    v_fma_f32 v126, v126, s58, s58
    s_waitcnt lgkmcnt(8)
    v_mfma_f32_32x32x16_bf16 v[48:63], a[112:115], v[80:83], v[48:63]
    ds_read_b64_tr_b16 v[80:81], v16 offset:2048
    ds_read_b64_tr_b16 v[82:83], v16 offset:2304
    v_rsq_f32_e64 v28, v28
    s_add_u32 s55, s55, 4096
    buffer_load_dwordx4 a[196:199], v12, s[28:31], s55 offen offset:0 sc1
    v_mfma_f32_32x32x16_bf16 v[48:63], a[116:119], v[84:87], v[48:63]
    ds_read_b64_tr_b16 v[84:85], v16 offset:2560
    ds_read_b64_tr_b16 v[86:87], v16 offset:2816
    v_mul_f32 v29, s58, v29
    v_exp_f32 v127, v127
    v_mul_f32_e64 v125, v125, v45
    v_cvt_pk_bf16_f32 v134, v124, v125
    v_mfma_f32_32x32x16_bf16 v[48:63], a[120:123], v[88:91], v[48:63]
    ds_read_b64_tr_b16 v[88:89], v16 offset:3072
    ds_read_b64_tr_b16 v[90:91], v16 offset:3328
    v_mul_f32_e64 v26, v28, v29
    buffer_load_dwordx4 a[200:203], v12, s[28:31], s54 offen offset:1024 sc1
    v_rcp_f32_e64 v126, v126
    v_fma_f32 v127, v127, s58, s58
    v_mul_f32_e64 v126, v126, v46
    v_mfma_f32_32x32x16_bf16 v[48:63], a[124:127], v[92:95], v[48:63]
    ds_read_b64_tr_b16 v[92:93], v16 offset:3584
    ds_read_b64_tr_b16 v[94:95], v16 offset:3840
    v_rcp_f32 v127, v127
    s_nop 0
    v_mul_f32_e64 v127, v127, v47
    v_cvt_pk_bf16_f32 v135, v126, v127
    buffer_store_dwordx4 v[132:135], v20, s[28:31], s48 offen offset:1024 sc1
    s_waitcnt lgkmcnt(8)
    v_and_b32 v8, v21, v64
    v_dot2_f32_bf16 v28, v8, v8, 0
    v_dot2_f32_bf16 v29, v65, v65, 0
    v_dot2_f32_bf16 v30, v66, v66, 0
    v_dot2_f32_bf16 v31, v67, v67, 0
    v_dot2_f32_bf16 v28, v68, v68, v28
    v_dot2_f32_bf16 v29, v69, v69, v29
    v_dot2_f32_bf16 v30, v70, v70, v30
    v_dot2_f32_bf16 v31, v71, v71, v31
    v_dot2_f32_bf16 v28, v72, v72, v28
    v_dot2_f32_bf16 v29, v73, v73, v29
    v_dot2_f32_bf16 v30, v74, v74, v30
    v_dot2_f32_bf16 v31, v75, v75, v31
    v_dot2_f32_bf16 v28, v76, v76, v28
    v_dot2_f32_bf16 v29, v77, v77, v29
    v_dot2_f32_bf16 v30, v78, v78, v30
    v_dot2_f32_bf16 v31, v79, v79, v31
    s_waitcnt lgkmcnt(0)
    s_nop 0
    v_dot2_f32_bf16 v28, v80, v80, v28
    v_dot2_f32_bf16 v29, v81, v81, v29
    v_dot2_f32_bf16 v30, v82, v82, v30
    v_dot2_f32_bf16 v31, v83, v83, v31
    v_dot2_f32_bf16 v28, v84, v84, v28
    v_dot2_f32_bf16 v29, v85, v85, v29
    v_dot2_f32_bf16 v30, v86, v86, v30
    v_dot2_f32_bf16 v31, v87, v87, v31
    v_dot2_f32_bf16 v28, v88, v88, v28
    v_dot2_f32_bf16 v29, v89, v89, v29
    v_dot2_f32_bf16 v30, v90, v90, v30
    v_dot2_f32_bf16 v31, v91, v91, v31
    v_dot2_f32_bf16 v28, v92, v92, v28
    v_dot2_f32_bf16 v29, v93, v93, v29
    v_dot2_f32_bf16 v30, v94, v94, v30
    v_dot2_f32_bf16 v31, v95, v95, v31
    v_pk_fma_f32 v[48:49], v[48:49], v[26:27], v[96:97] op_sel_hi:[1,0,1]
    v_pk_fma_f32 v[50:51], v[50:51], v[26:27], v[98:99] op_sel_hi:[1,0,1]
    v_pk_fma_f32 v[52:53], v[52:53], v[26:27], v[100:101] op_sel_hi:[1,0,1]
    v_pk_fma_f32 v[54:55], v[54:55], v[26:27], v[102:103] op_sel_hi:[1,0,1]
    v_pk_fma_f32 v[56:57], v[56:57], v[26:27], v[104:105] op_sel_hi:[1,0,1]
    v_pk_fma_f32 v[58:59], v[58:59], v[26:27], v[106:107] op_sel_hi:[1,0,1]
    v_pk_fma_f32 v[60:61], v[60:61], v[26:27], v[108:109] op_sel_hi:[1,0,1]
    v_pk_fma_f32 v[62:63], v[62:63], v[26:27], v[110:111] op_sel_hi:[1,0,1]
    v_pk_fma_f32 v[112:113], v[48:49], v[48:49], v[6:7]
    v_pk_fma_f32 v[114:115], v[50:51], v[50:51], v[6:7]
    v_pk_fma_f32 v[116:117], v[52:53], v[52:53], v[6:7]
    v_pk_fma_f32 v[118:119], v[54:55], v[54:55], v[6:7]
    v_pk_fma_f32 v[120:121], v[56:57], v[56:57], v[6:7]
    v_pk_fma_f32 v[122:123], v[58:59], v[58:59], v[6:7]
    v_pk_fma_f32 v[124:125], v[60:61], v[60:61], v[6:7]
    v_pk_fma_f32 v[126:127], v[62:63], v[62:63], v[6:7]
    v_pk_mul_f32 v[112:113], v[112:113], v[48:49] neg_lo:[1,0] neg_hi:[1,0]
    v_pk_mul_f32 v[114:115], v[114:115], v[50:51] neg_lo:[1,0] neg_hi:[1,0]
    v_pk_mul_f32 v[116:117], v[116:117], v[52:53] neg_lo:[1,0] neg_hi:[1,0]
    v_pk_mul_f32 v[118:119], v[118:119], v[54:55] neg_lo:[1,0] neg_hi:[1,0]
    v_pk_mul_f32 v[120:121], v[120:121], v[56:57] neg_lo:[1,0] neg_hi:[1,0]
    v_pk_mul_f32 v[122:123], v[122:123], v[58:59] neg_lo:[1,0] neg_hi:[1,0]
    v_pk_mul_f32 v[124:125], v[124:125], v[60:61] neg_lo:[1,0] neg_hi:[1,0]
    v_pk_mul_f32 v[126:127], v[126:127], v[62:63] neg_lo:[1,0] neg_hi:[1,0]
    v_mfma_f32_32x32x16_bf16 v[32:47], a[0:3], v[64:67], 0
    ds_read_b64_tr_b16 v[64:65], v17 offset:0
    ds_read_b64_tr_b16 v[66:67], v17 offset:256
    v_add_f32_e64 v28, v28, v29
    buffer_load_dwordx4 a[204:207], v12, s[28:31], s55 offen offset:1024 sc1
    v_exp_f32 v112, v112
    s_nop 0
    v_fma_f32 v112, v112, s58, s58
    v_mfma_f32_32x32x16_bf16 v[32:47], a[4:7], v[68:71], v[32:47]
    ds_read_b64_tr_b16 v[68:69], v17 offset:512
    ds_read_b64_tr_b16 v[70:71], v17 offset:768
    v_add_f32_e64 v30, v30, v31
    buffer_load_dwordx4 a[208:211], v12, s[28:31], s54 offen offset:2048 sc1
    v_exp_f32 v113, v113
    v_rcp_f32 v112, v112
    v_mfma_f32_32x32x16_bf16 v[32:47], a[8:11], v[72:75], v[32:47]
    ds_read_b64_tr_b16 v[72:73], v17 offset:1024
    ds_read_b64_tr_b16 v[74:75], v17 offset:1280
    v_add_f32_e64 v28, v28, v30
    v_fma_f32 v113, v113, s58, s58
    v_exp_f32_e64 v114, v114
    v_mfma_f32_32x32x16_bf16 v[32:47], a[12:15], v[76:79], v[32:47]
    ds_read_b64_tr_b16 v[76:77], v17 offset:1536
    ds_read_b64_tr_b16 v[78:79], v17 offset:1792
    v_mov_b32_e64 v29, v28
    buffer_load_dwordx4 a[212:215], v12, s[28:31], s55 offen offset:2048 sc1
    v_mul_f32 v112, v112, v48
    v_rcp_f32 v113, v113
    v_mfma_f32_32x32x16_bf16 v[32:47], a[16:19], v[80:83], v[32:47]
    ds_read_b64_tr_b16 v[80:81], v17 offset:2048
    ds_read_b64_tr_b16 v[82:83], v17 offset:2304
    v_permlane32_swap_b32 v28, v29
    v_fma_f32 v114, v114, s58, s58
    v_exp_f32 v115, v115
    v_mul_f32_e64 v113, v113, v49
    v_mfma_f32_32x32x16_bf16 v[32:47], a[20:23], v[84:87], v[32:47]
    ds_read_b64_tr_b16 v[84:85], v17 offset:2560
    ds_read_b64_tr_b16 v[86:87], v17 offset:2816
    v_add_f32_e64 v28, v28, v29
    buffer_load_dwordx4 a[216:219], v12, s[28:31], s54 offen offset:3072 sc1
    v_cvt_pk_bf16_f32 v128, v112, v113
    v_rcp_f32_e64 v114, v114
    v_mfma_f32_32x32x16_bf16 v[32:47], a[24:27], v[88:91], v[32:47]
    ds_read_b64_tr_b16 v[88:89], v17 offset:3072
    ds_read_b64_tr_b16 v[90:91], v17 offset:3328
    ds_write_b32 v23, v28 offset:1024
    buffer_load_dwordx4 a[220:223], v12, s[28:31], s55 offen offset:3072 sc1
    v_fma_f32 v115, v115, s58, s58
    v_exp_f32_e64 v116, v116
    v_mfma_f32_32x32x16_bf16 v[32:47], a[28:31], v[92:95], v[32:47]
    ds_read_b64_tr_b16 v[92:93], v17 offset:3584
    ds_read_b64_tr_b16 v[94:95], v17 offset:3840
    v_mul_f32_e64 v114, v114, v50
    v_rcp_f32 v115, v115
    v_fma_f32 v116, v116, s58, s58
    s_waitcnt lgkmcnt(9)
    v_mfma_f32_32x32x16_bf16 v[32:47], a[32:35], v[64:67], v[32:47]
    ds_read_b64_tr_b16 v[64:65], v18 offset:0
    ds_read_b64_tr_b16 v[66:67], v18 offset:256
    s_add_u32 s54, s54, 4096
    buffer_load_dwordx4 a[224:227], v12, s[28:31], s54 offen offset:0 sc1
    v_exp_f32 v117, v117
    v_mul_f32 v115, v115, v51
    v_mfma_f32_32x32x16_bf16 v[32:47], a[36:39], v[68:71], v[32:47]
    ds_read_b64_tr_b16 v[68:69], v18 offset:512
    ds_read_b64_tr_b16 v[70:71], v18 offset:768
    v_cvt_pk_bf16_f32 v129, v114, v115
    v_rcp_f32_e64 v116, v116
    v_fma_f32 v117, v117, s58, s58
    v_exp_f32_e64 v118, v118
    v_mfma_f32_32x32x16_bf16 v[32:47], a[40:43], v[72:75], v[32:47]
    ds_read_b64_tr_b16 v[72:73], v18 offset:1024
    ds_read_b64_tr_b16 v[74:75], v18 offset:1280
    s_add_u32 s55, s55, 4096
    buffer_load_dwordx4 a[228:231], v12, s[28:31], s55 offen offset:0 sc1
    v_mul_f32 v116, v116, v52
    v_rcp_f32 v117, v117
    v_mfma_f32_32x32x16_bf16 v[32:47], a[44:47], v[76:79], v[32:47]
    ds_read_b64_tr_b16 v[76:77], v18 offset:1536
    ds_read_b64_tr_b16 v[78:79], v18 offset:1792
    buffer_load_dwordx4 a[232:235], v12, s[28:31], s54 offen offset:1024 sc1
    v_fma_f32 v118, v118, s58, s58
    v_exp_f32 v119, v119
    s_waitcnt lgkmcnt(8)
    v_mfma_f32_32x32x16_bf16 v[32:47], a[48:51], v[80:83], v[32:47]
    ds_read_b64_tr_b16 v[80:81], v18 offset:2048
    ds_read_b64_tr_b16 v[82:83], v18 offset:2304
    v_mul_f32_e64 v117, v117, v53
    v_cvt_pk_bf16_f32 v130, v116, v117
    v_rcp_f32_e64 v118, v118
    v_mfma_f32_32x32x16_bf16 v[32:47], a[52:55], v[84:87], v[32:47]
    ds_read_b64_tr_b16 v[84:85], v18 offset:2560
    ds_read_b64_tr_b16 v[86:87], v18 offset:2816
    buffer_load_dwordx4 a[236:239], v12, s[28:31], s55 offen offset:1024 sc1
    v_fma_f32 v119, v119, s58, s58
    v_exp_f32 v120, v120
    v_mul_f32 v118, v118, v54
    v_mfma_f32_32x32x16_bf16 v[32:47], a[56:59], v[88:91], v[32:47]
    ds_read_b64_tr_b16 v[88:89], v18 offset:3072
    ds_read_b64_tr_b16 v[90:91], v18 offset:3328
    v_rcp_f32_e64 v119, v119
    v_fma_f32 v120, v120, s58, s58
    v_exp_f32_e64 v121, v121
    v_mfma_f32_32x32x16_bf16 v[32:47], a[60:63], v[92:95], v[32:47]
    ds_read_b64_tr_b16 v[92:93], v18 offset:3584
    ds_read_b64_tr_b16 v[94:95], v18 offset:3840
    buffer_load_dwordx4 a[240:243], v12, s[28:31], s54 offen offset:2048 sc1
    v_mul_f32 v119, v119, v55
    s_waitcnt lgkmcnt(8)
    s_waitcnt vmcnt(36)
    s_barrier
    v_mfma_f32_32x32x16_bf16 v[32:47], a[64:67], v[64:67], v[32:47]
    ds_read_b128 v[28:31], v22 offset:1024
    ds_read_b64_tr_b16 v[64:65], v19 offset:0
    ds_read_b64_tr_b16 v[66:67], v19 offset:256
    buffer_load_dwordx4 a[244:247], v12, s[28:31], s55 offen offset:2048 sc1
    v_cvt_pk_bf16_f32 v131, v118, v119
    v_rcp_f32_e64 v120, v120
    v_mfma_f32_32x32x16_bf16 v[32:47], a[68:71], v[68:71], v[32:47]
    ds_read_b64_tr_b16 v[68:69], v19 offset:512
    ds_read_b64_tr_b16 v[70:71], v19 offset:768
    v_fma_f32 v121, v121, s58, s58
    s_add_u32 s48, s48, 262144
    buffer_store_dwordx4 v[128:131], v20, s[28:31], s48 offen offset:0 sc1
    v_exp_f32_e64 v122, v122
    v_mfma_f32_32x32x16_bf16 v[32:47], a[72:75], v[72:75], v[32:47]
    ds_read_b64_tr_b16 v[72:73], v19 offset:1024
    ds_read_b64_tr_b16 v[74:75], v19 offset:1280
    buffer_load_dwordx4 a[248:251], v12, s[28:31], s54 offen offset:3072 sc1
    v_mul_f32 v120, v120, v56
    v_rcp_f32 v121, v121
    v_fma_f32 v122, v122, s58, s58
    v_mfma_f32_32x32x16_bf16 v[32:47], a[76:79], v[76:79], v[32:47]
    ds_read_b64_tr_b16 v[76:77], v19 offset:1536
    ds_read_b64_tr_b16 v[78:79], v19 offset:1792
    s_waitcnt lgkmcnt(8)
    v_exp_f32 v123, v123
    v_mul_f32 v121, v121, v57
    s_waitcnt lgkmcnt(9)
    v_mfma_f32_32x32x16_bf16 v[32:47], a[80:83], v[80:83], v[32:47]
    ds_read_b64_tr_b16 v[80:81], v19 offset:2048
    ds_read_b64_tr_b16 v[82:83], v19 offset:2304
    v_add_f32_e64 v28, v28, v29
    buffer_load_dwordx4 a[252:255], v12, s[28:31], s55 offen offset:3072 sc1
    v_cvt_pk_bf16_f32 v132, v120, v121
    v_rcp_f32_e64 v122, v122
    v_mfma_f32_32x32x16_bf16 v[32:47], a[84:87], v[84:87], v[32:47]
    ds_read_b64_tr_b16 v[84:85], v19 offset:2560
    ds_read_b64_tr_b16 v[86:87], v19 offset:2816
    v_add_f32_e64 v30, v30, v31
    s_add_u32 s54, s54, 4096
    buffer_load_dwordx4 v[160:163], v12, s[28:31], s54 offen offset:0 sc1
    v_fma_f32 v123, v123, s58, s58
    v_exp_f32_e64 v124, v124
    v_mfma_f32_32x32x16_bf16 v[32:47], a[88:91], v[88:91], v[32:47]
    ds_read_b64_tr_b16 v[88:89], v19 offset:3072
    ds_read_b64_tr_b16 v[90:91], v19 offset:3328
    v_add_f32 v28, v28, v30
    v_mul_f32 v122, v122, v58
    v_rcp_f32_e64 v123, v123
    v_mfma_f32_32x32x16_bf16 v[32:47], a[92:95], v[92:95], v[32:47]
    ds_read_b64_tr_b16 v[92:93], v19 offset:3584
    ds_read_b64_tr_b16 v[94:95], v19 offset:3840
    v_mul_f32 v28, 0x3b000000, v28
    s_add_u32 s55, s55, 4096
    buffer_load_dwordx4 v[164:167], v12, s[28:31], s55 offen offset:0 sc1
    v_fma_f32 v124, v124, s58, s58
    s_waitcnt lgkmcnt(8)
    v_mfma_f32_32x32x16_bf16 v[32:47], a[96:99], v[64:67], v[32:47]
    ds_read_b64_tr_b16 v[64:65], v16 offset:33024
    ds_read_b64_tr_b16 v[66:67], v16 offset:33280
    v_add_f32 v29, 0x3727c5ac, v28
    v_exp_f32 v125, v125
    v_mul_f32_e64 v123, v123, v59
    v_cvt_pk_bf16_f32 v133, v122, v123
    v_mfma_f32_32x32x16_bf16 v[32:47], a[100:103], v[68:71], v[32:47]
    ds_read_b64_tr_b16 v[68:69], v16 offset:33536
    ds_read_b64_tr_b16 v[70:71], v16 offset:33792
    v_rsq_f32_e64 v29, v29
    buffer_load_dwordx4 v[168:171], v12, s[28:31], s54 offen offset:1024 sc1
    v_rcp_f32_e64 v124, v124
    v_mfma_f32_32x32x16_bf16 v[32:47], a[104:107], v[72:75], v[32:47]
    ds_read_b64_tr_b16 v[72:73], v16 offset:34048
    ds_read_b64_tr_b16 v[74:75], v16 offset:34304
    v_mul_f32_e64 v28, v28, v29
    buffer_load_dwordx4 v[172:175], v12, s[28:31], s55 offen offset:1024 sc1
    v_fma_f32 v125, v125, s58, s58
    v_exp_f32_e64 v126, v126
    v_mfma_f32_32x32x16_bf16 v[32:47], a[108:111], v[76:79], v[32:47]
    ds_read_b64_tr_b16 v[76:77], v16 offset:34560
    ds_read_b64_tr_b16 v[78:79], v16 offset:34816
    v_fmaak_f32 v28, v28, v29, 0x3727c5ac
    v_mul_f32_e64 v124, v124, v60
    v_rcp_f32 v125, v125
    s_waitcnt lgkmcnt(8)
    v_mfma_f32_32x32x16_bf16 v[32:47], a[112:115], v[80:83], v[32:47]
    ds_read_b64_tr_b16 v[80:81], v16 offset:35072
    ds_read_b64_tr_b16 v[82:83], v16 offset:35328
    v_rsq_f32_e64 v28, v28
    buffer_load_dwordx4 v[176:179], v12, s[28:31], s54 offen offset:2048 sc1
    v_fma_f32 v126, v126, s58, s58
    v_exp_f32_e64 v127, v127
    v_mfma_f32_32x32x16_bf16 v[32:47], a[116:119], v[84:87], v[32:47]
    ds_read_b64_tr_b16 v[84:85], v16 offset:35584
    ds_read_b64_tr_b16 v[86:87], v16 offset:35840
    v_mul_f32 v29, s58, v29
    v_mul_f32 v125, v125, v61
    v_cvt_pk_bf16_f32 v134, v124, v125
    v_rcp_f32_e64 v126, v126
    v_mfma_f32_32x32x16_bf16 v[32:47], a[120:123], v[88:91], v[32:47]
    ds_read_b64_tr_b16 v[88:89], v16 offset:36096
    ds_read_b64_tr_b16 v[90:91], v16 offset:36352
    v_mul_f32_e64 v24, v28, v29
    buffer_load_dwordx4 v[180:183], v12, s[28:31], s55 offen offset:2048 sc1
    v_fma_f32 v127, v127, s58, s58
    v_mul_f32_e64 v126, v126, v62
    v_mfma_f32_32x32x16_bf16 v[32:47], a[124:127], v[92:95], v[32:47]
    ds_read_b64_tr_b16 v[92:93], v16 offset:36608
    ds_read_b64_tr_b16 v[94:95], v16 offset:36864
    v_rcp_f32 v127, v127
    s_nop 0
    v_mul_f32_e64 v127, v127, v63
    v_cvt_pk_bf16_f32 v135, v126, v127
    buffer_store_dwordx4 v[132:135], v20, s[28:31], s48 offen offset:1024 sc1
    s_waitcnt lgkmcnt(8)
    v_and_b32 v8, v21, v64
    v_dot2_f32_bf16 v28, v8, v8, 0
    v_dot2_f32_bf16 v29, v65, v65, 0
    v_dot2_f32_bf16 v30, v66, v66, 0
    v_dot2_f32_bf16 v31, v67, v67, 0
    v_dot2_f32_bf16 v28, v68, v68, v28
    v_dot2_f32_bf16 v29, v69, v69, v29
    v_dot2_f32_bf16 v30, v70, v70, v30
    v_dot2_f32_bf16 v31, v71, v71, v31
    v_dot2_f32_bf16 v28, v72, v72, v28
    v_dot2_f32_bf16 v29, v73, v73, v29
    v_dot2_f32_bf16 v30, v74, v74, v30
    v_dot2_f32_bf16 v31, v75, v75, v31
    v_dot2_f32_bf16 v28, v76, v76, v28
    v_dot2_f32_bf16 v29, v77, v77, v29
    v_dot2_f32_bf16 v30, v78, v78, v30
    v_dot2_f32_bf16 v31, v79, v79, v31
    s_waitcnt lgkmcnt(0)
    s_nop 0
    v_dot2_f32_bf16 v28, v80, v80, v28
    v_dot2_f32_bf16 v29, v81, v81, v29
    v_dot2_f32_bf16 v30, v82, v82, v30
    v_dot2_f32_bf16 v31, v83, v83, v31
    v_dot2_f32_bf16 v28, v84, v84, v28
    v_dot2_f32_bf16 v29, v85, v85, v29
    v_dot2_f32_bf16 v30, v86, v86, v30
    v_dot2_f32_bf16 v31, v87, v87, v31
    v_dot2_f32_bf16 v28, v88, v88, v28
    v_dot2_f32_bf16 v29, v89, v89, v29
    v_dot2_f32_bf16 v30, v90, v90, v30
    v_dot2_f32_bf16 v31, v91, v91, v31
    v_dot2_f32_bf16 v28, v92, v92, v28
    v_dot2_f32_bf16 v29, v93, v93, v29
    v_dot2_f32_bf16 v30, v94, v94, v30
    v_dot2_f32_bf16 v31, v95, v95, v31
    v_pk_fma_f32 v[32:33], v[32:33], v[24:25], v[96:97] op_sel_hi:[1,0,1]
    v_pk_fma_f32 v[34:35], v[34:35], v[24:25], v[98:99] op_sel_hi:[1,0,1]
    v_pk_fma_f32 v[36:37], v[36:37], v[24:25], v[100:101] op_sel_hi:[1,0,1]
    v_pk_fma_f32 v[38:39], v[38:39], v[24:25], v[102:103] op_sel_hi:[1,0,1]
    v_pk_fma_f32 v[40:41], v[40:41], v[24:25], v[104:105] op_sel_hi:[1,0,1]
    v_pk_fma_f32 v[42:43], v[42:43], v[24:25], v[106:107] op_sel_hi:[1,0,1]
    v_pk_fma_f32 v[44:45], v[44:45], v[24:25], v[108:109] op_sel_hi:[1,0,1]
    v_pk_fma_f32 v[46:47], v[46:47], v[24:25], v[110:111] op_sel_hi:[1,0,1]
    v_pk_fma_f32 v[112:113], v[32:33], v[32:33], v[6:7]
    v_pk_fma_f32 v[114:115], v[34:35], v[34:35], v[6:7]
    v_pk_fma_f32 v[116:117], v[36:37], v[36:37], v[6:7]
    v_pk_fma_f32 v[118:119], v[38:39], v[38:39], v[6:7]
    v_pk_fma_f32 v[120:121], v[40:41], v[40:41], v[6:7]
    v_pk_fma_f32 v[122:123], v[42:43], v[42:43], v[6:7]
    v_pk_fma_f32 v[124:125], v[44:45], v[44:45], v[6:7]
    v_pk_fma_f32 v[126:127], v[46:47], v[46:47], v[6:7]
    v_pk_mul_f32 v[112:113], v[112:113], v[32:33] neg_lo:[1,0] neg_hi:[1,0]
    v_pk_mul_f32 v[114:115], v[114:115], v[34:35] neg_lo:[1,0] neg_hi:[1,0]
    v_pk_mul_f32 v[116:117], v[116:117], v[36:37] neg_lo:[1,0] neg_hi:[1,0]
    v_pk_mul_f32 v[118:119], v[118:119], v[38:39] neg_lo:[1,0] neg_hi:[1,0]
    v_pk_mul_f32 v[120:121], v[120:121], v[40:41] neg_lo:[1,0] neg_hi:[1,0]
    v_pk_mul_f32 v[122:123], v[122:123], v[42:43] neg_lo:[1,0] neg_hi:[1,0]
    v_pk_mul_f32 v[124:125], v[124:125], v[44:45] neg_lo:[1,0] neg_hi:[1,0]
    v_pk_mul_f32 v[126:127], v[126:127], v[46:47] neg_lo:[1,0] neg_hi:[1,0]
    v_mfma_f32_32x32x16_bf16 v[48:63], a[0:3], v[64:67], 0
    ds_read_b64_tr_b16 v[64:65], v17 offset:33024
    ds_read_b64_tr_b16 v[66:67], v17 offset:33280
    v_add_f32_e64 v28, v28, v29
    buffer_load_dwordx4 v[184:187], v12, s[28:31], s54 offen offset:3072 sc1
    v_exp_f32 v112, v112
    s_nop 0
    v_fma_f32 v112, v112, s58, s58
L_hop2:
    s_cbranch_execz HOPRET_0
    v_mfma_f32_32x32x16_bf16 v[48:63], a[4:7], v[68:71], v[48:63]
    ds_read_b64_tr_b16 v[68:69], v17 offset:33536
    ds_read_b64_tr_b16 v[70:71], v17 offset:33792
    v_add_f32 v30, v30, v31
    buffer_load_dwordx4 v[188:191], v12, s[28:31], s55 offen offset:3072 sc1
    v_exp_f32_e64 v113, v113
    v_mfma_f32_32x32x16_bf16 v[48:63], a[8:11], v[72:75], v[48:63]
    ds_read_b64_tr_b16 v[72:73], v17 offset:34048
    ds_read_b64_tr_b16 v[74:75], v17 offset:34304
    v_add_f32 v28, v28, v30
    v_rcp_f32 v112, v112
    v_fma_f32 v113, v113, s58, s58
    v_exp_f32_e64 v114, v114
    v_mfma_f32_32x32x16_bf16 v[48:63], a[12:15], v[76:79], v[48:63]
    ds_read_b64_tr_b16 v[76:77], v17 offset:34560
    ds_read_b64_tr_b16 v[78:79], v17 offset:34816
    v_mov_b32_e64 v29, v28
    s_add_u32 s54, s54, 4096
    buffer_load_dwordx4 v[192:195], v12, s[28:31], s54 offen offset:0 sc1
    v_mul_f32_e64 v112, v112, v32
    v_mfma_f32_32x32x16_bf16 v[48:63], a[16:19], v[80:83], v[48:63]
    ds_read_b64_tr_b16 v[80:81], v17 offset:35072
    ds_read_b64_tr_b16 v[82:83], v17 offset:35328
    v_permlane32_swap_b32 v28, v29
    v_rcp_f32 v113, v113
    v_fma_f32 v114, v114, s58, s58
    v_mfma_f32_32x32x16_bf16 v[48:63], a[20:23], v[84:87], v[48:63]
    ds_read_b64_tr_b16 v[84:85], v17 offset:35584
    ds_read_b64_tr_b16 v[86:87], v17 offset:35840
    v_add_f32_e64 v28, v28, v29
    s_add_u32 s55, s55, 4096
    buffer_load_dwordx4 v[196:199], v12, s[28:31], s55 offen offset:0 sc1
    v_exp_f32_e64 v115, v115
    v_mfma_f32_32x32x16_bf16 v[48:63], a[24:27], v[88:91], v[48:63]
    ds_read_b64_tr_b16 v[88:89], v17 offset:36096
    ds_read_b64_tr_b16 v[90:91], v17 offset:36352
    ds_write_b32 v23, v28 offset:1536
    v_mul_f32_e64 v113, v113, v33
    v_cvt_pk_bf16_f32 v128, v112, v113
    v_rcp_f32_e64 v114, v114
    v_mfma_f32_32x32x16_bf16 v[48:63], a[28:31], v[92:95], v[48:63]
    ds_read_b64_tr_b16 v[92:93], v17 offset:36608
    ds_read_b64_tr_b16 v[94:95], v17 offset:36864
    buffer_load_dwordx4 v[200:203], v12, s[28:31], s54 offen offset:1024 sc1
    v_fma_f32 v115, v115, s58, s58
    v_exp_f32 v116, v116
    s_waitcnt lgkmcnt(9)
    v_mfma_f32_32x32x16_bf16 v[48:63], a[32:35], v[64:67], v[48:63]
    ds_read_b64_tr_b16 v[64:65], v18 offset:33024
    ds_read_b64_tr_b16 v[66:67], v18 offset:33280
    buffer_load_dwordx4 v[204:207], v12, s[28:31], s55 offen offset:1024 sc1
    v_mul_f32 v114, v114, v34
    v_rcp_f32 v115, v115
    v_mfma_f32_32x32x16_bf16 v[48:63], a[36:39], v[68:71], v[48:63]
    ds_read_b64_tr_b16 v[68:69], v18 offset:33536
    ds_read_b64_tr_b16 v[70:71], v18 offset:33792
    v_fma_f32 v116, v116, s58, s58
    v_exp_f32 v117, v117
    v_mul_f32 v115, v115, v35
    v_cvt_pk_bf16_f32 v129, v114, v115
    v_mfma_f32_32x32x16_bf16 v[48:63], a[40:43], v[72:75], v[48:63]
    ds_read_b64_tr_b16 v[72:73], v18 offset:34048
    ds_read_b64_tr_b16 v[74:75], v18 offset:34304
    buffer_load_dwordx4 v[208:211], v12, s[28:31], s54 offen offset:2048 sc1
    v_rcp_f32_e64 v116, v116
    v_fma_f32 v117, v117, s58, s58
    v_mfma_f32_32x32x16_bf16 v[48:63], a[44:47], v[76:79], v[48:63]
    ds_read_b64_tr_b16 v[76:77], v18 offset:34560
    ds_read_b64_tr_b16 v[78:79], v18 offset:34816
    v_exp_f32 v118, v118
    s_waitcnt lgkmcnt(8)
    s_waitcnt vmcnt(7)
    s_barrier
    v_mfma_f32_32x32x16_bf16 v[48:63], a[48:51], v[80:83], v[48:63]
    ds_read_b128 v[28:31], v22 offset:1536
    ds_read_b64_tr_b16 v[80:81], v18 offset:35072
    ds_read_b64_tr_b16 v[82:83], v18 offset:35328
    s_cmp_lg_u32 s3, 0
    s_cbranch_scc1 Lfl_1004
    v_mov_b32_e64 v9, 1
    v_lshlrev_b32 v11, 2, v0
    s_mov_b64 exec, 0xffff
    buffer_store_dword v9, v11, s[28:31], s63 offen sc1
    s_mov_b64 exec, -1
Lfl_1004:
    buffer_load_dwordx4 v[212:215], v12, s[28:31], s55 offen offset:2048 sc1
    v_mfma_f32_32x32x16_bf16 v[48:63], a[52:55], v[84:87], v[48:63]
    ds_read_b64_tr_b16 v[84:85], v18 offset:35584
    ds_read_b64_tr_b16 v[86:87], v18 offset:35840
    v_mul_f32_e64 v116, v116, v36
    v_mfma_f32_32x32x16_bf16 v[48:63], a[56:59], v[88:91], v[48:63]
    ds_read_b64_tr_b16 v[88:89], v18 offset:36096
    ds_read_b64_tr_b16 v[90:91], v18 offset:36352
    buffer_load_dwordx4 v[216:219], v12, s[28:31], s54 offen offset:3072 sc1
    v_rcp_f32_e64 v117, v117
    v_fma_f32 v118, v118, s58, s58
    v_mfma_f32_32x32x16_bf16 v[48:63], a[60:63], v[92:95], v[48:63]
    ds_read_b64_tr_b16 v[92:93], v18 offset:36608
    ds_read_b64_tr_b16 v[94:95], v18 offset:36864
    s_waitcnt lgkmcnt(8)
    v_exp_f32 v119, v119
    v_mul_f32 v117, v117, v37
    s_waitcnt lgkmcnt(9)
    v_mfma_f32_32x32x16_bf16 v[48:63], a[64:67], v[64:67], v[48:63]
    ds_read_b64_tr_b16 v[64:65], v19 offset:33024
    ds_read_b64_tr_b16 v[66:67], v19 offset:33280
    v_add_f32_e64 v28, v28, v29
    buffer_load_dwordx4 v[220:223], v12, s[28:31], s55 offen offset:3072 sc1
    v_cvt_pk_bf16_f32 v130, v116, v117
    v_rcp_f32_e64 v118, v118
    v_mfma_f32_32x32x16_bf16 v[48:63], a[68:71], v[68:71], v[48:63]
    ds_read_b64_tr_b16 v[68:69], v19 offset:33536
    ds_read_b64_tr_b16 v[70:71], v19 offset:33792
    v_add_f32_e64 v30, v30, v31
    s_add_u32 s54, s54, 4096
    buffer_load_dwordx4 v[224:227], v12, s[28:31], s54 offen offset:0 sc1
    v_fma_f32 v119, v119, s58, s58
    v_mfma_f32_32x32x16_bf16 v[48:63], a[72:75], v[72:75], v[48:63]
    ds_read_b64_tr_b16 v[72:73], v19 offset:34048
    ds_read_b64_tr_b16 v[74:75], v19 offset:34304
    v_add_f32 v28, v28, v30
    v_exp_f32 v120, v120
    v_mul_f32 v118, v118, v38
    v_rcp_f32 v119, v119
    v_mfma_f32_32x32x16_bf16 v[48:63], a[76:79], v[76:79], v[48:63]
    ds_read_b64_tr_b16 v[76:77], v19 offset:34560
    ds_read_b64_tr_b16 v[78:79], v19 offset:34816
    v_mul_f32 v28, 0x3b000000, v28
    s_add_u32 s55, s55, 4096
    buffer_load_dwordx4 v[228:231], v12, s[28:31], s55 offen offset:0 sc1
    s_waitcnt lgkmcnt(8)
    s_nop 0
    v_mfma_f32_32x32x16_bf16 v[48:63], a[80:83], v[80:83], v[48:63]
    ds_read_b64_tr_b16 v[80:81], v19 offset:35072
    ds_read_b64_tr_b16 v[82:83], v19 offset:35328
    v_add_f32 v29, 0x3727c5ac, v28
    v_fma_f32 v120, v120, s58, s58
    v_exp_f32_e64 v121, v121
    v_mfma_f32_32x32x16_bf16 v[48:63], a[84:87], v[84:87], v[48:63]
    ds_read_b64_tr_b16 v[84:85], v19 offset:35584
    ds_read_b64_tr_b16 v[86:87], v19 offset:35840
    v_rsq_f32_e64 v29, v29
    buffer_load_dwordx4 v[232:235], v12, s[28:31], s54 offen offset:1024 sc1
    v_mul_f32_e64 v119, v119, v39
    v_cvt_pk_bf16_f32 v131, v118, v119
    v_mfma_f32_32x32x16_bf16 v[48:63], a[88:91], v[88:91], v[48:63]
    ds_read_b64_tr_b16 v[88:89], v19 offset:36096
    ds_read_b64_tr_b16 v[90:91], v19 offset:36352
    v_mul_f32 v28, v28, v29
    v_rcp_f32 v120, v120
    v_fma_f32 v121, v121, s58, s58
    s_add_u32 s48, s48, 262144
    v_mfma_f32_32x32x16_bf16 v[48:63], a[92:95], v[92:95], v[48:63]
    ds_read_b64_tr_b16 v[92:93], v19 offset:36608
    ds_read_b64_tr_b16 v[94:95], v19 offset:36864
    v_fmaak_f32 v28, v28, v29, 0x3727c5ac
    buffer_load_dwordx4 v[236:239], v12, s[28:31], s55 offen offset:1024 sc1
    buffer_store_dwordx4 v[128:131], v20, s[28:31], s48 offen offset:0 sc1
    s_waitcnt lgkmcnt(8)
    v_mfma_f32_32x32x16_bf16 v[48:63], a[96:99], v[64:67], v[48:63]
    v_rsq_f32 v28, v28
    buffer_load_dwordx4 v[240:243], v12, s[28:31], s54 offen offset:2048 sc1
    v_exp_f32 v122, v122
    v_mul_f32 v120, v120, v40
    v_rcp_f32_e64 v121, v121
    v_mfma_f32_32x32x16_bf16 v[48:63], a[100:103], v[68:71], v[48:63]
    v_mul_f32_e64 v29, s58, v29
    v_fma_f32 v122, v122, s58, s58
    v_exp_f32 v123, v123
    v_mul_f32 v121, v121, v41
    v_cvt_pk_bf16_f32 v132, v120, v121
    v_mfma_f32_32x32x16_bf16 v[48:63], a[104:107], v[72:75], v[48:63]
    v_mul_f32_e64 v26, v28, v29
    buffer_load_dwordx4 v[244:247], v12, s[28:31], s55 offen offset:2048 sc1
    v_rcp_f32_e64 v122, v122
    v_fma_f32 v123, v123, s58, s58
    v_exp_f32_e64 v124, v124
    v_mfma_f32_32x32x16_bf16 v[48:63], a[108:111], v[76:79], v[48:63]
    v_mul_f32 v122, v122, v42
    v_rcp_f32 v123, v123
    v_fma_f32 v124, v124, s58, s58
    v_exp_f32 v125, v125
    s_waitcnt lgkmcnt(0)
    v_mfma_f32_32x32x16_bf16 v[48:63], a[112:115], v[80:83], v[48:63]
    buffer_load_dwordx4 v[248:251], v12, s[28:31], s54 offen offset:3072 sc1
    v_mul_f32_e64 v123, v123, v43
    v_cvt_pk_bf16_f32 v133, v122, v123
    v_rcp_f32_e64 v124, v124
    v_fma_f32 v125, v125, s58, s58
    v_mfma_f32_32x32x16_bf16 v[48:63], a[116:119], v[84:87], v[48:63]
    v_exp_f32 v126, v126
    v_mul_f32 v124, v124, v44
    v_rcp_f32_e64 v125, v125
    v_fma_f32 v126, v126, s58, s58
    v_mfma_f32_32x32x16_bf16 v[48:63], a[120:123], v[88:91], v[48:63]
    buffer_load_dwordx4 v[252:255], v12, s[28:31], s55 offen offset:3072 sc1
    v_exp_f32 v127, v127
    v_mul_f32 v125, v125, v45
    v_cvt_pk_bf16_f32 v134, v124, v125
    v_rcp_f32_e64 v126, v126
    v_mfma_f32_32x32x16_bf16 v[48:63], a[124:127], v[92:95], v[48:63]
    v_fma_f32 v127, v127, s58, s58
    v_mul_f32_e64 v126, v126, v46
    v_rcp_f32 v127, v127
    s_nop 0
    v_mul_f32 v127, v127, v47
    v_cvt_pk_bf16_f32 v135, v126, v127
    buffer_store_dwordx4 v[132:135], v20, s[28:31], s48 offen offset:1024 sc1
    buffer_load_dword v13, v10, s[28:31], s40 offen sc1
    s_nop 3
    v_pk_fma_f32 v[48:49], v[48:49], v[26:27], v[96:97] op_sel_hi:[1,0,1]
    v_pk_fma_f32 v[50:51], v[50:51], v[26:27], v[98:99] op_sel_hi:[1,0,1]
    v_pk_fma_f32 v[52:53], v[52:53], v[26:27], v[100:101] op_sel_hi:[1,0,1]
    v_pk_fma_f32 v[54:55], v[54:55], v[26:27], v[102:103] op_sel_hi:[1,0,1]
    v_pk_fma_f32 v[112:113], v[48:49], v[48:49], v[6:7]
    v_pk_fma_f32 v[114:115], v[50:51], v[50:51], v[6:7]
    v_pk_fma_f32 v[116:117], v[52:53], v[52:53], v[6:7]
    v_pk_fma_f32 v[118:119], v[54:55], v[54:55], v[6:7]
    v_pk_mul_f32 v[112:113], v[112:113], v[48:49] neg_lo:[1,0] neg_hi:[1,0]
    v_pk_mul_f32 v[114:115], v[114:115], v[50:51] neg_lo:[1,0] neg_hi:[1,0]
    v_pk_mul_f32 v[116:117], v[116:117], v[52:53] neg_lo:[1,0] neg_hi:[1,0]
    v_pk_mul_f32 v[118:119], v[118:119], v[54:55] neg_lo:[1,0] neg_hi:[1,0]
    v_exp_f32 v112, v112
    v_exp_f32 v113, v113
    v_exp_f32 v114, v114
    v_exp_f32 v115, v115
    v_exp_f32 v116, v116
    v_exp_f32 v117, v117
    v_exp_f32 v118, v118
    v_exp_f32 v119, v119
    v_pk_fma_f32 v[112:113], v[112:113], s[58:59], s[58:59]
    v_pk_fma_f32 v[114:115], v[114:115], s[58:59], s[58:59]
    v_pk_fma_f32 v[116:117], v[116:117], s[58:59], s[58:59]
    v_pk_fma_f32 v[118:119], v[118:119], s[58:59], s[58:59]
    v_rcp_f32 v112, v112
    v_rcp_f32 v113, v113
    v_rcp_f32 v114, v114
    v_rcp_f32 v115, v115
    v_rcp_f32 v116, v116
    v_rcp_f32 v117, v117
    v_rcp_f32 v118, v118
    v_rcp_f32 v119, v119
    v_pk_mul_f32 v[112:113], v[112:113], v[48:49]
    v_pk_mul_f32 v[114:115], v[114:115], v[50:51]
    v_pk_mul_f32 v[116:117], v[116:117], v[52:53]
    v_pk_mul_f32 v[118:119], v[118:119], v[54:55]
    v_cvt_pk_bf16_f32 v128, v112, v113
    v_cvt_pk_bf16_f32 v129, v114, v115
    v_cvt_pk_bf16_f32 v130, v116, v117
    v_cvt_pk_bf16_f32 v131, v118, v119
    s_add_u32 s48, s48, 262144
    buffer_store_dwordx4 v[128:131], v20, s[28:31], s48 offen offset:0 sc1
    v_pk_fma_f32 v[56:57], v[56:57], v[26:27], v[104:105] op_sel_hi:[1,0,1]
    v_pk_fma_f32 v[58:59], v[58:59], v[26:27], v[106:107] op_sel_hi:[1,0,1]
    v_pk_fma_f32 v[60:61], v[60:61], v[26:27], v[108:109] op_sel_hi:[1,0,1]
    v_pk_fma_f32 v[62:63], v[62:63], v[26:27], v[110:111] op_sel_hi:[1,0,1]
    v_pk_fma_f32 v[120:121], v[56:57], v[56:57], v[6:7]
    v_pk_fma_f32 v[122:123], v[58:59], v[58:59], v[6:7]
    v_pk_fma_f32 v[124:125], v[60:61], v[60:61], v[6:7]
    v_pk_fma_f32 v[126:127], v[62:63], v[62:63], v[6:7]
    v_pk_mul_f32 v[120:121], v[120:121], v[56:57] neg_lo:[1,0] neg_hi:[1,0]
    v_pk_mul_f32 v[122:123], v[122:123], v[58:59] neg_lo:[1,0] neg_hi:[1,0]
    v_pk_mul_f32 v[124:125], v[124:125], v[60:61] neg_lo:[1,0] neg_hi:[1,0]
    v_pk_mul_f32 v[126:127], v[126:127], v[62:63] neg_lo:[1,0] neg_hi:[1,0]
    v_exp_f32 v120, v120
    v_exp_f32 v121, v121
    v_exp_f32 v122, v122
    v_exp_f32 v123, v123
    v_exp_f32 v124, v124
    v_exp_f32 v125, v125
    v_exp_f32 v126, v126
    v_exp_f32 v127, v127
    v_pk_fma_f32 v[120:121], v[120:121], s[58:59], s[58:59]
    v_pk_fma_f32 v[122:123], v[122:123], s[58:59], s[58:59]
    v_pk_fma_f32 v[124:125], v[124:125], s[58:59], s[58:59]
    v_pk_fma_f32 v[126:127], v[126:127], s[58:59], s[58:59]
    v_rcp_f32 v120, v120
    v_rcp_f32 v121, v121
    v_rcp_f32 v122, v122
    v_rcp_f32 v123, v123
    v_rcp_f32 v124, v124
    v_rcp_f32 v125, v125
    v_rcp_f32 v126, v126
    v_rcp_f32 v127, v127
    v_pk_mul_f32 v[120:121], v[120:121], v[56:57]
    v_pk_mul_f32 v[122:123], v[122:123], v[58:59]
    v_pk_mul_f32 v[124:125], v[124:125], v[60:61]
    v_pk_mul_f32 v[126:127], v[126:127], v[62:63]
    v_cvt_pk_bf16_f32 v132, v120, v121
    v_cvt_pk_bf16_f32 v133, v122, v123
    v_cvt_pk_bf16_f32 v134, v124, v125
    v_cvt_pk_bf16_f32 v135, v126, v127
    buffer_store_dwordx4 v[132:135], v20, s[28:31], s48 offen offset:1024 sc1
L_g1_join0:
    s_waitcnt vmcnt(2)
    v_cmp_gt_u32 vcc, 1, v13
    s_mov_b32 s60, 0
    s_cbranch_vccz Lok_15
Lretry_16:
    buffer_load_dword v13, v10, s[28:31], s40 offen sc1
    s_waitcnt vmcnt(0)
    v_cmp_gt_u32 vcc, 1, v13
    s_add_u32 s60, s60, 1
    s_cbranch_vccz Lok_15
    s_sleep 1
    s_cmp_lt_u32 s60, s61
    s_cbranch_scc1 Lretry_16
    s_mov_b32 s61, 1
Lok_15:
    buffer_load_dwordx4 v[96:99], v2, s[28:31], s4 offen offset:0 sc1
    s_xor_b32 s45, s3, 1
    s_mul_i32 s45, s45, 6144
    s_add_u32 s45, s45, 0
    v_add_u32 v6, s45, v1
    s_xor_b32 s45, s3, 2
    s_mul_i32 s45, s45, 6144
    s_add_u32 s45, s45, 2048
    v_add_u32 v7, s45, v1
    buffer_load_dwordx4 v[100:103], v2, s[28:31], s4 offen offset:1024 sc1
    s_xor_b32 s45, s3, 3
    s_mul_i32 s45, s45, 6144
    s_add_u32 s45, s45, 4096
    v_add_u32 v8, s45, v1
    v_mov_b32 v26, v155
    v_and_b32_e64 v9, 30, v0
    v_lshl_add_u32 v3, v9, 5, v3
    v_lshlrev_b32_e64 v32, 16, v144
    v_and_b32 v33, 0xffff0000, v144
    buffer_load_dwordx4 v[104:107], v2, s[28:31], s4 offen offset:2048 sc1
    v_lshlrev_b32_e64 v34, 16, v145
    v_and_b32 v35, 0xffff0000, v145
    v_lshlrev_b32_e64 v36, 16, v146
    v_and_b32 v37, 0xffff0000, v146
    v_lshlrev_b32_e64 v38, 16, v147
    v_and_b32 v39, 0xffff0000, v147
    v_add_f32 v32, v32, v152
    v_add_f32 v33, v33, v152
    v_add_f32_e64 v34, v34, v152
    buffer_load_dwordx4 v[108:111], v2, s[28:31], s4 offen offset:3072 sc1
    v_add_f32 v35, v35, v152
    v_add_f32 v36, v36, v152
    v_add_f32 v37, v37, v152
    v_add_f32 v38, v38, v152
    v_add_f32 v39, v39, v152
    v_mov_b32 v40, 0
    v_mov_b32 v41, 0
    v_mov_b32 v42, 0
    v_mov_b32 v43, 0
    s_add_u32 s4, s4, s22
    buffer_load_dwordx4 v[112:115], v2, s[28:31], s4 offen offset:0 sc1
    v_mov_b32 v44, 0
    v_mov_b32 v45, 0
    v_mov_b32 v46, 0
    v_mov_b32 v47, 0
    v_add_f32 v153, 0x3ba7c5ac, v153
    v_and_b32 v153, 0x7f800000, v153
    v_mul_f32 v153, 0x43400000, v153
    v_min_f32 v153, 0x7b800000, v153
    v_lshlrev_b32_e64 v64, 16, v148
    buffer_load_dwordx4 v[116:119], v2, s[28:31], s4 offen offset:1024 sc1
    v_and_b32 v65, 0xffff0000, v148
    v_lshlrev_b32_e64 v66, 16, v149
    v_and_b32 v67, 0xffff0000, v149
    v_lshlrev_b32_e64 v68, 16, v150
    v_and_b32 v69, 0xffff0000, v150
    v_lshlrev_b32_e64 v70, 16, v151
    v_and_b32 v71, 0xffff0000, v151
    v_add_f32 v64, v64, v152
    v_add_f32 v65, v65, v152
    buffer_load_dwordx4 v[120:123], v2, s[28:31], s4 offen offset:2048 sc1
    v_add_f32 v66, v66, v152
    v_add_f32 v67, v67, v152
    v_add_f32 v68, v68, v152
    v_add_f32 v69, v69, v152
    v_add_f32 v70, v70, v152
    v_add_f32 v71, v71, v152
    v_mov_b32 v72, 0
    v_mov_b32 v73, 0
    v_mov_b32_e64 v74, 0
    buffer_load_dwordx4 v[124:127], v2, s[28:31], s4 offen offset:3072 sc1
    v_mov_b32 v75, 0
    v_mov_b32 v76, 0
    v_mov_b32 v77, 0
    v_mov_b32 v78, 0
    v_mov_b32_e64 v79, 0
    v_add_f32 v154, 0x3ba7c5ac, v154
    v_and_b32 v154, 0x7f800000, v154
    v_mul_f32 v154, 0x43400000, v154
    v_min_f32 v154, 0x7b800000, v154
    s_waitcnt vmcnt(8)
    s_barrier
    s_cmp_lg_u32 s3, 0
    s_cbranch_scc1 Lfl_17
    v_mov_b32 v9, 2
    v_lshlrev_b32 v11, 2, v0
    s_mov_b64 exec, 0xffff
    buffer_store_dword v9, v11, s[28:31], s63 offen sc1
    s_mov_b64 exec, -1
Lfl_17:
    s_add_u32 s4, s4, s23
    buffer_load_dwordx4 v[128:131], v2, s[28:31], s4 offen offset:0 sc1
    buffer_load_dwordx4 v[132:135], v2, s[28:31], s4 offen offset:1024 sc1
    buffer_load_dwordx4 v[136:139], v2, s[28:31], s4 offen offset:2048 sc1
    buffer_load_dwordx4 v[140:143], v2, s[28:31], s4 offen offset:3072 sc1
    s_add_u32 s4, s4, s22
    buffer_load_dwordx4 v[16:19], v2, s[28:31], s4 offen offset:0 sc1
    buffer_load_dwordx4 v[20:23], v2, s[28:31], s4 offen offset:1024 sc1
    s_waitcnt vmcnt(13)
    v_mfma_f32_32x32x16_bf16 v[32:47], v[96:99], a[128:131], v[32:47]
    v_mfma_f32_32x32x16_bf16 v[48:63], v[96:99], a[132:135], 0
    buffer_load_dwordx4 v[96:99], v2, s[28:31], s4 offen offset:2048 sc1
    s_waitcnt vmcnt(13)
    v_mfma_f32_32x32x16_bf16 v[32:47], v[100:103], a[136:139], v[32:47]
    v_mfma_f32_32x32x16_bf16 v[48:63], v[100:103], a[140:143], v[48:63]
    buffer_load_dwordx4 v[100:103], v2, s[28:31], s4 offen offset:3072 sc1
    s_waitcnt vmcnt(13)
    v_mfma_f32_32x32x16_bf16 v[32:47], v[104:107], a[144:147], v[32:47]
    v_mfma_f32_32x32x16_bf16 v[48:63], v[104:107], a[148:151], v[48:63]
    s_add_u32 s4, s4, s23
    buffer_load_dwordx4 v[104:107], v2, s[28:31], s4 offen offset:0 sc1
    s_waitcnt vmcnt(13)
    v_mfma_f32_32x32x16_bf16 v[32:47], v[108:111], a[152:155], v[32:47]
    v_mfma_f32_32x32x16_bf16 v[48:63], v[108:111], a[156:159], v[48:63]
    buffer_load_dwordx4 v[108:111], v2, s[28:31], s4 offen offset:1024 sc1
    s_waitcnt vmcnt(13)
    v_mfma_f32_32x32x16_bf16 v[32:47], v[112:115], a[160:163], v[32:47]
    v_mfma_f32_32x32x16_bf16 v[48:63], v[112:115], a[164:167], v[48:63]
    buffer_load_dwordx4 v[112:115], v2, s[28:31], s4 offen offset:2048 sc1
    s_waitcnt vmcnt(13)
    v_mfma_f32_32x32x16_bf16 v[32:47], v[116:119], a[168:171], v[32:47]
    v_mfma_f32_32x32x16_bf16 v[48:63], v[116:119], a[172:175], v[48:63]
    buffer_load_dwordx4 v[116:119], v2, s[28:31], s4 offen offset:3072 sc1
    buffer_load_dword v13, v10, s[28:31], s40 offen sc1
    s_waitcnt vmcnt(14)
    v_mfma_f32_32x32x16_bf16 v[32:47], v[120:123], a[176:179], v[32:47]
    v_mfma_f32_32x32x16_bf16 v[48:63], v[120:123], a[180:183], v[48:63]
    s_add_u32 s4, s4, s22
    buffer_load_dwordx4 v[120:123], v2, s[28:31], s4 offen offset:0 sc1
    s_waitcnt vmcnt(14)
    v_mfma_f32_32x32x16_bf16 v[32:47], v[124:127], a[184:187], v[32:47]
    v_mfma_f32_32x32x16_bf16 v[48:63], v[124:127], a[188:191], v[48:63]
    buffer_load_dwordx4 v[124:127], v2, s[28:31], s4 offen offset:1024 sc1
    s_waitcnt vmcnt(14)
    v_mfma_f32_32x32x16_bf16 v[32:47], v[128:131], a[192:195], v[32:47]
    v_mfma_f32_32x32x16_bf16 v[48:63], v[128:131], a[196:199], v[48:63]
    buffer_load_dwordx4 v[128:131], v2, s[28:31], s4 offen offset:2048 sc1
    s_waitcnt vmcnt(14)
    v_mfma_f32_32x32x16_bf16 v[32:47], v[132:135], a[200:203], v[32:47]
    v_mfma_f32_32x32x16_bf16 v[48:63], v[132:135], a[204:207], v[48:63]
    buffer_load_dwordx4 v[132:135], v2, s[28:31], s4 offen offset:3072 sc1
    s_waitcnt vmcnt(14)
    v_mfma_f32_32x32x16_bf16 v[32:47], v[136:139], a[208:211], v[32:47]
    v_mfma_f32_32x32x16_bf16 v[48:63], v[136:139], a[212:215], v[48:63]
    s_add_u32 s4, s4, s23
    buffer_load_dwordx4 v[136:139], v2, s[28:31], s4 offen offset:0 sc1
    s_waitcnt vmcnt(14)
    v_mfma_f32_32x32x16_bf16 v[32:47], v[140:143], a[216:219], v[32:47]
    v_mfma_f32_32x32x16_bf16 v[48:63], v[140:143], a[220:223], v[48:63]
    buffer_load_dwordx4 v[140:143], v2, s[28:31], s4 offen offset:1024 sc1
    s_waitcnt vmcnt(14)
    v_mfma_f32_32x32x16_bf16 v[32:47], v[16:19], a[224:227], v[32:47]
    v_mfma_f32_32x32x16_bf16 v[48:63], v[16:19], a[228:231], v[48:63]
    buffer_load_dwordx4 v[16:19], v2, s[28:31], s4 offen offset:2048 sc1
    s_waitcnt vmcnt(14)
    v_mfma_f32_32x32x16_bf16 v[32:47], v[20:23], a[232:235], v[32:47]
    v_mfma_f32_32x32x16_bf16 v[48:63], v[20:23], a[236:239], v[48:63]
    buffer_load_dwordx4 v[20:23], v2, s[28:31], s4 offen offset:3072 sc1
    s_waitcnt vmcnt(14)
    v_mfma_f32_32x32x16_bf16 v[32:47], v[96:99], a[240:243], v[32:47]
    v_mfma_f32_32x32x16_bf16 v[48:63], v[96:99], a[244:247], v[48:63]
    s_waitcnt vmcnt(13)
    v_mfma_f32_32x32x16_bf16 v[32:47], v[100:103], a[248:251], v[32:47]
    v_mfma_f32_32x32x16_bf16 v[48:63], v[100:103], a[252:255], v[48:63]
    s_waitcnt vmcnt(12)
    v_mfma_f32_32x32x16_bf16 v[32:47], v[104:107], v[160:163], v[32:47]
    v_mfma_f32_32x32x16_bf16 v[48:63], v[104:107], v[164:167], v[48:63]
    s_waitcnt vmcnt(11)
    v_mfma_f32_32x32x16_bf16 v[32:47], v[108:111], v[168:171], v[32:47]
    v_mfma_f32_32x32x16_bf16 v[48:63], v[108:111], v[172:175], v[48:63]
    s_waitcnt vmcnt(8)
    v_cmp_gt_u32 vcc, 2, v13
    s_mov_b32 s60, 0
    s_cbranch_vccz Lok_18
Lretry_19:
    buffer_load_dword v13, v10, s[28:31], s40 offen sc1
    s_waitcnt vmcnt(0)
    v_cmp_gt_u32 vcc, 2, v13
    s_add_u32 s60, s60, 1
    s_cbranch_vccz Lok_18
    s_sleep 1
    s_cmp_lt_u32 s60, s61
    s_cbranch_scc1 Lretry_19
    s_mov_b32 s61, 1
Lok_18:
    buffer_load_dwordx4 v[96:99], v2, s[28:31], s5 offen offset:0 sc1
    buffer_load_dwordx4 v[100:103], v2, s[28:31], s5 offen offset:1024 sc1
    s_waitcnt vmcnt(12)
    v_mfma_f32_32x32x16_bf16 v[32:47], v[112:115], v[176:179], v[32:47]
    v_mfma_f32_32x32x16_bf16 v[48:63], v[112:115], v[180:183], v[48:63]
    buffer_load_dwordx4 v[104:107], v2, s[28:31], s5 offen offset:2048 sc1
    buffer_load_dwordx4 v[108:111], v2, s[28:31], s5 offen offset:3072 sc1
    s_waitcnt vmcnt(13)
    v_mfma_f32_32x32x16_bf16 v[32:47], v[116:119], v[184:187], v[32:47]
    v_mfma_f32_32x32x16_bf16 v[48:63], v[116:119], v[188:191], v[48:63]
    s_add_u32 s5, s5, s22
    buffer_load_dwordx4 v[112:115], v2, s[28:31], s5 offen offset:0 sc1
    buffer_load_dwordx4 v[116:119], v2, s[28:31], s5 offen offset:1024 sc1
    s_waitcnt vmcnt(13)
    v_mfma_f32_32x32x16_bf16 v[32:47], v[120:123], v[192:195], v[32:47]
    v_mfma_f32_32x32x16_bf16 v[48:63], v[120:123], v[196:199], v[48:63]
    buffer_load_dwordx4 v[120:123], v2, s[28:31], s5 offen offset:2048 sc1
    s_waitcnt vmcnt(13)
    v_mfma_f32_32x32x16_bf16 v[32:47], v[124:127], v[200:203], v[32:47]
    v_mfma_f32_32x32x16_bf16 v[48:63], v[124:127], v[204:207], v[48:63]
    buffer_load_dwordx4 v[124:127], v2, s[28:31], s5 offen offset:3072 sc1
    s_waitcnt vmcnt(13)
    v_mfma_f32_32x32x16_bf16 v[32:47], v[128:131], v[208:211], v[32:47]
    v_mfma_f32_32x32x16_bf16 v[48:63], v[128:131], v[212:215], v[48:63]
    s_add_u32 s5, s5, s23
    buffer_load_dwordx4 v[128:131], v2, s[28:31], s5 offen offset:0 sc1
    s_waitcnt vmcnt(13)
    v_mfma_f32_32x32x16_bf16 v[32:47], v[132:135], v[216:219], v[32:47]
    v_mfma_f32_32x32x16_bf16 v[48:63], v[132:135], v[220:223], v[48:63]
    buffer_load_dwordx4 v[132:135], v2, s[28:31], s5 offen offset:1024 sc1
    s_waitcnt vmcnt(13)
    v_mfma_f32_32x32x16_bf16 v[32:47], v[136:139], v[224:227], v[32:47]
    v_mfma_f32_32x32x16_bf16 v[48:63], v[136:139], v[228:231], v[48:63]
    buffer_load_dwordx4 v[136:139], v2, s[28:31], s5 offen offset:2048 sc1
    s_waitcnt vmcnt(13)
    v_mfma_f32_32x32x16_bf16 v[32:47], v[140:143], v[232:235], v[32:47]
    v_mfma_f32_32x32x16_bf16 v[48:63], v[140:143], v[236:239], v[48:63]
    buffer_load_dwordx4 v[140:143], v2, s[28:31], s5 offen offset:3072 sc1
    s_waitcnt vmcnt(13)
    v_mfma_f32_32x32x16_bf16 v[32:47], v[16:19], v[240:243], v[32:47]
    v_mfma_f32_32x32x16_bf16 v[48:63], v[16:19], v[244:247], v[48:63]
    s_add_u32 s5, s5, s22
    buffer_load_dwordx4 v[16:19], v2, s[28:31], s5 offen offset:0 sc1
    s_waitcnt vmcnt(13)
    v_mfma_f32_32x32x16_bf16 v[32:47], v[20:23], v[248:251], v[32:47]
    v_mfma_f32_32x32x16_bf16 v[48:63], v[20:23], v[252:255], v[48:63]
    buffer_load_dwordx4 v[20:23], v2, s[28:31], s5 offen offset:1024 sc1
    s_waitcnt vmcnt(13)
    v_mfma_f32_32x32x16_bf16 v[64:79], v[96:99], a[128:131], v[64:79]
    v_mfma_f32_32x32x16_bf16 v[80:95], v[96:99], a[132:135], 0
    buffer_load_dwordx4 v[96:99], v2, s[28:31], s5 offen offset:2048 sc1
    s_waitcnt vmcnt(13)
    v_mfma_f32_32x32x16_bf16 v[64:79], v[100:103], a[136:139], v[64:79]
    v_mfma_f32_32x32x16_bf16 v[80:95], v[100:103], a[140:143], v[80:95]
    s_nop 2
    ds_write_b128 v6, v[40:43] offset:0
    buffer_load_dwordx4 v[100:103], v2, s[28:31], s5 offen offset:3072 sc1
    s_waitcnt vmcnt(13)
    v_mfma_f32_32x32x16_bf16 v[64:79], v[104:107], a[144:147], v[64:79]
    ds_write_b128 v6, v[44:47] offset:1024
    v_mfma_f32_32x32x16_bf16 v[80:95], v[104:107], a[148:151], v[80:95]
    ds_write_b128 v7, v[48:51] offset:0
    s_add_u32 s5, s5, s23
    buffer_load_dwordx4 v[104:107], v2, s[28:31], s5 offen offset:0 sc1
    s_waitcnt vmcnt(13)
    v_mfma_f32_32x32x16_bf16 v[64:79], v[108:111], a[152:155], v[64:79]
    ds_write_b128 v7, v[52:55] offset:1024
    v_mfma_f32_32x32x16_bf16 v[80:95], v[108:111], a[156:159], v[80:95]
    ds_write_b128 v8, v[56:59] offset:0
    buffer_load_dwordx4 v[108:111], v2, s[28:31], s5 offen offset:1024 sc1
    s_waitcnt vmcnt(13)
    v_mfma_f32_32x32x16_bf16 v[64:79], v[112:115], a[160:163], v[64:79]
    ds_write_b128 v8, v[60:63] offset:1024
    v_mfma_f32_32x32x16_bf16 v[80:95], v[112:115], a[164:167], v[80:95]
    buffer_load_dwordx4 v[112:115], v2, s[28:31], s5 offen offset:2048 sc1
    s_waitcnt vmcnt(13)
    v_mfma_f32_32x32x16_bf16 v[64:79], v[116:119], a[168:171], v[64:79]
    v_mfma_f32_32x32x16_bf16 v[80:95], v[116:119], a[172:175], v[80:95]
    buffer_load_dwordx4 v[116:119], v2, s[28:31], s5 offen offset:3072 sc1
    s_waitcnt vmcnt(13)
    v_mfma_f32_32x32x16_bf16 v[64:79], v[120:123], a[176:179], v[64:79]
    v_mfma_f32_32x32x16_bf16 v[80:95], v[120:123], a[180:183], v[80:95]
    s_add_u32 s5, s5, s22
    buffer_load_dwordx4 v[120:123], v2, s[28:31], s5 offen offset:0 sc1
    s_waitcnt vmcnt(13)
    v_mfma_f32_32x32x16_bf16 v[64:79], v[124:127], a[184:187], v[64:79]
    s_waitcnt lgkmcnt(0)
    s_barrier
    ds_read_b128 v[40:43], v5 offset:0
    ds_read_b128 v[44:47], v5 offset:1024
    v_mfma_f32_32x32x16_bf16 v[80:95], v[124:127], a[188:191], v[80:95]
    ds_read_b128 v[48:51], v5 offset:2048
    ds_read_b128 v[52:55], v5 offset:3072
    buffer_load_dwordx4 v[124:127], v2, s[28:31], s5 offen offset:1024 sc1
    s_waitcnt vmcnt(13)
    v_mfma_f32_32x32x16_bf16 v[64:79], v[128:131], a[192:195], v[64:79]
    ds_read_b128 v[56:59], v5 offset:4096
    ds_read_b128 v[60:63], v5 offset:5120
    v_mfma_f32_32x32x16_bf16 v[80:95], v[128:131], a[196:199], v[80:95]
    buffer_load_dwordx4 v[128:131], v2, s[28:31], s5 offen offset:2048 sc1
    s_waitcnt vmcnt(13)
    v_mfma_f32_32x32x16_bf16 v[64:79], v[132:135], a[200:203], v[64:79]
    v_mfma_f32_32x32x16_bf16 v[80:95], v[132:135], a[204:207], v[80:95]
    buffer_load_dwordx4 v[132:135], v2, s[28:31], s5 offen offset:3072 sc1
    s_waitcnt vmcnt(13)
    v_mfma_f32_32x32x16_bf16 v[64:79], v[136:139], a[208:211], v[64:79]
    v_mfma_f32_32x32x16_bf16 v[80:95], v[136:139], a[212:215], v[80:95]
    s_waitcnt lgkmcnt(4)
    v_add_f32 v32, v32, v40
    v_add_f32 v33, v33, v41
    s_add_u32 s5, s5, s23
    buffer_load_dwordx4 v[136:139], v2, s[28:31], s5 offen offset:0 sc1
    s_waitcnt vmcnt(13)
    v_mfma_f32_32x32x16_bf16 v[64:79], v[140:143], a[216:219], v[64:79]
    v_add_f32 v34, v34, v42
    v_add_f32 v35, v35, v43
    v_mfma_f32_32x32x16_bf16 v[80:95], v[140:143], a[220:223], v[80:95]
    v_add_f32 v36, v36, v44
    v_add_f32 v37, v37, v45
    buffer_load_dwordx4 v[140:143], v2, s[28:31], s5 offen offset:1024 sc1
    s_waitcnt vmcnt(13)
    v_mfma_f32_32x32x16_bf16 v[64:79], v[16:19], a[224:227], v[64:79]
    v_add_f32 v38, v38, v46
    v_add_f32_e64 v39, v39, v47
    v_mfma_f32_32x32x16_bf16 v[80:95], v[16:19], a[228:231], v[80:95]
    s_waitcnt lgkmcnt(0)
    v_add_f32 v48, v48, v56
    buffer_load_dwordx4 v[16:19], v2, s[28:31], s5 offen offset:2048 sc1
    s_waitcnt vmcnt(13)
    v_mfma_f32_32x32x16_bf16 v[64:79], v[20:23], a[232:235], v[64:79]
    v_add_f32 v49, v49, v57
    v_add_f32_e64 v50, v50, v58
    v_mfma_f32_32x32x16_bf16 v[80:95], v[20:23], a[236:239], v[80:95]
L_hop3:
    s_cbranch_execz HOPRET_1
    v_add_f32_e64 v51, v51, v59
    v_add_f32 v52, v52, v60
    buffer_load_dwordx4 v[20:23], v2, s[28:31], s5 offen offset:3072 sc1
    s_waitcnt vmcnt(13)
    v_mfma_f32_32x32x16_bf16 v[64:79], v[96:99], a[240:243], v[64:79]
    v_add_f32 v53, v53, v61
    v_add_f32_e64 v54, v54, v62
    v_mfma_f32_32x32x16_bf16 v[80:95], v[96:99], a[244:247], v[80:95]
    v_add_f32_e64 v55, v55, v63
    v_add_f32 v32, v32, v48
    s_waitcnt vmcnt(12)
    v_mfma_f32_32x32x16_bf16 v[64:79], v[100:103], a[248:251], v[64:79]
    v_add_f32 v33, v33, v49
    v_add_f32 v34, v34, v50
    v_mfma_f32_32x32x16_bf16 v[80:95], v[100:103], a[252:255], v[80:95]
    v_add_f32_e64 v35, v35, v51
    v_add_f32 v36, v36, v52
    s_waitcnt vmcnt(11)
    v_mfma_f32_32x32x16_bf16 v[64:79], v[104:107], v[160:163], v[64:79]
    v_add_f32 v37, v37, v53
    v_add_f32 v38, v38, v54
    v_mfma_f32_32x32x16_bf16 v[80:95], v[104:107], v[164:167], v[80:95]
    v_add_f32 v39, v39, v55
    v_cvt_pk_bf16_f32 v144, v32, v33
    s_waitcnt vmcnt(10)
    v_mfma_f32_32x32x16_bf16 v[64:79], v[108:111], v[168:171], v[64:79]
    v_cvt_pk_bf16_f32 v145, v34, v35
    v_cvt_pk_bf16_f32 v146, v36, v37
    v_mfma_f32_32x32x16_bf16 v[80:95], v[108:111], v[172:175], v[80:95]
    v_cvt_pk_bf16_f32 v147, v38, v39
    buffer_store_dwordx4 v[144:147], v3, s[28:31], s6 offen sc1
    s_waitcnt vmcnt(10)
    v_mfma_f32_32x32x16_bf16 v[64:79], v[112:115], v[176:179], v[64:79]
    v_mul_f32 v40, v32, v26
    v_mul_f32_e64 v41, v33, v26
    v_mfma_f32_32x32x16_bf16 v[80:95], v[112:115], v[180:183], v[80:95]
    v_mul_f32 v42, v34, v26
    v_mul_f32 v43, v35, v26
    v_mul_f32 v44, v36, v26
    s_waitcnt vmcnt(9)
    v_mfma_f32_32x32x16_bf16 v[64:79], v[116:119], v[184:187], v[64:79]
    v_mul_f32 v45, v37, v26
    v_mul_f32 v46, v38, v26
    v_mfma_f32_32x32x16_bf16 v[80:95], v[116:119], v[188:191], v[80:95]
    v_mul_f32 v47, v39, v26
    v_mul_f32 v40, v40, v32
    s_waitcnt vmcnt(8)
    v_mul_f32 v41, v41, v33
    v_mul_f32_e64 v42, v42, v34
    v_mfma_f32_32x32x16_bf16 v[80:95], v[120:123], v[196:199], v[80:95]
    v_mul_f32 v43, v43, v35
    v_mul_f32 v44, v44, v36
    buffer_load_dword v13, v15, s[28:31], s62 offen offset:16 sc1
    s_waitcnt vmcnt(8)
    v_mul_f32 v45, v45, v37
    v_mul_f32_e64 v46, v46, v38
    v_mfma_f32_32x32x16_bf16 v[80:95], v[124:127], v[204:207], v[80:95]
    v_mul_f32 v47, v47, v39
    v_add_f32 v40, v40, v40 row_ror:8 row_mask:0xf bank_mask:0x3
    s_waitcnt vmcnt(7)
    v_add_f32 v41, v41, v41 row_ror:8 row_mask:0xf bank_mask:0x3
    v_add_f32 v42, v42, v42 row_ror:8 row_mask:0xf bank_mask:0x3
    v_mfma_f32_32x32x16_bf16 v[80:95], v[128:131], v[212:215], v[80:95]
    v_add_f32 v43, v43, v43 row_ror:8 row_mask:0xf bank_mask:0x3
    v_add_f32 v40, v44, v44 row_ror:8 row_mask:0xf bank_mask:0xc
    s_waitcnt vmcnt(6)
    v_add_f32 v41, v45, v45 row_ror:8 row_mask:0xf bank_mask:0xc
    v_add_f32 v42, v46, v46 row_ror:8 row_mask:0xf bank_mask:0xc
    v_mfma_f32_32x32x16_bf16 v[80:95], v[132:135], v[220:223], v[80:95]
    v_add_f32 v43, v47, v47 row_ror:8 row_mask:0xf bank_mask:0xc
    v_add_f32 v40, v40, v40 row_half_mirror row_mask:0xf bank_mask:0x5
    s_waitcnt vmcnt(5)
    v_add_f32 v41, v41, v41 row_half_mirror row_mask:0xf bank_mask:0x5
    v_add_f32 v40, v42, v42 row_half_mirror row_mask:0xf bank_mask:0xa
    v_mfma_f32_32x32x16_bf16 v[80:95], v[136:139], v[228:231], v[80:95]
    v_add_f32 v41, v43, v43 row_half_mirror row_mask:0xf bank_mask:0xa
    v_add_f32 v40, v40, v40 quad_perm:[1,0,3,2] row_mask:0xf bank_mask:0xf
    s_waitcnt vmcnt(4)
    v_add_f32 v41, v41, v41 quad_perm:[1,0,3,2] row_mask:0xf bank_mask:0xf
    v_add_f32 v40, v40, v40 quad_perm:[2,3,0,1] row_mask:0xf bank_mask:0xf
    v_mfma_f32_32x32x16_bf16 v[80:95], v[140:143], v[236:239], v[80:95]
    v_add_f32 v41, v41, v41 quad_perm:[2,3,0,1] row_mask:0xf bank_mask:0xf
    s_nop 1
    v_permlane16_swap_b32 v40, v41
    s_waitcnt vmcnt(3)
    v_add_f32 v40, v40, v41
    v_add_f32 v40, v40, v153
    v_mfma_f32_32x32x16_bf16 v[80:95], v[16:19], v[244:247], v[80:95]
    v_sub_f32 v40, v40, v153
    s_mov_b64 exec, s[10:11]
    buffer_atomic_add_f32 v40, v4, s[28:31], s8 offen offset:0 sc1
    buffer_atomic_add_f32 v40, v4, s[28:31], s24 offen offset:0 sc1
    s_mov_b64 exec, -1
    s_waitcnt vmcnt(4)
    v_mfma_f32_32x32x16_bf16 v[80:95], v[20:23], v[252:255], v[80:95]
    v_mfma_f32_32x32x16_bf16 v[64:79], v[120:123], v[192:195], v[64:79]
    v_mfma_f32_32x32x16_bf16 v[64:79], v[124:127], v[200:203], v[64:79]
    v_mfma_f32_32x32x16_bf16 v[64:79], v[128:131], v[208:211], v[64:79]
    s_nop 8
    ds_write_b128 v7, v[80:83] offset:24576
    v_mfma_f32_32x32x16_bf16 v[64:79], v[132:135], v[216:219], v[64:79]
    ds_write_b128 v7, v[84:87] offset:25600
    v_mfma_f32_32x32x16_bf16 v[64:79], v[136:139], v[224:227], v[64:79]
    v_mfma_f32_32x32x16_bf16 v[64:79], v[140:143], v[232:235], v[64:79]
    ds_write_b128 v8, v[88:91] offset:24576
    v_mfma_f32_32x32x16_bf16 v[64:79], v[16:19], v[240:243], v[64:79]
    ds_write_b128 v8, v[92:95] offset:25600
    v_mfma_f32_32x32x16_bf16 v[64:79], v[20:23], v[248:251], v[64:79]
    s_nop 11
    ds_write_b128 v6, v[72:75] offset:24576
    ds_write_b128 v6, v[76:79] offset:25600
    s_waitcnt lgkmcnt(0)
    s_barrier
    ds_read_b128 v[72:75], v5 offset:24576
    ds_read_b128 v[76:79], v5 offset:25600
    ds_read_b128 v[80:83], v5 offset:26624
    ds_read_b128 v[84:87], v5 offset:27648
    ds_read_b128 v[88:91], v5 offset:28672
    ds_read_b128 v[92:95], v5 offset:29696
    s_waitcnt lgkmcnt(4)
    v_pk_add_f32 v[64:65], v[64:65], v[72:73]
    v_pk_add_f32 v[66:67], v[66:67], v[74:75]
    v_pk_add_f32 v[68:69], v[68:69], v[76:77]
    v_pk_add_f32 v[70:71], v[70:71], v[78:79]
    s_waitcnt lgkmcnt(0)
    v_pk_add_f32 v[80:81], v[80:81], v[88:89]
    v_pk_add_f32 v[82:83], v[82:83], v[90:91]
    v_pk_add_f32 v[84:85], v[84:85], v[92:93]
    v_pk_add_f32 v[86:87], v[86:87], v[94:95]
    v_pk_add_f32 v[64:65], v[64:65], v[80:81]
    v_pk_add_f32 v[66:67], v[66:67], v[82:83]
    v_pk_add_f32 v[68:69], v[68:69], v[84:85]
    v_pk_add_f32 v[70:71], v[70:71], v[86:87]
    v_cvt_pk_bf16_f32 v148, v64, v65
    v_cvt_pk_bf16_f32 v149, v66, v67
    v_cvt_pk_bf16_f32 v150, v68, v69
    v_cvt_pk_bf16_f32 v151, v70, v71
    buffer_store_dwordx4 v[148:151], v3, s[28:31], s7 offen sc1
    v_pk_mul_f32 v[72:73], v[64:65], v[26:27] op_sel_hi:[1,0]
    v_pk_mul_f32 v[74:75], v[66:67], v[26:27] op_sel_hi:[1,0]
    v_pk_mul_f32 v[76:77], v[68:69], v[26:27] op_sel_hi:[1,0]
    v_pk_mul_f32 v[78:79], v[70:71], v[26:27] op_sel_hi:[1,0]
    v_pk_mul_f32 v[72:73], v[72:73], v[64:65]
    v_pk_mul_f32 v[74:75], v[74:75], v[66:67]
    v_pk_mul_f32 v[76:77], v[76:77], v[68:69]
    v_pk_mul_f32 v[78:79], v[78:79], v[70:71]
    v_add_f32 v72, v72, v72 row_ror:8 row_mask:0xf bank_mask:0x3
    v_add_f32 v73, v73, v73 row_ror:8 row_mask:0xf bank_mask:0x3
    v_add_f32 v74, v74, v74 row_ror:8 row_mask:0xf bank_mask:0x3
    v_add_f32 v75, v75, v75 row_ror:8 row_mask:0xf bank_mask:0x3
    v_add_f32 v72, v76, v76 row_ror:8 row_mask:0xf bank_mask:0xc
    v_add_f32 v73, v77, v77 row_ror:8 row_mask:0xf bank_mask:0xc
    v_add_f32 v74, v78, v78 row_ror:8 row_mask:0xf bank_mask:0xc
    v_add_f32 v75, v79, v79 row_ror:8 row_mask:0xf bank_mask:0xc
    v_add_f32 v72, v72, v72 row_half_mirror row_mask:0xf bank_mask:0x5
    v_add_f32 v73, v73, v73 row_half_mirror row_mask:0xf bank_mask:0x5
    s_nop 0
    v_add_f32 v72, v74, v74 row_half_mirror row_mask:0xf bank_mask:0xa
    v_add_f32 v73, v75, v75 row_half_mirror row_mask:0xf bank_mask:0xa
    s_nop 0
    v_add_f32 v72, v72, v72 quad_perm:[1,0,3,2] row_mask:0xf bank_mask:0xf
    v_add_f32 v73, v73, v73 quad_perm:[1,0,3,2] row_mask:0xf bank_mask:0xf
    s_nop 0
    v_add_f32 v72, v72, v72 quad_perm:[2,3,0,1] row_mask:0xf bank_mask:0xf
    v_add_f32 v73, v73, v73 quad_perm:[2,3,0,1] row_mask:0xf bank_mask:0xf
    s_nop 1
    v_permlane16_swap_b32 v72, v73
    v_add_f32 v72, v72, v73
    v_add_f32_e64 v72, v72, v154
    v_sub_f32 v72, v72, v154
    s_mov_b64 exec, s[10:11]
    buffer_atomic_add_f32 v72, v4, s[28:31], s8 offen offset:128 sc1
    buffer_atomic_add_f32 v72, v4, s[28:31], s24 offen offset:128 sc1
    s_mov_b64 exec, -1
    s_lshr_b32 s54, s3, 1
    s_lshl_b32 s54, s54, 3
    s_add_u32 s54, s54, s44
    s_xor_b32 s55, s54, 8
    s_mul_i32 s45, s3, 28
    s_mul_i32 s54, s54, 144
    s_add_u32 s54, s54, s45
    s_lshl_b32 s54, s54, 10
    s_add_u32 s54, s54, 0xe00000
    s_mul_i32 s55, s55, 144
    s_add_u32 s55, s55, s45
    s_lshl_b32 s55, s55, 10
    s_add_u32 s55, s55, 0xe00000
    s_mul_i32 s56, s3, 20480
    s_sub_u32 s56, 114688, s56
    s_min_u32 s52, s54, s55
    s_add_u32 s52, s52, s56
    s_and_b32 s45, s3, 1
    s_lshl_b32 s45, s45, 8
    v_xor_b32 v12, s45, v1
    v_and_b32 v3, 15, v0
    v_lshrrev_b32 v7, 4, v0
    v_lshlrev_b32 v8, 2, v7
    v_cvt_f32_u32 v8, v8
    s_lshl_b32 s45, s3, 4
    v_add_u32 v9, s45, v3
    v_cvt_f32_u32 v10, v9
    v_cvt_f32_u32 v11, v3
    v_mul_f32 v224, v10, v8
    v_mul_f32_e64 v225, v11, v8
    v_mul_f32 v226, 0x3c800000, v224
    v_mul_f32 v225, 0x3d000000, v225
    v_mul_f32 v224, 0x3a000000, v224
    v_and_b32_e64 v9, 1, v9
    s_mov_b32 s46, 0x80008000
    v_mul_lo_u32 v9, v9, s46
    v_fmamk_f32 v200, v10, 0x00000000, v226
    v_fmamk_f32 v201, v10, 0x3c800000, v226
    v_fmamk_f32 v202, v10, 0x3d000000, v226
    v_fmamk_f32 v203, v10, 0x3d400000, v226
    v_fmamk_f32 v204, v10, 0x3e800000, v226
    v_fmamk_f32 v205, v10, 0x3e880000, v226
    v_fmamk_f32 v206, v10, 0x3e900000, v226
    v_fmamk_f32 v207, v10, 0x3e980000, v226
    v_cos_f32 v208, v200
    v_sin_f32 v216, v200
    v_cos_f32 v209, v201
    v_sin_f32 v217, v201
    v_cos_f32 v210, v202
    v_sin_f32 v218, v202
    v_cos_f32 v211, v203
    v_sin_f32 v219, v203
    v_cos_f32 v212, v204
    v_sin_f32 v220, v204
    v_cos_f32 v213, v205
    v_sin_f32 v221, v205
    v_cos_f32 v214, v206
    v_sin_f32 v222, v206
    v_cos_f32 v215, v207
    v_sin_f32 v223, v207
    v_cvt_pk_bf16_f32 v16, v208, v209
    v_cvt_pk_bf16_f32 v24, v216, v217
    v_cvt_pk_bf16_f32 v17, v210, v211
    v_cvt_pk_bf16_f32 v25, v218, v219
    v_cvt_pk_bf16_f32 v18, v212, v213
    v_cvt_pk_bf16_f32 v26, v220, v221
    v_cvt_pk_bf16_f32 v19, v214, v215
    v_cvt_pk_bf16_f32 v27, v222, v223
    v_xor_b32 v32, s46, v24
    v_xor_b32 v20, v9, v16
    v_xor_b32 v28, v9, v24
    v_xor_b32 v36, v9, v32
    v_xor_b32 v33, s46, v25
    v_xor_b32 v21, v9, v17
    v_xor_b32 v29, v9, v25
    v_xor_b32 v37, v9, v33
    v_xor_b32 v34, s46, v26
    v_xor_b32 v22, v9, v18
    v_xor_b32 v30, v9, v26
    v_xor_b32 v38, v9, v34
    v_xor_b32 v35, s46, v27
    v_xor_b32 v23, v9, v19
    v_xor_b32 v31, v9, v27
    v_xor_b32 v39, v9, v35
    v_fmamk_f32 v200, v11, 0x00000000, v225
    v_fmamk_f32 v201, v11, 0x3d000000, v225
    v_fmamk_f32 v202, v11, 0x3d800000, v225
    v_fmamk_f32 v203, v11, 0x3dc00000, v225
    v_fmamk_f32 v204, v11, 0x3f000000, v225
    v_fmamk_f32 v205, v11, 0x3f080000, v225
    v_fmamk_f32 v206, v11, 0x3f100000, v225
    v_fmamk_f32 v207, v11, 0x3f180000, v225
    v_cos_f32 v208, v200
    v_sin_f32 v216, v200
    v_cos_f32 v209, v201
    v_sin_f32 v217, v201
    v_cos_f32 v210, v202
    v_sin_f32 v218, v202
    v_cos_f32 v211, v203
    v_sin_f32 v219, v203
    v_cos_f32 v212, v204
    v_sin_f32 v220, v204
    v_cos_f32 v213, v205
    v_sin_f32 v221, v205
    v_cos_f32 v214, v206
    v_sin_f32 v222, v206
    v_cos_f32 v215, v207
    v_sin_f32 v223, v207
    v_cvt_pk_bf16_f32 v40, v208, v209
    v_cvt_pk_bf16_f32 v48, v216, v217
    v_cvt_pk_bf16_f32 v41, v210, v211
    v_cvt_pk_bf16_f32 v49, v218, v219
    v_cvt_pk_bf16_f32 v42, v212, v213
    v_cvt_pk_bf16_f32 v50, v220, v221
    v_cvt_pk_bf16_f32 v43, v214, v215
    v_cvt_pk_bf16_f32 v51, v222, v223
    s_mov_b32 s47, 0x80000000
    v_xor_b32 v56, s46, v48
    v_xor_b32 v44, s47, v40
    v_xor_b32 v52, s47, v48
    v_xor_b32 v60, s47, v56
    v_xor_b32 v57, s46, v49
    v_xor_b32 v45, s47, v41
    v_xor_b32 v53, s47, v49
    v_xor_b32 v61, s47, v57
    v_xor_b32 v58, s46, v50
    v_xor_b32 v46, s47, v42
    v_xor_b32 v54, s47, v50
    v_xor_b32 v62, s47, v58
    v_xor_b32 v59, s46, v51
    v_xor_b32 v47, s47, v43
    v_xor_b32 v55, s47, v51
    v_xor_b32 v63, s47, v59
    v_fmamk_f32 v200, v10, 0x00000000, v224
    v_fmamk_f32 v201, v10, 0x3a000000, v224
    v_fmamk_f32 v202, v10, 0x3a800000, v224
    v_fmamk_f32 v203, v10, 0x3ac00000, v224
    v_fmamk_f32 v204, v10, 0x3c000000, v224
    v_fmamk_f32 v205, v10, 0x3c080000, v224
    v_fmamk_f32 v206, v10, 0x3c100000, v224
    v_fmamk_f32 v207, v10, 0x3c180000, v224
    v_cos_f32 v64, v200
    v_sin_f32 v72, v200
    v_cos_f32 v65, v201
    v_sin_f32 v73, v201
    v_cos_f32 v66, v202
    v_sin_f32 v74, v202
    v_cos_f32 v67, v203
    v_sin_f32 v75, v203
    v_cos_f32 v68, v204
    v_sin_f32 v76, v204
    v_cos_f32 v69, v205
    v_sin_f32 v77, v205
    v_cos_f32 v70, v206
    v_sin_f32 v78, v206
    v_cos_f32 v71, v207
    v_sin_f32 v79, v207
    s_waitcnt vmcnt(0)
    v_cmp_gt_u32 vcc, 1, v13
    s_mov_b32 s60, 0
    s_cbranch_vccz Lok_20
Lretry_21:
    buffer_load_dword v13, v15, s[28:31], s62 offen offset:16 sc1
    s_waitcnt vmcnt(0)
    v_cmp_gt_u32 vcc, 1, v13
    s_add_u32 s60, s60, 1
    s_cbranch_vccz Lok_20
    s_sleep 1
    s_cmp_lt_u32 s60, s61
    s_cbranch_scc1 Lretry_21
    s_mov_b32 s61, 1
Lok_20:
    s_barrier
    s_cmp_lg_u32 s3, 0
    s_cbranch_scc1 Larr_22
    v_mov_b32 v13, 1
    s_mov_b64 exec, 0xff
    buffer_atomic_add v13, v14, s[28:31], s62 offen offset:8 sc1
    s_mov_b64 exec, -1
Larr_22:
    s_barrier
    s_branch L_layer1
L_g1_spare0:
    s_cmp_lg_u32 s3, 0
    s_cbranch_scc1 Lskip_23
    s_mov_b32 s60, 0
Lpoll_24:
    buffer_load_dword v13, v15, s[28:31], s62 offen offset:4 sc1
    s_waitcnt vmcnt(0)
    v_cmp_ne_u32 vcc, 8, v13
    s_add_u32 s60, s60, 1
    s_cbranch_vccz Lskip_23
    s_cmp_lt_u32 s60, s61
    s_cbranch_scc1 Lpoll_24
    s_mov_b32 s61, 1
Lskip_23:
    s_barrier
    s_waitcnt vmcnt(0)
    s_mov_b32 s46, s43
    s_cmp_ge_u32 s46, 28
    s_cbranch_scc1 L_noe
    s_mov_b32 s32, s16
    s_and_b32 s33, s17, 0xffff
    s_mov_b32 s34, 0x1c0000
    s_mov_b32 s35, 0x00020000
    s_lshl_b32 s47, s46, 2
    s_add_u32 s47, s47, s3
    s_lshl_b32 s47, s47, 14
    s_mul_i32 s48, s3, 17408
    s_add_u32 m0, s48, 0
    s_nop 0
    buffer_load_dwordx4 v1, s[32:35], s47 offen lds
    s_add_u32 s47, s47, 1024
    s_add_u32 m0, s48, 1088
    s_nop 0
    buffer_load_dwordx4 v1, s[32:35], s47 offen lds
    s_add_u32 s47, s47, 1024
    s_add_u32 m0, s48, 2176
    s_nop 0
    buffer_load_dwordx4 v1, s[32:35], s47 offen lds
    s_add_u32 s47, s47, 1024
    s_add_u32 m0, s48, 3264
    s_nop 0
    buffer_load_dwordx4 v1, s[32:35], s47 offen lds
    s_add_u32 s47, s47, 1024
    s_add_u32 m0, s48, 4352
    s_nop 0
    buffer_load_dwordx4 v1, s[32:35], s47 offen lds
    s_add_u32 s47, s47, 1024
    s_add_u32 m0, s48, 5440
    s_nop 0
    buffer_load_dwordx4 v1, s[32:35], s47 offen lds
    s_add_u32 s47, s47, 1024
    s_add_u32 m0, s48, 6528
    s_nop 0
    buffer_load_dwordx4 v1, s[32:35], s47 offen lds
    s_add_u32 s47, s47, 1024
    s_add_u32 m0, s48, 7616
    s_nop 0
    buffer_load_dwordx4 v1, s[32:35], s47 offen lds
    s_add_u32 s47, s47, 1024
    s_add_u32 m0, s48, 8704
    s_nop 0
    buffer_load_dwordx4 v1, s[32:35], s47 offen lds
    s_add_u32 s47, s47, 1024
    s_add_u32 m0, s48, 9792
    s_nop 0
    buffer_load_dwordx4 v1, s[32:35], s47 offen lds
    s_add_u32 s47, s47, 1024
    s_add_u32 m0, s48, 10880
    s_nop 0
    buffer_load_dwordx4 v1, s[32:35], s47 offen lds
    s_add_u32 s47, s47, 1024
    s_add_u32 m0, s48, 11968
    s_nop 0
    buffer_load_dwordx4 v1, s[32:35], s47 offen lds
    s_add_u32 s47, s47, 1024
    s_add_u32 m0, s48, 13056
    s_nop 0
    buffer_load_dwordx4 v1, s[32:35], s47 offen lds
    s_add_u32 s47, s47, 1024
    s_add_u32 m0, s48, 14144
    s_nop 0
    buffer_load_dwordx4 v1, s[32:35], s47 offen lds
    s_add_u32 s47, s47, 1024
    s_add_u32 m0, s48, 15232
    s_nop 0
    buffer_load_dwordx4 v1, s[32:35], s47 offen lds
    s_add_u32 s47, s47, 1024
    s_add_u32 m0, s48, 16320
    s_nop 0
    buffer_load_dwordx4 v1, s[32:35], s47 offen lds
    s_add_u32 s47, s47, 1024
    v_lshrrev_b32 v32, 5, v0
    v_bfe_u32 v33, v0, 2, 2
    v_lshl_add_u32 v32, v32, 2, v33
    v_mul_u32_u24 v32, 1088, v32
    v_bfe_u32 v33, v0, 4, 1
    v_lshl_add_u32 v32, v33, 5, v32
    v_and_b32_e64 v33, 3, v0
    v_lshl_add_u32 v32, v33, 3, v32
    v_add_u32_e64 v32, s48, v32
    s_lshl_b32 s47, s46, 2
    s_add_u32 s47, s47, s3
    s_lshl_b32 s47, s47, 10
    s_add_u32 s47, s47, 0xe00000
    s_waitcnt vmcnt(0)
    ds_read_b64_tr_b16 v[36:37], v32 offset:0
    ds_read_b64_tr_b16 v[38:39], v32 offset:8704
    ds_read_b64_tr_b16 v[40:41], v32 offset:64
    ds_read_b64_tr_b16 v[42:43], v32 offset:8768
    ds_read_b64_tr_b16 v[44:45], v32 offset:128
    ds_read_b64_tr_b16 v[46:47], v32 offset:8832
    ds_read_b64_tr_b16 v[48:49], v32 offset:192
    ds_read_b64_tr_b16 v[50:51], v32 offset:8896
    s_waitcnt lgkmcnt(0)
    s_nop 0
    buffer_store_dwordx4 v[36:39], v20, s[28:31], s47 offen sc1
    s_add_u32 s47, s47, 147456
    buffer_store_dwordx4 v[40:43], v20, s[28:31], s47 offen sc1
    s_add_u32 s47, s47, 147456
    buffer_store_dwordx4 v[44:47], v20, s[28:31], s47 offen sc1
    s_add_u32 s47, s47, 147456
    buffer_store_dwordx4 v[48:51], v20, s[28:31], s47 offen sc1
    s_add_u32 s47, s47, 147456
    ds_read_b64_tr_b16 v[52:53], v32 offset:256
    ds_read_b64_tr_b16 v[54:55], v32 offset:8960
    ds_read_b64_tr_b16 v[56:57], v32 offset:320
    ds_read_b64_tr_b16 v[58:59], v32 offset:9024
    ds_read_b64_tr_b16 v[60:61], v32 offset:384
    ds_read_b64_tr_b16 v[62:63], v32 offset:9088
    ds_read_b64_tr_b16 v[64:65], v32 offset:448
    ds_read_b64_tr_b16 v[66:67], v32 offset:9152
    s_waitcnt lgkmcnt(0)
    s_nop 0
    buffer_store_dwordx4 v[52:55], v20, s[28:31], s47 offen sc1
    s_add_u32 s47, s47, 147456
    buffer_store_dwordx4 v[56:59], v20, s[28:31], s47 offen sc1
    s_add_u32 s47, s47, 147456
    buffer_store_dwordx4 v[60:63], v20, s[28:31], s47 offen sc1
    s_add_u32 s47, s47, 147456
    buffer_store_dwordx4 v[64:67], v20, s[28:31], s47 offen sc1
    s_add_u32 s47, s47, 147456
    ds_read_b64_tr_b16 v[68:69], v32 offset:512
    ds_read_b64_tr_b16 v[70:71], v32 offset:9216
    ds_read_b64_tr_b16 v[72:73], v32 offset:576
    ds_read_b64_tr_b16 v[74:75], v32 offset:9280
    ds_read_b64_tr_b16 v[76:77], v32 offset:640
    ds_read_b64_tr_b16 v[78:79], v32 offset:9344
    ds_read_b64_tr_b16 v[80:81], v32 offset:704
    ds_read_b64_tr_b16 v[82:83], v32 offset:9408
    s_waitcnt lgkmcnt(0)
    s_nop 0
    buffer_store_dwordx4 v[68:71], v20, s[28:31], s47 offen sc1
    s_add_u32 s47, s47, 147456
    buffer_store_dwordx4 v[72:75], v20, s[28:31], s47 offen sc1
    s_add_u32 s47, s47, 147456
    buffer_store_dwordx4 v[76:79], v20, s[28:31], s47 offen sc1
    s_add_u32 s47, s47, 147456
    buffer_store_dwordx4 v[80:83], v20, s[28:31], s47 offen sc1
    s_add_u32 s47, s47, 147456
    ds_read_b64_tr_b16 v[84:85], v32 offset:768
    ds_read_b64_tr_b16 v[86:87], v32 offset:9472
    ds_read_b64_tr_b16 v[88:89], v32 offset:832
    ds_read_b64_tr_b16 v[90:91], v32 offset:9536
    ds_read_b64_tr_b16 v[92:93], v32 offset:896
    ds_read_b64_tr_b16 v[94:95], v32 offset:9600
    ds_read_b64_tr_b16 v[96:97], v32 offset:960
    ds_read_b64_tr_b16 v[98:99], v32 offset:9664
    s_waitcnt lgkmcnt(0)
    s_nop 0
    buffer_store_dwordx4 v[84:87], v20, s[28:31], s47 offen sc1
    s_add_u32 s47, s47, 147456
    buffer_store_dwordx4 v[88:91], v20, s[28:31], s47 offen sc1
    s_add_u32 s47, s47, 147456
    buffer_store_dwordx4 v[92:95], v20, s[28:31], s47 offen sc1
    s_add_u32 s47, s47, 147456
    buffer_store_dwordx4 v[96:99], v20, s[28:31], s47 offen sc1
    s_add_u32 s47, s47, 147456
L_noe:
    s_add_u32 s45, s25, 0x200000
    buffer_load_dwordx4 v[144:147], v3, s[28:31], s45 offen sc1
    v_accvgpr_mov_b32 a224, a0
    v_accvgpr_mov_b32 a225, a1
    s_add_u32 s45, s25, 0x220000
    buffer_load_dwordx4 v[148:151], v3, s[28:31], s45 offen sc1
    v_accvgpr_mov_b32 a226, a2
    v_accvgpr_mov_b32 a227, a3
    buffer_load_dword v152, v152, s[28:31], s9 offen sc1
    v_accvgpr_mov_b32 a232, a4
    v_accvgpr_mov_b32 a233, a5
    s_sub_u32 s45, s8, 0x4000
    buffer_load_dword v153, v4, s[28:31], s45 offen offset:0 sc1
    buffer_load_dword v154, v4, s[28:31], s45 offen offset:128 sc1
    v_accvgpr_mov_b32 a234, a6
    v_accvgpr_mov_b32 a235, a7
    buffer_load_dwordx4 a[128:131], v12, s[28:31], s54 offen offset:0 sc1
    v_accvgpr_mov_b32 a240, a8
    v_accvgpr_mov_b32 a241, a9
    buffer_load_dwordx4 a[132:135], v12, s[28:31], s55 offen offset:0 sc1
    v_accvgpr_mov_b32 a242, a10
    v_accvgpr_mov_b32 a243, a11
    buffer_load_dwordx4 a[136:139], v12, s[28:31], s54 offen offset:1024 sc1
    v_accvgpr_mov_b32 a248, a12
    v_accvgpr_mov_b32 a249, a13
    buffer_load_dwordx4 a[140:143], v12, s[28:31], s55 offen offset:1024 sc1
    v_accvgpr_mov_b32 a250, a14
    v_accvgpr_mov_b32 a251, a15
    v_accvgpr_read_b32 v160, a16
    buffer_load_dwordx4 a[144:147], v12, s[28:31], s54 offen offset:2048 sc1
    v_accvgpr_read_b32 v161, a17
    v_accvgpr_read_b32 v162, a18
    buffer_load_dwordx4 a[148:151], v12, s[28:31], s55 offen offset:2048 sc1
    v_accvgpr_read_b32 v163, a19
    v_accvgpr_read_b32 v168, a20
    buffer_load_dwordx4 a[152:155], v12, s[28:31], s54 offen offset:3072 sc1
    v_accvgpr_read_b32 v169, a21
    v_accvgpr_read_b32 v170, a22
    buffer_load_dwordx4 a[156:159], v12, s[28:31], s55 offen offset:3072 sc1
    v_accvgpr_read_b32 v171, a23
    v_accvgpr_read_b32 v176, a24
    s_add_u32 s54, s54, 4096
    buffer_load_dwordx4 a[160:163], v12, s[28:31], s54 offen offset:0 sc1
    v_accvgpr_read_b32 v177, a25
    v_accvgpr_read_b32 v178, a26
    s_add_u32 s55, s55, 4096
    buffer_load_dwordx4 a[164:167], v12, s[28:31], s55 offen offset:0 sc1
    v_accvgpr_read_b32 v179, a27
    v_accvgpr_read_b32 v184, a28
    buffer_load_dwordx4 a[168:171], v12, s[28:31], s54 offen offset:1024 sc1
    v_accvgpr_read_b32 v185, a29
    v_accvgpr_read_b32 v186, a30
    v_accvgpr_read_b32 v187, a31
    buffer_load_dwordx4 a[172:175], v12, s[28:31], s55 offen offset:1024 sc1
    v_accvgpr_mov_b32 a228, a32
    v_accvgpr_mov_b32 a229, a33
    buffer_load_dwordx4 a[176:179], v12, s[28:31], s54 offen offset:2048 sc1
    v_accvgpr_mov_b32 a230, a34
    v_accvgpr_mov_b32 a231, a35
    buffer_load_dwordx4 a[180:183], v12, s[28:31], s55 offen offset:2048 sc1
    v_accvgpr_mov_b32 a236, a36
    v_accvgpr_mov_b32 a237, a37
    buffer_load_dwordx4 a[184:187], v12, s[28:31], s54 offen offset:3072 sc1
    v_accvgpr_mov_b32 a238, a38
    v_accvgpr_mov_b32 a239, a39
    buffer_load_dwordx4 a[188:191], v12, s[28:31], s55 offen offset:3072 sc1
    v_accvgpr_mov_b32 a244, a40
    v_accvgpr_mov_b32 a245, a41
    s_add_u32 s54, s54, 4096
    buffer_load_dwordx4 a[192:195], v12, s[28:31], s54 offen offset:0 sc1
    v_accvgpr_mov_b32 a246, a42
    v_accvgpr_mov_b32 a247, a43
    s_add_u32 s55, s55, 4096
    buffer_load_dwordx4 a[196:199], v12, s[28:31], s55 offen offset:0 sc1
    v_accvgpr_mov_b32 a252, a44
    v_accvgpr_mov_b32 a253, a45
    buffer_load_dwordx4 a[200:203], v12, s[28:31], s54 offen offset:1024 sc1
    v_accvgpr_mov_b32 a254, a46
    v_accvgpr_mov_b32 a255, a47
    v_accvgpr_read_b32 v164, a48
    buffer_load_dwordx4 a[204:207], v12, s[28:31], s55 offen offset:1024 sc1
    v_accvgpr_read_b32 v165, a49
    v_accvgpr_read_b32 v166, a50
    buffer_load_dwordx4 a[208:211], v12, s[28:31], s54 offen offset:2048 sc1
    v_accvgpr_read_b32 v167, a51
    v_accvgpr_read_b32 v172, a52
    buffer_load_dwordx4 a[212:215], v12, s[28:31], s55 offen offset:2048 sc1
    v_accvgpr_read_b32 v173, a53
    v_accvgpr_read_b32 v174, a54
    buffer_load_dwordx4 a[216:219], v12, s[28:31], s54 offen offset:3072 sc1
    v_accvgpr_read_b32 v175, a55
    v_accvgpr_read_b32 v180, a56
    buffer_load_dwordx4 a[220:223], v12, s[28:31], s55 offen offset:3072 sc1
    v_accvgpr_read_b32 v181, a57
    v_accvgpr_read_b32 v182, a58
    s_add_u32 s54, s54, 4096
    v_accvgpr_read_b32 v183, a59
    v_accvgpr_read_b32 v188, a60
    s_add_u32 s55, s55, 4096
    v_accvgpr_read_b32 v189, a61
    v_accvgpr_read_b32 v190, a62
    v_accvgpr_read_b32 v191, a63
    v_accvgpr_read_b32 v192, a64
    v_accvgpr_read_b32 v193, a65
    v_accvgpr_read_b32 v194, a66
    v_accvgpr_read_b32 v195, a67
    v_accvgpr_read_b32 v200, a68
    v_accvgpr_read_b32 v201, a69
    v_accvgpr_read_b32 v202, a70
    v_accvgpr_read_b32 v203, a71
    v_accvgpr_read_b32 v208, a72
    v_accvgpr_read_b32 v209, a73
    v_accvgpr_read_b32 v210, a74
    v_accvgpr_read_b32 v211, a75
    s_add_u32 s54, s54, 4096
L_hop4:
    s_cbranch_execz HOPRET_1
    s_nop 0
    v_accvgpr_read_b32 v216, a76
    v_accvgpr_read_b32 v217, a77
    s_add_u32 s55, s55, 4096
    v_accvgpr_read_b32 v218, a78
    v_accvgpr_read_b32 v219, a79
    v_accvgpr_read_b32 v224, a80
    v_accvgpr_read_b32 v225, a81
    v_accvgpr_read_b32 v226, a82
    v_accvgpr_read_b32 v227, a83
    v_accvgpr_read_b32 v232, a84
    v_accvgpr_read_b32 v233, a85
    v_accvgpr_read_b32 v234, a86
    v_accvgpr_read_b32 v235, a87
    v_accvgpr_read_b32 v240, a88
    v_accvgpr_read_b32 v241, a89
    v_accvgpr_read_b32 v242, a90
    v_accvgpr_read_b32 v243, a91
    v_accvgpr_read_b32 v248, a92
    s_add_u32 s54, s54, 4096
    v_accvgpr_read_b32 v249, a93
    v_accvgpr_read_b32 v250, a94
    v_accvgpr_read_b32 v251, a95
    s_add_u32 s55, s55, 4096
    v_accvgpr_read_b32 v196, a96
    v_accvgpr_read_b32 v197, a97
    v_accvgpr_read_b32 v198, a98
    v_accvgpr_read_b32 v199, a99
    v_accvgpr_read_b32 v204, a100
    v_accvgpr_read_b32 v205, a101
    v_accvgpr_read_b32 v206, a102
    v_accvgpr_read_b32 v207, a103
    v_accvgpr_read_b32 v212, a104
    v_accvgpr_read_b32 v213, a105
    v_accvgpr_read_b32 v214, a106
    v_accvgpr_read_b32 v215, a107
    v_accvgpr_read_b32 v220, a108
    v_accvgpr_read_b32 v221, a109
    s_add_u32 s54, s54, 4096
    v_accvgpr_read_b32 v222, a110
    v_accvgpr_read_b32 v223, a111
    v_accvgpr_read_b32 v228, a112
    s_add_u32 s55, s55, 4096
    v_accvgpr_read_b32 v229, a113
    v_accvgpr_read_b32 v230, a114
    v_accvgpr_read_b32 v231, a115
    v_accvgpr_read_b32 v236, a116
    v_accvgpr_read_b32 v237, a117
    v_accvgpr_read_b32 v238, a118
    v_accvgpr_read_b32 v239, a119
    v_accvgpr_read_b32 v244, a120
    v_accvgpr_read_b32 v245, a121
    v_accvgpr_read_b32 v246, a122
    v_accvgpr_read_b32 v247, a123
    v_accvgpr_read_b32 v252, a124
    v_accvgpr_read_b32 v253, a125
    v_accvgpr_read_b32 v254, a126
    v_accvgpr_read_b32 v255, a127
    s_waitcnt vmcnt(0)
    s_and_b32 s45, s43, 31
    s_lshl_b32 s45, s45, 8
    v_lshl_add_u32 v32, v0, 13, s45
    s_barrier
    s_cmp_lg_u32 s3, 0
    s_cbranch_scc1 Larr_26
    v_mov_b32_e64 v13, 1
    s_mov_b64 exec, 0xff
    buffer_atomic_add v13, v32, s[28:31], s62 offen offset:16 sc1
    s_mov_b64 exec, -1
Larr_26:
    v_mov_b32 v13, 0
    s_branch L_g1_join0
L_layer1:
    buffer_load_dwordx4 a[128:131], v12, s[28:31], s54 offen offset:0 sc1
    s_lshr_b32 s45, s3, 1
    s_lshl_b32 s45, s45, 10
    buffer_load_dwordx4 a[132:135], v12, s[28:31], s55 offen offset:0 sc1
    s_and_b32 s46, s3, 1
    s_lshl_b32 s46, s46, 3
    s_add_u32 s45, s45, s46
    buffer_load_dwordx4 a[136:139], v12, s[28:31], s54 offen offset:1024 sc1
    v_add_u32 v8, s45, v1
    v_lshrrev_b32 v9, 2, v3
    v_xor_b32_e64 v9, v9, v7
    buffer_load_dwordx4 a[140:143], v12, s[28:31], s55 offen offset:1024 sc1
    v_lshlrev_b32 v9, 3, v9
    v_lshl_add_u32 v9, v3, 5, v9
    s_lshl_b32 s45, s3, 9
    buffer_load_dwordx4 a[144:147], v12, s[28:31], s54 offen offset:2048 sc1
    s_add_u32 s45, s45, 8192
    v_add_u32 v9, s45, v9
    v_and_b32 v10, 3, v0
    buffer_load_dwordx4 a[148:151], v12, s[28:31], s55 offen offset:2048 sc1
    v_xor_b32 v10, v10, v7
    v_lshlrev_b32 v10, 3, v10
    v_lshrrev_b32_e64 v11, 2, v0
    buffer_load_dwordx4 a[152:155], v12, s[28:31], s54 offen offset:3072 sc1
    v_lshl_add_u32 v10, v11, 5, v10
    v_add_u32 v10, 8192, v10
    v_lshrrev_b32_e64 v11, 5, v0
    buffer_load_dwordx4 a[156:159], v12, s[28:31], s55 offen offset:3072 sc1
    v_lshlrev_b32 v2, 5, v11
    v_and_b32 v11, 1, v0
    v_lshl_add_u32 v2, v11, 4, v2
    s_add_u32 s54, s54, 4096
    buffer_load_dwordx4 a[160:163], v12, s[28:31], s54 offen offset:0 sc1
    v_bfe_u32 v11, v0, 1, 1
    v_lshl_add_u32 v5, v11, 6, v2
    v_bfe_u32 v11, v0, 2, 3
    s_add_u32 s55, s55, 4096
    buffer_load_dwordx4 a[164:167], v12, s[28:31], s55 offen offset:0 sc1
    v_lshl_add_u32 v5, v11, 15, v5
    v_bfe_u32 v11, v0, 1, 4
    v_lshl_add_u32 v2, v11, 15, v2
    buffer_load_dwordx4 a[168:171], v12, s[28:31], s54 offen offset:1024 sc1
    s_and_b32 s46, s26, 1
    s_lshr_b32 s45, s26, 2
    s_lshl_b32 s45, s45, 1
    buffer_load_dwordx4 a[172:175], v12, s[28:31], s55 offen offset:1024 sc1
    s_add_u32 s46, s46, s45
    s_and_b32 s45, s26, 2
    s_lshl_b32 s45, s45, 1
    buffer_load_dwordx4 a[176:179], v12, s[28:31], s54 offen offset:2048 sc1
    s_add_u32 s46, s46, s45
    s_lshl_b32 s46, s46, 5
    s_add_u32 s46, s46, s27
    s_lshl_b32 s12, s3, 19
    s_add_u32 s12, s12, 0x400000
    s_lshl_b32 s45, s3, 11
    s_lshr_b32 s49, s46, 6
    s_lshl_b32 s49, s49, 4
    s_and_b32 s57, s46, 15
    s_add_u32 s49, s49, s57
    s_bfe_u32 s57, s46, 0x10004
    s_lshl_b32 s57, s57, 7
    s_add_u32 s49, s49, s57
    s_sub_u32 s57, 256, s49
    s_bitcmp1_b32 s46, 5
    s_cselect_b32 s49, s57, s49
    s_cmp_eq_u32 s46, 0
    s_cselect_b32 s49, 256, s49
    s_cmp_eq_u32 s46, 32
    s_cselect_b32 s49, 64, s49
    s_cmp_eq_u32 s46, 48
    s_cselect_b32 s49, 192, s49
    s_sub_u32 s49, s49, 1
    s_lshl_b32 s49, s49, 13
    s_add_u32 s49, s49, s45
    s_add_u32 s49, s49, 0x800000
    s_lshl_b32 s57, s46, 7
    s_add_u32 s12, s12, s57
    s_add_u32 s13, s12, 262144
    s_cmp_eq_u32 s46, 0
    s_cselect_b32 s58, 0, 1.0
    s_mov_b32 s59, s58
    v_mov_b32 v11, 0x4227c5ac
    s_lshr_b32 s57, s26, 2
    s_lshl_b32 s57, s57, 13
    s_add_u32 s57, s57, s45
    s_add_u32 s57, s57, 0x1088000
    s_and_b32 s47, s3, 1
    s_lshl_b32 s47, s47, 20
    s_lshr_b32 s45, s3, 1
    s_xor_b32 s45, s45, 1
    s_lshl_b32 s45, s45, 13
    s_add_u32 s47, s47, s45
    s_lshr_b32 s45, s46, 7
    s_lshl_b32 s45, s45, 14
    s_add_u32 s47, s47, s45
    s_and_b32 s45, s46, 127
    s_lshl_b32 s45, s45, 6
    s_add_u32 s47, s47, s45
    s_add_u32 s47, s47, 0x600000
    s_add_u32 s48, s47, 524288
    s_lshl_b32 s45, s3, 12
    s_add_u32 s45, s45, 134144
    v_add_u32_e64 v4, s45, v1
    ds_read_b128 v[192:195], v4 offset:2048
    ds_read_b128 v[196:199], v4 offset:3072
    s_waitcnt lgkmcnt(0)
    v_lshlrev_b32 v80, 16, v192
    v_and_b32 v88, 0xffff0000, v192
    v_lshlrev_b32_e64 v81, 16, v193
    v_and_b32 v89, 0xffff0000, v193
    v_lshlrev_b32_e64 v82, 16, v194
    v_and_b32 v90, 0xffff0000, v194
    v_lshlrev_b32_e64 v83, 16, v195
    v_and_b32 v91, 0xffff0000, v195
    v_lshlrev_b32_e64 v84, 16, v196
    v_and_b32 v92, 0xffff0000, v196
    v_lshlrev_b32_e64 v85, 16, v197
    v_and_b32 v93, 0xffff0000, v197
    v_lshlrev_b32_e64 v86, 16, v198
    v_and_b32 v94, 0xffff0000, v198
    v_lshlrev_b32_e64 v87, 16, v199
    v_and_b32 v95, 0xffff0000, v199
    s_cmp_eq_u32 s3, 0
    s_cbranch_scc1 HOPEND_2
    s_mov_b64 exec, 0
    s_cmp_eq_u32 s3, 1
    s_cbranch_scc1 HOPRET_2
    s_cmp_eq_u32 s3, 2
    s_cbranch_scc1 L_hop8
    s_branch L_hop7
HOPRET_2:
    s_mov_b64 exec, -1
HOPEND_2:
    s_cmp_lg_u32 s3, 0
    s_cbranch_scc1 Lskip_27
    s_mov_b32 s60, 0
Lpoll_28:
    buffer_load_dword v13, v15, s[28:31], s62 offen offset:8 sc1
    s_waitcnt vmcnt(0)
    v_cmp_ne_u32 vcc, 8, v13
    s_add_u32 s60, s60, 1
    s_cbranch_vccz Lskip_27
    s_cmp_lt_u32 s60, s61
    s_cbranch_scc1 Lpoll_28
    s_mov_b32 s61, 1
Lskip_27:
    s_barrier
    buffer_load_dwordx4 v[184:187], v5, s[28:31], s12 offen sc1
    buffer_load_dwordx4 v[188:191], v5, s[28:31], s13 offen sc1
    buffer_load_dwordx4 v[112:115], v1, s[28:31], s57 offen sc1
    buffer_load_dwordx4 v[116:119], v1, s[28:31], s57 offen offset:1024 sc1
    s_waitcnt vmcnt(2)
    s_waitcnt vmcnt(0)
    v_fmamk_f32 v112, v112, 0x46000000, v11
    v_fmamk_f32 v113, v113, 0x46000000, v11
    v_fmamk_f32 v114, v114, 0x46000000, v11
    v_fmamk_f32 v115, v115, 0x46000000, v11
    v_fmamk_f32 v116, v116, 0x46000000, v11
    v_fmamk_f32 v117, v117, 0x46000000, v11
    v_fmamk_f32 v118, v118, 0x46000000, v11
    v_fmamk_f32 v119, v119, 0x46000000, v11
    v_rsq_f32 v112, v112
    v_rsq_f32 v113, v113
    v_rsq_f32 v114, v114
    v_rsq_f32 v115, v115
    v_rsq_f32 v116, v116
    v_rsq_f32 v117, v117
    v_rsq_f32 v118, v118
    v_rsq_f32 v119, v119
    v_pk_mul_f32 v[120:121], v[112:113], s[58:59]
    v_pk_mul_f32 v[122:123], v[114:115], s[58:59]
    v_pk_mul_f32 v[124:125], v[116:117], s[58:59]
    v_pk_mul_f32 v[126:127], v[118:119], s[58:59]
    s_waitcnt vmcnt(2)
    v_permlane32_swap_b32 v184, v188
    v_permlane32_swap_b32 v185, v189
    v_permlane32_swap_b32 v186, v190
    v_permlane32_swap_b32 v187, v191
    v_lshlrev_b32 v96, 16, v184
    v_and_b32 v97, 0xffff0000, v184
    v_lshlrev_b32_e64 v98, 16, v185
    v_and_b32 v99, 0xffff0000, v185
    v_pk_mul_f32 v[160:161], v[96:97], v[112:113]
    v_pk_mul_f32 v[162:163], v[98:99], v[114:115]
    v_cvt_pk_bf16_f32 v176, v160, v161
    v_cvt_pk_bf16_f32 v177, v162, v163
    ds_write_b64 v8, v[176:177] offset:0
    v_lshlrev_b32_e64 v100, 16, v186
    v_and_b32 v101, 0xffff0000, v186
    v_lshlrev_b32_e64 v102, 16, v187
    v_and_b32 v103, 0xffff0000, v187
    v_pk_mul_f32 v[164:165], v[100:101], v[116:117]
    v_pk_mul_f32 v[166:167], v[102:103], v[118:119]
    v_cvt_pk_bf16_f32 v178, v164, v165
    v_cvt_pk_bf16_f32 v179, v166, v167
    ds_write_b64 v8, v[178:179] offset:2048
    v_lshlrev_b32_e64 v104, 16, v188
    v_and_b32 v105, 0xffff0000, v188
    v_lshlrev_b32_e64 v106, 16, v189
    v_and_b32 v107, 0xffff0000, v189
    v_pk_mul_f32 v[168:169], v[104:105], v[120:121]
    v_pk_mul_f32 v[170:171], v[106:107], v[122:123]
    v_cvt_pk_bf16_f32 v180, v168, v169
    v_cvt_pk_bf16_f32 v181, v170, v171
    ds_write_b64 v8, v[180:181] offset:4096
    v_lshlrev_b32_e64 v108, 16, v190
    v_and_b32 v109, 0xffff0000, v190
    v_lshlrev_b32_e64 v110, 16, v191
    v_and_b32 v111, 0xffff0000, v191
    v_pk_mul_f32 v[172:173], v[108:109], v[124:125]
    v_pk_mul_f32 v[174:175], v[110:111], v[126:127]
    v_cvt_pk_bf16_f32 v182, v172, v173
    v_cvt_pk_bf16_f32 v183, v174, v175
    ds_write_b64 v8, v[182:183] offset:6144
    s_waitcnt lgkmcnt(0)
    s_barrier
    buffer_load_dwordx4 a[180:183], v12, s[28:31], s55 offen offset:2048 sc1
    ds_read_b128 v[112:115], v1 offset:0
    ds_read_b128 v[116:119], v1 offset:4096
    ds_read_b128 v[120:123], v1 offset:1024
    ds_read_b128 v[124:127], v1 offset:5120
    ds_read_b128 v[128:131], v1 offset:2048
    ds_read_b128 v[132:135], v1 offset:6144
    ds_read_b128 v[136:139], v1 offset:3072
    buffer_load_dwordx4 a[184:187], v12, s[28:31], s54 offen offset:3072 sc1
    ds_read_b128 v[140:143], v1 offset:7168
    s_waitcnt lgkmcnt(6)
    v_mfma_f32_16x16x32_bf16 v[144:147], v[112:115], v[16:19], 0
    v_mfma_f32_16x16x32_bf16 v[152:155], v[116:119], v[16:19], 0
    v_mfma_f32_16x16x32_bf16 v[144:147], v[116:119], v[24:27], v[144:147]
    v_mfma_f32_16x16x32_bf16 v[152:155], v[112:115], v[32:35], v[152:155]
    s_waitcnt lgkmcnt(4)
    buffer_load_dwordx4 a[188:191], v12, s[28:31], s55 offen offset:3072 sc1
    v_mfma_f32_16x16x32_bf16 v[144:147], v[120:123], v[20:23], v[144:147]
    v_mfma_f32_16x16x32_bf16 v[152:155], v[124:127], v[20:23], v[152:155]
    v_mfma_f32_16x16x32_bf16 v[144:147], v[124:127], v[28:31], v[144:147]
    v_mfma_f32_16x16x32_bf16 v[152:155], v[120:123], v[36:39], v[152:155]
    s_waitcnt lgkmcnt(2)
    v_mfma_f32_16x16x32_bf16 v[148:151], v[128:131], v[16:19], 0
    v_mfma_f32_16x16x32_bf16 v[156:159], v[132:135], v[16:19], 0
    v_mfma_f32_16x16x32_bf16 v[148:151], v[132:135], v[24:27], v[148:151]
    s_add_u32 s54, s54, 4096
    buffer_load_dwordx4 a[192:195], v12, s[28:31], s54 offen offset:0 sc1
    v_mfma_f32_16x16x32_bf16 v[156:159], v[128:131], v[32:35], v[156:159]
    s_waitcnt lgkmcnt(0)
    v_mfma_f32_16x16x32_bf16 v[148:151], v[136:139], v[20:23], v[148:151]
    v_mfma_f32_16x16x32_bf16 v[156:159], v[140:143], v[20:23], v[156:159]
    v_mfma_f32_16x16x32_bf16 v[148:151], v[140:143], v[28:31], v[148:151]
    v_mfma_f32_16x16x32_bf16 v[156:159], v[136:139], v[36:39], v[156:159]
    v_pk_mul_f32 v[160:161], v[144:145], v[64:65]
    s_add_u32 s55, s55, 4096
    buffer_load_dwordx4 a[196:199], v12, s[28:31], s55 offen offset:0 sc1
    v_pk_mul_f32 v[168:169], v[152:153], v[64:65]
    v_pk_fma_f32 v[160:161], v[152:153], v[72:73], v[160:161]
    v_pk_fma_f32 v[168:169], v[144:145], v[72:73], v[168:169] neg_lo:[0,1,0] neg_hi:[0,1,0]
    v_cvt_pk_bf16_f32 v176, v160, v161
    v_cvt_pk_bf16_f32 v180, v168, v169
    v_pk_mul_f32 v[162:163], v[146:147], v[66:67]
    v_pk_mul_f32 v[170:171], v[154:155], v[66:67]
    v_pk_fma_f32 v[162:163], v[154:155], v[74:75], v[162:163]
    buffer_load_dwordx4 a[200:203], v12, s[28:31], s54 offen offset:1024 sc1
    v_pk_fma_f32 v[170:171], v[146:147], v[74:75], v[170:171] neg_lo:[0,1,0] neg_hi:[0,1,0]
    v_cvt_pk_bf16_f32 v177, v162, v163
    v_cvt_pk_bf16_f32 v181, v170, v171
    v_pk_mul_f32 v[164:165], v[148:149], v[68:69]
    v_pk_mul_f32 v[172:173], v[156:157], v[68:69]
    v_pk_fma_f32 v[164:165], v[156:157], v[76:77], v[164:165]
    v_pk_fma_f32 v[172:173], v[148:149], v[76:77], v[172:173] neg_lo:[0,1,0] neg_hi:[0,1,0]
    buffer_load_dwordx4 a[204:207], v12, s[28:31], s55 offen offset:1024 sc1
    v_cvt_pk_bf16_f32 v178, v164, v165
    v_cvt_pk_bf16_f32 v182, v172, v173
    v_pk_mul_f32 v[166:167], v[150:151], v[70:71]
    v_pk_mul_f32 v[174:175], v[158:159], v[70:71]
    v_pk_fma_f32 v[166:167], v[158:159], v[78:79], v[166:167]
    v_pk_fma_f32 v[174:175], v[150:151], v[78:79], v[174:175] neg_lo:[0,1,0] neg_hi:[0,1,0]
    v_cvt_pk_bf16_f32 v179, v166, v167
    buffer_load_dwordx4 a[208:211], v12, s[28:31], s54 offen offset:2048 sc1
    v_cvt_pk_bf16_f32 v183, v174, v175
    v_mfma_f32_16x16x32_bf16 v[144:147], v[40:43], v[176:179], 0
    s_nop 0
    v_mfma_f32_16x16x32_bf16 v[152:155], v[40:43], v[180:183], 0
    v_mfma_f32_16x16x32_bf16 v[144:147], v[48:51], v[180:183], v[144:147]
    v_mfma_f32_16x16x32_bf16 v[152:155], v[56:59], v[176:179], v[152:155]
    v_mfma_f32_16x16x32_bf16 v[148:151], v[44:47], v[176:179], 0
    v_mfma_f32_16x16x32_bf16 v[156:159], v[44:47], v[180:183], 0
    v_mfma_f32_16x16x32_bf16 v[148:151], v[52:55], v[180:183], v[148:151]
    buffer_load_dwordx4 a[212:215], v12, s[28:31], s55 offen offset:2048 sc1
    v_mfma_f32_16x16x32_bf16 v[156:159], v[60:63], v[176:179], v[156:159]
    s_nop 1
    v_pk_mul_f32 v[160:161], v[144:145], v[80:81]
    v_pk_mul_f32 v[168:169], v[152:153], v[80:81]
    v_pk_fma_f32 v[160:161], v[152:153], v[88:89], v[160:161] neg_lo:[0,1,0] neg_hi:[0,1,0]
    v_pk_fma_f32 v[168:169], v[144:145], v[88:89], v[168:169]
    v_cvt_pk_bf16_f32 v176, v160, v161
    v_cvt_pk_bf16_f32 v180, v168, v169
    buffer_load_dwordx4 a[216:219], v12, s[28:31], s54 offen offset:3072 sc1
    v_pk_mul_f32 v[162:163], v[146:147], v[82:83]
    v_pk_mul_f32 v[170:171], v[154:155], v[82:83]
    v_pk_fma_f32 v[162:163], v[154:155], v[90:91], v[162:163] neg_lo:[0,1,0] neg_hi:[0,1,0]
    v_pk_fma_f32 v[170:171], v[146:147], v[90:91], v[170:171]
    v_cvt_pk_bf16_f32 v177, v162, v163
    v_cvt_pk_bf16_f32 v181, v170, v171
    v_pk_mul_f32 v[164:165], v[148:149], v[84:85]
    v_pk_mul_f32 v[172:173], v[156:157], v[84:85]
    buffer_load_dwordx4 a[220:223], v12, s[28:31], s55 offen offset:3072 sc1
    v_pk_fma_f32 v[164:165], v[156:157], v[92:93], v[164:165] neg_lo:[0,1,0] neg_hi:[0,1,0]
    v_pk_fma_f32 v[172:173], v[148:149], v[92:93], v[172:173]
    v_cvt_pk_bf16_f32 v178, v164, v165
    v_cvt_pk_bf16_f32 v182, v172, v173
    v_pk_mul_f32 v[166:167], v[150:151], v[86:87]
    v_pk_mul_f32 v[174:175], v[158:159], v[86:87]
    v_pk_fma_f32 v[166:167], v[158:159], v[94:95], v[166:167] neg_lo:[0,1,0] neg_hi:[0,1,0]
    s_add_u32 s54, s54, 4096
    buffer_load_dwordx4 a[224:227], v12, s[28:31], s54 offen offset:0 sc1
    v_pk_fma_f32 v[174:175], v[150:151], v[94:95], v[174:175]
    v_cvt_pk_bf16_f32 v179, v166, v167
    v_cvt_pk_bf16_f32 v183, v174, v175
    s_nop 0
    s_nop 0
    v_mfma_f32_16x16x32_bf16 v[144:147], v[40:43], v[176:179], 0
    v_mfma_f32_16x16x32_bf16 v[152:155], v[40:43], v[180:183], 0
    v_mfma_f32_16x16x32_bf16 v[144:147], v[56:59], v[180:183], v[144:147]
    v_mfma_f32_16x16x32_bf16 v[152:155], v[48:51], v[176:179], v[152:155]
    v_mfma_f32_16x16x32_bf16 v[148:151], v[44:47], v[176:179], 0
    s_add_u32 s55, s55, 4096
    buffer_load_dwordx4 a[228:231], v12, s[28:31], s55 offen offset:0 sc1
    v_mfma_f32_16x16x32_bf16 v[156:159], v[44:47], v[180:183], 0
    v_mfma_f32_16x16x32_bf16 v[148:151], v[60:63], v[180:183], v[148:151]
    v_mfma_f32_16x16x32_bf16 v[156:159], v[52:55], v[176:179], v[156:159]
    s_nop 0
    s_nop 0
    v_pk_mul_f32 v[160:161], v[144:145], v[64:65]
    v_pk_mul_f32 v[168:169], v[152:153], v[64:65]
    v_pk_fma_f32 v[160:161], v[152:153], v[72:73], v[160:161] neg_lo:[0,1,0] neg_hi:[0,1,0]
    v_pk_fma_f32 v[168:169], v[144:145], v[72:73], v[168:169]
    buffer_load_dwordx4 a[232:235], v12, s[28:31], s54 offen offset:1024 sc1
    v_cvt_pk_bf16_f32 v176, v160, v161
    v_cvt_pk_bf16_f32 v180, v168, v169
    v_pk_mul_f32 v[162:163], v[146:147], v[66:67]
    v_pk_mul_f32 v[170:171], v[154:155], v[66:67]
    v_pk_fma_f32 v[162:163], v[154:155], v[74:75], v[162:163] neg_lo:[0,1,0] neg_hi:[0,1,0]
    v_pk_fma_f32 v[170:171], v[146:147], v[74:75], v[170:171]
    v_cvt_pk_bf16_f32 v177, v162, v163
    buffer_load_dwordx4 a[236:239], v12, s[28:31], s55 offen offset:1024 sc1
    v_cvt_pk_bf16_f32 v181, v170, v171
    v_pk_mul_f32 v[164:165], v[148:149], v[68:69]
    v_pk_mul_f32 v[172:173], v[156:157], v[68:69]
    v_pk_fma_f32 v[164:165], v[156:157], v[76:77], v[164:165] neg_lo:[0,1,0] neg_hi:[0,1,0]
    v_pk_fma_f32 v[172:173], v[148:149], v[76:77], v[172:173]
    v_cvt_pk_bf16_f32 v178, v164, v165
    v_cvt_pk_bf16_f32 v182, v172, v173
    v_pk_mul_f32 v[166:167], v[150:151], v[70:71]
    buffer_load_dwordx4 a[240:243], v12, s[28:31], s54 offen offset:2048 sc1
    v_pk_mul_f32 v[174:175], v[158:159], v[70:71]
    v_pk_fma_f32 v[166:167], v[158:159], v[78:79], v[166:167] neg_lo:[0,1,0] neg_hi:[0,1,0]
    v_pk_fma_f32 v[174:175], v[150:151], v[78:79], v[174:175]
    v_cvt_pk_bf16_f32 v179, v166, v167
    v_cvt_pk_bf16_f32 v183, v174, v175
    ds_write_b64 v9, v[176:177] offset:0
    ds_write_b64 v9, v[178:179] offset:2048
    buffer_load_dwordx4 a[244:247], v12, s[28:31], s55 offen offset:2048 sc1
    ds_write_b64 v9, v[180:181] offset:4096
    ds_write_b64 v9, v[182:183] offset:6144
    s_waitcnt lgkmcnt(0)
    s_barrier
    ds_read_b64_tr_b16 v[112:113], v10 offset:0
    ds_read_b64_tr_b16 v[114:115], v10 offset:512
    ds_read_b64_tr_b16 v[116:117], v10 offset:4096
    ds_read_b64_tr_b16 v[118:119], v10 offset:4608
    buffer_load_dwordx4 a[248:251], v12, s[28:31], s54 offen offset:3072 sc1
    ds_read_b64_tr_b16 v[120:121], v10 offset:1024
    ds_read_b64_tr_b16 v[122:123], v10 offset:1536
    ds_read_b64_tr_b16 v[124:125], v10 offset:5120
    ds_read_b64_tr_b16 v[126:127], v10 offset:5632
    ds_read_b64_tr_b16 v[128:129], v10 offset:2048
    ds_read_b64_tr_b16 v[130:131], v10 offset:2560
    ds_read_b64_tr_b16 v[132:133], v10 offset:6144
    buffer_load_dwordx4 a[252:255], v12, s[28:31], s55 offen offset:3072 sc1
    ds_read_b64_tr_b16 v[134:135], v10 offset:6656
    s_waitcnt lgkmcnt(8)
    s_nop 0
    v_mfma_f32_16x16x32_bf16 v[96:99], v[16:19], v[112:115], v[96:99]
    v_mfma_f32_16x16x32_bf16 v[104:107], v[16:19], v[116:119], v[104:107]
    ds_read_b64_tr_b16 v[136:137], v10 offset:3072
    ds_read_b64_tr_b16 v[138:139], v10 offset:3584
    ds_read_b64_tr_b16 v[140:141], v10 offset:7168
    ds_read_b64_tr_b16 v[142:143], v10 offset:7680
    v_mfma_f32_16x16x32_bf16 v[96:99], v[32:35], v[116:119], v[96:99]
    v_mfma_f32_16x16x32_bf16 v[104:107], v[24:27], v[112:115], v[104:107]
    s_waitcnt lgkmcnt(8)
    v_mfma_f32_16x16x32_bf16 v[96:99], v[20:23], v[120:123], v[96:99]
    v_mfma_f32_16x16x32_bf16 v[104:107], v[20:23], v[124:127], v[104:107]
    v_mfma_f32_16x16x32_bf16 v[96:99], v[36:39], v[124:127], v[96:99]
    v_mfma_f32_16x16x32_bf16 v[104:107], v[28:31], v[120:123], v[104:107]
    s_waitcnt lgkmcnt(4)
    v_mfma_f32_16x16x32_bf16 v[100:103], v[16:19], v[128:131], v[100:103]
    v_mfma_f32_16x16x32_bf16 v[108:111], v[16:19], v[132:135], v[108:111]
    v_mfma_f32_16x16x32_bf16 v[100:103], v[32:35], v[132:135], v[100:103]
    v_mfma_f32_16x16x32_bf16 v[108:111], v[24:27], v[128:131], v[108:111]
    s_waitcnt lgkmcnt(0)
    v_mfma_f32_16x16x32_bf16 v[100:103], v[20:23], v[136:139], v[100:103]
    v_mfma_f32_16x16x32_bf16 v[108:111], v[20:23], v[140:143], v[108:111]
    v_mfma_f32_16x16x32_bf16 v[100:103], v[36:39], v[140:143], v[100:103]
    v_mfma_f32_16x16x32_bf16 v[108:111], v[28:31], v[136:139], v[108:111]
    v_cvt_pk_bf16_f32 v176, v96, v97
    v_cvt_pk_bf16_f32 v177, v98, v99
    s_nop 4
    v_cvt_pk_bf16_f32 v178, v100, v101
    v_cvt_pk_bf16_f32 v179, v102, v103
    v_cvt_pk_bf16_f32 v180, v104, v105
    v_cvt_pk_bf16_f32 v181, v106, v107
    v_cvt_pk_bf16_f32 v182, v108, v109
    v_cvt_pk_bf16_f32 v183, v110, v111
    s_cmp_lg_u32 s46, 0
    s_cbranch_scc1 Lnodc_30
    v_mov_b32 v180, v188
    v_mov_b32 v181, v189
    v_mov_b32 v182, v190
    v_mov_b32 v183, v191
Lnodc_30:
    v_permlane32_swap_b32 v176, v180
    v_permlane32_swap_b32 v177, v181
    v_permlane32_swap_b32 v178, v182
    v_permlane32_swap_b32 v179, v183
    buffer_store_dwordx4 v[176:179], v2, s[28:31], s47 offen sc1
    buffer_store_dwordx4 v[180:183], v2, s[28:31], s48 offen sc1
    v_lshrrev_b32_e64 v4, 5, v0
    v_bfe_u32 v5, v0, 2, 2
    v_lshl_add_u32 v5, v4, 2, v5
    v_lshlrev_b32 v5, 5, v5
    v_and_b32 v6, 3, v0
    v_lshl_add_u32 v5, v6, 3, v5
    v_bfe_u32 v6, v0, 4, 1
    v_mul_u32_u24 v6, 16512, v6
    v_add_u32 v5, v5, v6
    s_add_u32 s45, s3, 0
    s_and_b32 s45, s45, 3
    s_lshl_b32 s45, s45, 12
    v_add_u32 v16, s45, v5
    s_add_u32 s45, s3, 1
    s_and_b32 s45, s45, 3
    s_lshl_b32 s45, s45, 12
    v_add_u32 v17, s45, v5
    s_add_u32 s45, s3, 2
    s_and_b32 s45, s45, 3
    s_lshl_b32 s45, s45, 12
    v_add_u32 v18, s45, v5
    s_add_u32 s45, s3, 3
    s_and_b32 s45, s45, 3
    s_lshl_b32 s45, s45, 12
    v_add_u32_e64 v19, s45, v5
    v_mov_b32 v20, v1
    s_cmp_eq_u32 s3, 0
    s_cselect_b32 s45, 0, 2
    v_cmp_eq_u32 vcc, s45, v4
    v_mov_b32 v6, 0xffff
    v_and_b32 v22, 31, v0
    v_cndmask_b32 v21, -1, v6, vcc
    v_lshlrev_b32 v22, 4, v22
    v_add_u32 v22, 132096, v22
    s_lshl_b32 s45, s3, 2
    v_add_u32 v23, s45, v22
    s_lshl_b32 s45, s3, 12
    s_add_u32 s45, s45, 134144
    v_add_u32_e64 v9, s45, v1
    ds_read_b128 v[136:139], v9
    ds_read_b128 v[140:143], v9 offset:1024
    s_lshl_b32 s46, s3, 12
    s_and_b32 s47, s41, 7
    s_lshl_b32 s47, s47, 18
    s_lshr_b32 s45, s41, 3
    s_xor_b32 s45, s45, 1
    s_lshl_b32 s45, s45, 13
    s_add_u32 s47, s47, s45
    s_lshr_b32 s45, s3, 1
    s_lshl_b32 s45, s45, 14
    s_add_u32 s47, s47, s45
    s_and_b32 s45, s3, 1
    s_lshl_b32 s45, s45, 12
    s_add_u32 s47, s47, s45
    s_add_u32 s47, s47, 0x600000
    s_and_b32 s13, s41, 7
    s_lshl_b32 s13, s13, 20
    s_lshr_b32 s45, s13, 18
    s_xor_b32 s45, s45, s41
    s_and_b32 s45, s45, 8
    s_lshl_b32 s45, s45, 10
    s_add_u32 s13, s13, s45
    s_add_u32 s13, s13, 0x1c00000
    s_lshr_b32 s48, s42, 2
    s_lshl_b32 s48, s48, 14
    s_lshl_b32 s45, s3, 11
    s_add_u32 s48, s48, s45
    s_add_u32 s48, s48, s13
    s_mov_b32 s58, 0x3eeff558
    s_mov_b32 s59, s58
    v_mov_b32 v6, 0x409d30fc
    v_mov_b32 v7, v6
    s_and_b32 s40, s63, 0xfffff000
    s_and_b32 s49, s41, 7
    s_lshl_b32 s49, s49, 9
    s_lshr_b32 s45, s41, 3
    s_lshl_b32 s45, s45, 13
    s_add_u32 s49, s49, s45
    s_add_u32 s49, s49, 0x1094000
    s_mul_i32 s45, s3, 7
    s_lshr_b32 s45, s45, 1
    v_min_u32 v10, 3, v0
    v_add_u32 v10, s45, v10
    v_lshlrev_b32 v10, 8, v10
    s_lshr_b32 s10, s43, 1
    s_and_b32 s11, s43, 1
    s_lshl_b32 s12, s10, 2
    s_add_u32 s12, s12, s11
    v_and_b32 v8, 31, v0
    v_lshrrev_b32 v11, 5, v0
    s_lshl_b32 s9, s44, 6
    s_and_b32 s45, s3, 1
    s_lshl_b32 s45, s45, 5
    s_add_u32 s9, s9, s45
    s_lshr_b32 s45, s3, 1
    s_lshl_b32 s45, s45, 9
    s_add_u32 s9, s9, s45
    s_mov_b32 s24, 0x80008000
    s_cmp_ge_u32 s3, 2
    s_cselect_b32 s25, s24, 0
    v_lshlrev_b32 v4, 4, v11
    s_mov_b32 s36, s20
    s_and_b32 s37, s21, 0xffff
    s_mov_b32 s38, 0x200000
    s_mov_b32 s39, 0x00020000
    v_mov_b32 v2, v1
    v_and_b32 v3, 3, v0
    v_lshlrev_b32_e64 v3, 5, v3
    v_bfe_u32 v8, v0, 3, 2
    v_add_u32_e64 v3, v3, v8
    v_bfe_u32 v8, v0, 2, 1
    v_lshl_add_u32 v3, v8, 4, v3
    v_lshl_add_u32 v3, v3, 10, v4
    s_lshl_b32 s6, s10, 17
    s_lshl_b32 s45, s11, 12
    s_add_u32 s6, s6, s45
    s_add_u32 s6, s6, s9
    s_add_u32 s7, s6, 8192
    s_and_b32 s4, s10, 7
    s_lshl_b32 s4, s4, 20
    s_lshr_b32 s45, s4, 18
    s_xor_b32 s45, s45, s10
    s_and_b32 s45, s45, 8
    s_lshl_b32 s45, s45, 10
    s_add_u32 s4, s4, s45
    s_add_u32 s4, s4, 0x1c00000
    s_and_b32 s45, s43, 1
    s_lshl_b32 s45, s45, 18
    s_add_u32 s4, s4, s45
    s_mul_i32 s12, s3, 7
    s_lshr_b32 s12, s12, 1
    s_lshl_b32 s12, s12, 14
    s_and_b32 s45, s3, 1
    s_lshl_b32 s22, s45, 13
    s_lshl_b32 s45, s45, 12
    s_add_u32 s12, s12, s45
    s_add_u32 s4, s4, s12
    s_add_u32 s5, s4, 524288
    s_sub_u32 s23, 12288, s22
    s_add_u32 s22, s22, 4096
    s_and_b32 s45, s43, 1
    s_mul_i32 s45, s45, 33024
L_hop5:
    s_cbranch_execz HOPRET_1
    v_add_u32_e64 v25, s45, v16
    s_mul_i32 s45, s3, 6144
    v_add_u32_e64 v5, s45, v1
    s_mov_b32 s10, 0x11111111
    s_mov_b32 s11, s10
    s_waitcnt vmcnt(0)
    s_barrier
    s_cmp_lg_u32 s3, 0
    s_cbranch_scc1 Larr_31
    v_mov_b32 v13, 1
    s_mov_b64 exec, 0xff
    buffer_atomic_add v13, v14, s[28:31], s62 offen offset:12 sc1
    s_mov_b64 exec, -1
Larr_31:
    s_barrier
    s_add_u32 s54, s54, 4096
    buffer_load_dwordx4 v[160:163], v12, s[28:31], s54 offen offset:0 sc1
    s_add_u32 s55, s55, 4096
    buffer_load_dwordx4 v[164:167], v12, s[28:31], s55 offen offset:0 sc1
    buffer_load_dwordx4 v[168:171], v12, s[28:31], s54 offen offset:1024 sc1
    buffer_load_dwordx4 v[172:175], v12, s[28:31], s55 offen offset:1024 sc1
    buffer_load_dwordx4 v[176:179], v12, s[28:31], s54 offen offset:2048 sc1
    buffer_load_dwordx4 v[180:183], v12, s[28:31], s55 offen offset:2048 sc1
    buffer_load_dwordx4 v[184:187], v12, s[28:31], s54 offen offset:3072 sc1
    buffer_load_dwordx4 v[188:191], v12, s[28:31], s55 offen offset:3072 sc1
    s_add_u32 s54, s54, 4096
    buffer_load_dwordx4 v[192:195], v12, s[28:31], s54 offen offset:0 sc1
    s_add_u32 s55, s55, 4096
    buffer_load_dwordx4 v[196:199], v12, s[28:31], s55 offen offset:0 sc1
    s_cmp_ge_u32 s100, 14
    s_cbranch_scc1 L_g1_spare1
    s_cmp_lg_u32 s3, 0
    s_cbranch_scc1 Lskip_32
    s_mov_b32 s60, 0
Lpoll_33:
    s_nop 0
    buffer_load_dword v13, v15, s[28:31], s62 offen offset:12 sc1
    s_waitcnt vmcnt(0)
    v_cmp_ne_u32 vcc, 8, v13
    s_add_u32 s60, s60, 1
    s_cbranch_vccz Lskip_32
    s_cmp_lt_u32 s60, s61
    s_cbranch_scc1 Lpoll_33
    s_mov_b32 s61, 1
Lskip_32:
    s_barrier
    s_add_u32 m0, s46, 0
    s_add_u32 s57, s47, 0
    buffer_load_dwordx4 v1, s[28:31], s57 offen offset:0 sc1 lds
    buffer_load_dwordx4 v1, s[28:31], s57 offen offset:1024 sc1 lds
    buffer_load_dwordx4 v1, s[28:31], s57 offen offset:2048 sc1 lds
    buffer_load_dwordx4 v1, s[28:31], s57 offen offset:3072 sc1 lds
    s_add_u32 m0, s46, 16512
    s_add_u32 s57, s47, 32768
    buffer_load_dwordx4 v1, s[28:31], s57 offen offset:0 sc1 lds
    buffer_load_dwordx4 v1, s[28:31], s57 offen offset:1024 sc1 lds
    buffer_load_dwordx4 v1, s[28:31], s57 offen offset:2048 sc1 lds
    buffer_load_dwordx4 v1, s[28:31], s57 offen offset:3072 sc1 lds
    s_add_u32 m0, s46, 33024
    s_add_u32 s57, s47, 65536
    buffer_load_dwordx4 v1, s[28:31], s57 offen offset:0 sc1 lds
    buffer_load_dwordx4 v1, s[28:31], s57 offen offset:1024 sc1 lds
    buffer_load_dwordx4 v1, s[28:31], s57 offen offset:2048 sc1 lds
    buffer_load_dwordx4 v1, s[28:31], s57 offen offset:3072 sc1 lds
    s_add_u32 m0, s46, 49536
    s_add_u32 s57, s47, 98304
    buffer_load_dwordx4 v1, s[28:31], s57 offen offset:0 sc1 lds
    buffer_load_dwordx4 v1, s[28:31], s57 offen offset:1024 sc1 lds
    buffer_load_dwordx4 v1, s[28:31], s57 offen offset:2048 sc1 lds
    buffer_load_dwordx4 v1, s[28:31], s57 offen offset:3072 sc1 lds
    s_waitcnt vmcnt(8)
    s_nop 0
    ds_read_b64_tr_b16 v[64:65], v16 offset:0
    ds_read_b64_tr_b16 v[66:67], v16 offset:256
    ds_read_b64_tr_b16 v[68:69], v16 offset:512
    ds_read_b64_tr_b16 v[70:71], v16 offset:768
    ds_read_b64_tr_b16 v[72:73], v16 offset:1024
    ds_read_b64_tr_b16 v[74:75], v16 offset:1280
    ds_read_b64_tr_b16 v[76:77], v16 offset:1536
    ds_read_b64_tr_b16 v[78:79], v16 offset:1792
    ds_read_b64_tr_b16 v[80:81], v16 offset:2048
    ds_read_b64_tr_b16 v[82:83], v16 offset:2304
    ds_read_b64_tr_b16 v[84:85], v16 offset:2560
    ds_read_b64_tr_b16 v[86:87], v16 offset:2816
    ds_read_b64_tr_b16 v[88:89], v16 offset:3072
    ds_read_b64_tr_b16 v[90:91], v16 offset:3328
    ds_read_b64_tr_b16 v[92:93], v16 offset:3584
    ds_read_b64_tr_b16 v[94:95], v16 offset:3840
    s_barrier
    s_waitcnt lgkmcnt(8)
    v_and_b32_e64 v8, v21, v64
    v_dot2_f32_bf16 v28, v8, v8, 0
    v_dot2_f32_bf16 v29, v65, v65, 0
    v_dot2_f32_bf16 v30, v66, v66, 0
    v_dot2_f32_bf16 v31, v67, v67, 0
    v_dot2_f32_bf16 v28, v68, v68, v28
    v_dot2_f32_bf16 v29, v69, v69, v29
    v_dot2_f32_bf16 v30, v70, v70, v30
    v_dot2_f32_bf16 v31, v71, v71, v31
    v_dot2_f32_bf16 v28, v72, v72, v28
    v_dot2_f32_bf16 v29, v73, v73, v29
    v_dot2_f32_bf16 v30, v74, v74, v30
    v_dot2_f32_bf16 v31, v75, v75, v31
    v_dot2_f32_bf16 v28, v76, v76, v28
    v_dot2_f32_bf16 v29, v77, v77, v29
    v_dot2_f32_bf16 v30, v78, v78, v30
    v_dot2_f32_bf16 v31, v79, v79, v31
    s_waitcnt lgkmcnt(0)
    s_nop 0
    v_dot2_f32_bf16 v28, v80, v80, v28
    v_dot2_f32_bf16 v29, v81, v81, v29
    v_dot2_f32_bf16 v30, v82, v82, v30
    v_dot2_f32_bf16 v31, v83, v83, v31
    v_dot2_f32_bf16 v28, v84, v84, v28
    v_dot2_f32_bf16 v29, v85, v85, v29
    v_dot2_f32_bf16 v30, v86, v86, v30
    v_dot2_f32_bf16 v31, v87, v87, v31
    v_dot2_f32_bf16 v28, v88, v88, v28
    v_dot2_f32_bf16 v29, v89, v89, v29
    v_dot2_f32_bf16 v30, v90, v90, v30
    v_dot2_f32_bf16 v31, v91, v91, v31
    v_dot2_f32_bf16 v28, v92, v92, v28
    v_dot2_f32_bf16 v29, v93, v93, v29
    v_dot2_f32_bf16 v30, v94, v94, v30
    v_dot2_f32_bf16 v31, v95, v95, v31
    v_mfma_f32_32x32x16_bf16 v[32:47], a[0:3], v[64:67], 0
    ds_read_b64_tr_b16 v[64:65], v17 offset:0
    ds_read_b64_tr_b16 v[66:67], v17 offset:256
    v_add_f32_e64 v28, v28, v29
    s_add_u32 m0, s46, 66048
    s_add_u32 s57, s47, 131072
    buffer_load_dwordx4 v1, s[28:31], s57 offen offset:0 sc1 lds
    v_mfma_f32_32x32x16_bf16 v[32:47], a[4:7], v[68:71], v[32:47]
    ds_read_b64_tr_b16 v[68:69], v17 offset:512
    ds_read_b64_tr_b16 v[70:71], v17 offset:768
    v_add_f32_e64 v30, v30, v31
    v_mfma_f32_32x32x16_bf16 v[32:47], a[8:11], v[72:75], v[32:47]
    ds_read_b64_tr_b16 v[72:73], v17 offset:1024
    ds_read_b64_tr_b16 v[74:75], v17 offset:1280
    v_add_f32 v28, v28, v30
    v_lshlrev_b32 v96, 16, v136
    v_and_b32 v97, 0xffff0000, v136
    v_mfma_f32_32x32x16_bf16 v[32:47], a[12:15], v[76:79], v[32:47]
    ds_read_b64_tr_b16 v[76:77], v17 offset:1536
    ds_read_b64_tr_b16 v[78:79], v17 offset:1792
    v_mov_b32_e64 v29, v28
    buffer_load_dwordx4 v1, s[28:31], s57 offen offset:1024 sc1 lds
    v_mfma_f32_32x32x16_bf16 v[32:47], a[16:19], v[80:83], v[32:47]
    ds_read_b64_tr_b16 v[80:81], v17 offset:2048
    ds_read_b64_tr_b16 v[82:83], v17 offset:2304
    v_permlane32_swap_b32 v28, v29
    v_mul_f32 v96, s58, v96
    v_mul_f32_e64 v97, s58, v97
    v_mfma_f32_32x32x16_bf16 v[32:47], a[20:23], v[84:87], v[32:47]
    ds_read_b64_tr_b16 v[84:85], v17 offset:2560
    ds_read_b64_tr_b16 v[86:87], v17 offset:2816
    v_add_f32 v28, v28, v29
    v_lshlrev_b32 v98, 16, v137
    v_mfma_f32_32x32x16_bf16 v[32:47], a[24:27], v[88:91], v[32:47]
    ds_read_b64_tr_b16 v[88:89], v17 offset:3072
    ds_read_b64_tr_b16 v[90:91], v17 offset:3328
    ds_write_b32 v23, v28 offset:0
    v_and_b32 v99, 0xffff0000, v137
    v_mul_f32_e64 v98, s58, v98
    v_mfma_f32_32x32x16_bf16 v[32:47], a[28:31], v[92:95], v[32:47]
    ds_read_b64_tr_b16 v[92:93], v17 offset:3584
    ds_read_b64_tr_b16 v[94:95], v17 offset:3840
    buffer_load_dwordx4 v1, s[28:31], s57 offen offset:2048 sc1 lds
    s_waitcnt lgkmcnt(9)
    v_mfma_f32_32x32x16_bf16 v[32:47], a[32:35], v[64:67], v[32:47]
    ds_read_b64_tr_b16 v[64:65], v18 offset:0
    ds_read_b64_tr_b16 v[66:67], v18 offset:256
    v_mul_f32 v99, s58, v99
    v_lshlrev_b32_e64 v100, 16, v138
    v_and_b32 v101, 0xffff0000, v138
    v_mfma_f32_32x32x16_bf16 v[32:47], a[36:39], v[68:71], v[32:47]
    ds_read_b64_tr_b16 v[68:69], v18 offset:512
    ds_read_b64_tr_b16 v[70:71], v18 offset:768
    v_mul_f32 v100, s58, v100
    v_mul_f32 v101, s58, v101
    v_mfma_f32_32x32x16_bf16 v[32:47], a[40:43], v[72:75], v[32:47]
    ds_read_b64_tr_b16 v[72:73], v18 offset:1024
    ds_read_b64_tr_b16 v[74:75], v18 offset:1280
    buffer_load_dwordx4 v1, s[28:31], s57 offen offset:3072 sc1 lds
    v_lshlrev_b32_e64 v102, 16, v139
    v_and_b32 v103, 0xffff0000, v139
    v_mfma_f32_32x32x16_bf16 v[32:47], a[44:47], v[76:79], v[32:47]
    ds_read_b64_tr_b16 v[76:77], v18 offset:1536
    ds_read_b64_tr_b16 v[78:79], v18 offset:1792
    v_mul_f32 v102, s58, v102
    s_waitcnt lgkmcnt(8)
    v_mfma_f32_32x32x16_bf16 v[32:47], a[48:51], v[80:83], v[32:47]
    ds_read_b64_tr_b16 v[80:81], v18 offset:2048
    ds_read_b64_tr_b16 v[82:83], v18 offset:2304
    v_mul_f32 v103, s58, v103
    v_lshlrev_b32 v104, 16, v140
    v_and_b32 v105, 0xffff0000, v140
    v_mfma_f32_32x32x16_bf16 v[32:47], a[52:55], v[84:87], v[32:47]
    ds_read_b64_tr_b16 v[84:85], v18 offset:2560
    ds_read_b64_tr_b16 v[86:87], v18 offset:2816
    v_mul_f32 v104, s58, v104
    v_mul_f32 v105, s58, v105
    v_mfma_f32_32x32x16_bf16 v[32:47], a[56:59], v[88:91], v[32:47]
    ds_read_b64_tr_b16 v[88:89], v18 offset:3072
    ds_read_b64_tr_b16 v[90:91], v18 offset:3328
    s_add_u32 m0, s46, 82560
    s_add_u32 s57, s47, 163840
    buffer_load_dwordx4 v1, s[28:31], s57 offen offset:0 sc1 lds
    v_mfma_f32_32x32x16_bf16 v[32:47], a[60:63], v[92:95], v[32:47]
    ds_read_b64_tr_b16 v[92:93], v18 offset:3584
    ds_read_b64_tr_b16 v[94:95], v18 offset:3840
    s_waitcnt lgkmcnt(8)
    s_waitcnt vmcnt(5)
    s_barrier
    v_mfma_f32_32x32x16_bf16 v[32:47], a[64:67], v[64:67], v[32:47]
    ds_read_b128 v[28:31], v22 offset:0
    ds_read_b64_tr_b16 v[64:65], v19 offset:0
    ds_read_b64_tr_b16 v[66:67], v19 offset:256
    v_lshlrev_b32 v106, 16, v141
    v_mfma_f32_32x32x16_bf16 v[32:47], a[68:71], v[68:71], v[32:47]
    ds_read_b64_tr_b16 v[68:69], v19 offset:512
    ds_read_b64_tr_b16 v[70:71], v19 offset:768
    buffer_load_dwordx4 v1, s[28:31], s57 offen offset:1024 sc1 lds
    v_and_b32 v107, 0xffff0000, v141
    v_mfma_f32_32x32x16_bf16 v[32:47], a[72:75], v[72:75], v[32:47]
    ds_read_b64_tr_b16 v[72:73], v19 offset:1024
    ds_read_b64_tr_b16 v[74:75], v19 offset:1280
    v_mul_f32 v106, s58, v106
    v_mul_f32 v107, s58, v107
    v_lshlrev_b32_e64 v108, 16, v142
    v_mfma_f32_32x32x16_bf16 v[32:47], a[76:79], v[76:79], v[32:47]
    ds_read_b64_tr_b16 v[76:77], v19 offset:1536
    ds_read_b64_tr_b16 v[78:79], v19 offset:1792
    s_waitcnt lgkmcnt(8)
    s_waitcnt lgkmcnt(9)
    v_mfma_f32_32x32x16_bf16 v[32:47], a[80:83], v[80:83], v[32:47]
    ds_read_b64_tr_b16 v[80:81], v19 offset:2048
    ds_read_b64_tr_b16 v[82:83], v19 offset:2304
    v_add_f32_e64 v28, v28, v29
    v_and_b32 v109, 0xffff0000, v142
    v_mul_f32_e64 v108, s58, v108
    v_mfma_f32_32x32x16_bf16 v[32:47], a[84:87], v[84:87], v[32:47]
    ds_read_b64_tr_b16 v[84:85], v19 offset:2560
    ds_read_b64_tr_b16 v[86:87], v19 offset:2816
    v_add_f32_e64 v30, v30, v31
    buffer_load_dwordx4 v1, s[28:31], s57 offen offset:2048 sc1 lds
    v_mfma_f32_32x32x16_bf16 v[32:47], a[88:91], v[88:91], v[32:47]
    ds_read_b64_tr_b16 v[88:89], v19 offset:3072
    ds_read_b64_tr_b16 v[90:91], v19 offset:3328
    v_add_f32 v28, v28, v30
    v_mul_f32 v109, s58, v109
    v_lshlrev_b32 v110, 16, v143
    v_mfma_f32_32x32x16_bf16 v[32:47], a[92:95], v[92:95], v[32:47]
    ds_read_b64_tr_b16 v[92:93], v19 offset:3584
    ds_read_b64_tr_b16 v[94:95], v19 offset:3840
    v_mul_f32 v28, 0x3b000000, v28
    s_waitcnt lgkmcnt(8)
    v_mfma_f32_32x32x16_bf16 v[32:47], a[96:99], v[64:67], v[32:47]
    ds_read_b64_tr_b16 v[64:65], v16 offset:33024
    ds_read_b64_tr_b16 v[66:67], v16 offset:33280
    v_add_f32 v29, 0x3727c5ac, v28
    buffer_load_dwordx4 v1, s[28:31], s57 offen offset:3072 sc1 lds
    v_and_b32 v111, 0xffff0000, v143
    v_mfma_f32_32x32x16_bf16 v[32:47], a[100:103], v[68:71], v[32:47]
    ds_read_b64_tr_b16 v[68:69], v16 offset:33536
    ds_read_b64_tr_b16 v[70:71], v16 offset:33792
    v_rsq_f32_e64 v29, v29
    v_mfma_f32_32x32x16_bf16 v[32:47], a[104:107], v[72:75], v[32:47]
    ds_read_b64_tr_b16 v[72:73], v16 offset:34048
    ds_read_b64_tr_b16 v[74:75], v16 offset:34304
    v_mul_f32 v28, v28, v29
    v_mul_f32 v110, s58, v110
    v_mul_f32 v111, s58, v111
    v_mfma_f32_32x32x16_bf16 v[32:47], a[108:111], v[76:79], v[32:47]
    ds_read_b64_tr_b16 v[76:77], v16 offset:34560
    ds_read_b64_tr_b16 v[78:79], v16 offset:34816
    v_fmaak_f32 v28, v28, v29, 0x3727c5ac
    s_waitcnt lgkmcnt(8)
    v_mfma_f32_32x32x16_bf16 v[32:47], a[112:115], v[80:83], v[32:47]
    ds_read_b64_tr_b16 v[80:81], v16 offset:35072
    ds_read_b64_tr_b16 v[82:83], v16 offset:35328
    v_rsq_f32 v28, v28
    s_mov_b32 s32, s18
    s_and_b32 s33, s19, 0xffff
    s_mov_b32 s34, 0x400
    s_mov_b32 s35, 0x00020000
    buffer_load_dwordx4 v[144:147], v4, s[32:35], s9 offen
    v_mfma_f32_32x32x16_bf16 v[32:47], a[116:119], v[84:87], v[32:47]
    ds_read_b64_tr_b16 v[84:85], v16 offset:35584
    ds_read_b64_tr_b16 v[86:87], v16 offset:35840
    v_mul_f32_e64 v29, s58, v29
    v_mfma_f32_32x32x16_bf16 v[32:47], a[120:123], v[88:91], v[32:47]
    ds_read_b64_tr_b16 v[88:89], v16 offset:36096
    ds_read_b64_tr_b16 v[90:91], v16 offset:36352
    v_mul_f32 v24, v28, v29
    v_mfma_f32_32x32x16_bf16 v[32:47], a[124:127], v[92:95], v[32:47]
    ds_read_b64_tr_b16 v[92:93], v16 offset:36608
    ds_read_b64_tr_b16 v[94:95], v16 offset:36864
    v_add_u32 v16, 66048, v16
    s_nop 8
    v_pk_fma_f32 v[32:33], v[32:33], v[24:25], v[96:97] op_sel_hi:[1,0,1]
    v_pk_fma_f32 v[34:35], v[34:35], v[24:25], v[98:99] op_sel_hi:[1,0,1]
    v_pk_fma_f32 v[36:37], v[36:37], v[24:25], v[100:101] op_sel_hi:[1,0,1]
    v_pk_fma_f32 v[38:39], v[38:39], v[24:25], v[102:103] op_sel_hi:[1,0,1]
    v_pk_fma_f32 v[40:41], v[40:41], v[24:25], v[104:105] op_sel_hi:[1,0,1]
    v_pk_fma_f32 v[42:43], v[42:43], v[24:25], v[106:107] op_sel_hi:[1,0,1]
    v_pk_fma_f32 v[44:45], v[44:45], v[24:25], v[108:109] op_sel_hi:[1,0,1]
    v_pk_fma_f32 v[46:47], v[46:47], v[24:25], v[110:111] op_sel_hi:[1,0,1]
    v_pk_fma_f32 v[112:113], v[32:33], v[32:33], v[6:7]
    v_pk_fma_f32 v[114:115], v[34:35], v[34:35], v[6:7]
    v_pk_fma_f32 v[116:117], v[36:37], v[36:37], v[6:7]
    v_pk_fma_f32 v[118:119], v[38:39], v[38:39], v[6:7]
    v_pk_fma_f32 v[120:121], v[40:41], v[40:41], v[6:7]
    v_pk_fma_f32 v[122:123], v[42:43], v[42:43], v[6:7]
    v_pk_fma_f32 v[124:125], v[44:45], v[44:45], v[6:7]
    v_pk_fma_f32 v[126:127], v[46:47], v[46:47], v[6:7]
    v_pk_mul_f32 v[112:113], v[112:113], v[32:33] neg_lo:[1,0] neg_hi:[1,0]
    v_pk_mul_f32 v[114:115], v[114:115], v[34:35] neg_lo:[1,0] neg_hi:[1,0]
    v_pk_mul_f32 v[116:117], v[116:117], v[36:37] neg_lo:[1,0] neg_hi:[1,0]
    v_pk_mul_f32 v[118:119], v[118:119], v[38:39] neg_lo:[1,0] neg_hi:[1,0]
    v_pk_mul_f32 v[120:121], v[120:121], v[40:41] neg_lo:[1,0] neg_hi:[1,0]
    v_pk_mul_f32 v[122:123], v[122:123], v[42:43] neg_lo:[1,0] neg_hi:[1,0]
    v_pk_mul_f32 v[124:125], v[124:125], v[44:45] neg_lo:[1,0] neg_hi:[1,0]
    v_pk_mul_f32 v[126:127], v[126:127], v[46:47] neg_lo:[1,0] neg_hi:[1,0]
    s_waitcnt lgkmcnt(8)
    s_nop 0
    v_mfma_f32_32x32x16_bf16 v[48:63], a[0:3], v[64:67], 0
    ds_read_b64_tr_b16 v[64:65], v17 offset:33024
    ds_read_b64_tr_b16 v[66:67], v17 offset:33280
    s_add_u32 m0, s46, 99072
    s_add_u32 s57, s47, 196608
    buffer_load_dwordx4 v1, s[28:31], s57 offen offset:0 sc1 lds
    v_exp_f32_e64 v112, v112
    v_mfma_f32_32x32x16_bf16 v[48:63], a[4:7], v[68:71], v[48:63]
    ds_read_b64_tr_b16 v[68:69], v17 offset:33536
    ds_read_b64_tr_b16 v[70:71], v17 offset:33792
    buffer_load_dwordx4 v1, s[28:31], s57 offen offset:1024 sc1 lds
    v_fma_f32 v112, v112, s58, s58
    v_exp_f32_e64 v113, v113
    v_mfma_f32_32x32x16_bf16 v[48:63], a[8:11], v[72:75], v[48:63]
    ds_read_b64_tr_b16 v[72:73], v17 offset:34048
    ds_read_b64_tr_b16 v[74:75], v17 offset:34304
    v_rcp_f32_e64 v112, v112
    v_fma_f32 v113, v113, s58, s58
    v_exp_f32_e64 v114, v114
    v_mfma_f32_32x32x16_bf16 v[48:63], a[12:15], v[76:79], v[48:63]
    ds_read_b64_tr_b16 v[76:77], v17 offset:34560
    ds_read_b64_tr_b16 v[78:79], v17 offset:34816
    buffer_load_dwordx4 v1, s[28:31], s57 offen offset:2048 sc1 lds
    v_mul_f32_e64 v112, v112, v32
    v_rcp_f32 v113, v113
    s_waitcnt lgkmcnt(8)
    v_mfma_f32_32x32x16_bf16 v[48:63], a[16:19], v[80:83], v[48:63]
    ds_read_b64_tr_b16 v[80:81], v17 offset:35072
    ds_read_b64_tr_b16 v[82:83], v17 offset:35328
    v_fma_f32 v114, v114, s58, s58
    v_exp_f32 v115, v115
    v_mul_f32 v113, v113, v33
    v_mfma_f32_32x32x16_bf16 v[48:63], a[20:23], v[84:87], v[48:63]
    ds_read_b64_tr_b16 v[84:85], v17 offset:35584
    ds_read_b64_tr_b16 v[86:87], v17 offset:35840
    buffer_load_dwordx4 v1, s[28:31], s57 offen offset:3072 sc1 lds
    v_cvt_pk_bf16_f32 v128, v112, v113
    v_rcp_f32_e64 v114, v114
    v_fma_f32 v115, v115, s58, s58
    v_mfma_f32_32x32x16_bf16 v[48:63], a[24:27], v[88:91], v[48:63]
    ds_read_b64_tr_b16 v[88:89], v17 offset:36096
    ds_read_b64_tr_b16 v[90:91], v17 offset:36352
    v_exp_f32 v116, v116
    v_mul_f32 v114, v114, v34
    v_rcp_f32_e64 v115, v115
    v_mfma_f32_32x32x16_bf16 v[48:63], a[28:31], v[92:95], v[48:63]
    ds_read_b64_tr_b16 v[92:93], v17 offset:36608
    ds_read_b64_tr_b16 v[94:95], v17 offset:36864
    v_add_u32 v17, 66048, v17
    s_add_u32 m0, s46, 115584
    s_add_u32 s57, s47, 229376
    buffer_load_dwordx4 v1, s[28:31], s57 offen offset:0 sc1 lds
    s_waitcnt lgkmcnt(8)
    v_mfma_f32_32x32x16_bf16 v[48:63], a[32:35], v[64:67], v[48:63]
    ds_read_b64_tr_b16 v[64:65], v18 offset:33024
    ds_read_b64_tr_b16 v[66:67], v18 offset:33280
    v_fma_f32 v116, v116, s58, s58
    v_exp_f32 v117, v117
    v_mfma_f32_32x32x16_bf16 v[48:63], a[36:39], v[68:71], v[48:63]
    ds_read_b64_tr_b16 v[68:69], v18 offset:33536
    ds_read_b64_tr_b16 v[70:71], v18 offset:33792
    buffer_load_dwordx4 v1, s[28:31], s57 offen offset:1024 sc1 lds
    v_mul_f32_e64 v115, v115, v35
    v_cvt_pk_bf16_f32 v129, v114, v115
    v_rcp_f32_e64 v116, v116
    v_mfma_f32_32x32x16_bf16 v[48:63], a[40:43], v[72:75], v[48:63]
    ds_read_b64_tr_b16 v[72:73], v18 offset:34048
    ds_read_b64_tr_b16 v[74:75], v18 offset:34304
    v_fma_f32 v117, v117, s58, s58
    v_exp_f32 v118, v118
    v_mul_f32 v116, v116, v36
    v_mfma_f32_32x32x16_bf16 v[48:63], a[44:47], v[76:79], v[48:63]
    ds_read_b64_tr_b16 v[76:77], v18 offset:34560
    ds_read_b64_tr_b16 v[78:79], v18 offset:34816
    buffer_load_dwordx4 v1, s[28:31], s57 offen offset:2048 sc1 lds
    v_rcp_f32 v117, v117
    v_fma_f32 v118, v118, s58, s58
    s_waitcnt lgkmcnt(8)
    v_mfma_f32_32x32x16_bf16 v[48:63], a[48:51], v[80:83], v[48:63]
    ds_read_b64_tr_b16 v[80:81], v18 offset:35072
    ds_read_b64_tr_b16 v[82:83], v18 offset:35328
    v_exp_f32 v119, v119
    v_mul_f32 v117, v117, v37
    v_cvt_pk_bf16_f32 v130, v116, v117
    v_mfma_f32_32x32x16_bf16 v[48:63], a[52:55], v[84:87], v[48:63]
    ds_read_b64_tr_b16 v[84:85], v18 offset:35584
    ds_read_b64_tr_b16 v[86:87], v18 offset:35840
    buffer_load_dwordx4 v1, s[28:31], s57 offen offset:3072 sc1 lds
    v_rcp_f32_e64 v118, v118
    v_fma_f32 v119, v119, s58, s58
    v_exp_f32_e64 v120, v120
    v_mfma_f32_32x32x16_bf16 v[48:63], a[56:59], v[88:91], v[48:63]
    ds_read_b64_tr_b16 v[88:89], v18 offset:36096
    ds_read_b64_tr_b16 v[90:91], v18 offset:36352
    v_mul_f32 v118, v118, v38
    v_rcp_f32 v119, v119
    v_fma_f32 v120, v120, s58, s58
    v_mfma_f32_32x32x16_bf16 v[48:63], a[60:63], v[92:95], v[48:63]
    ds_read_b64_tr_b16 v[92:93], v18 offset:36608
    ds_read_b64_tr_b16 v[94:95], v18 offset:36864
    v_add_u32 v18, 66048, v18
    v_lshlrev_b32 v8, 2, v0
    s_waitcnt lgkmcnt(8)
    s_waitcnt vmcnt(9)
    s_barrier
    v_mfma_f32_32x32x16_bf16 v[48:63], a[64:67], v[64:67], v[48:63]
    ds_read_b64_tr_b16 v[64:65], v19 offset:33024
    ds_read_b64_tr_b16 v[66:67], v19 offset:33280
    buffer_load_dword v28, v8, s[28:31], s49 offen sc1
    buffer_load_dword v26, v8, s[28:31], s49 offen offset:256 sc1
    v_exp_f32_e64 v121, v121
    v_mfma_f32_32x32x16_bf16 v[48:63], a[68:71], v[68:71], v[48:63]
    ds_read_b64_tr_b16 v[68:69], v19 offset:33536
    ds_read_b64_tr_b16 v[70:71], v19 offset:33792
    buffer_load_dwordx4 v[200:203], v12, s[28:31], s54 offen offset:1024 sc1
    v_mul_f32_e64 v119, v119, v39
    v_cvt_pk_bf16_f32 v131, v118, v119
    v_rcp_f32_e64 v120, v120
    v_mfma_f32_32x32x16_bf16 v[48:63], a[72:75], v[72:75], v[48:63]
    ds_read_b64_tr_b16 v[72:73], v19 offset:34048
    ds_read_b64_tr_b16 v[74:75], v19 offset:34304
    v_fma_f32 v121, v121, s58, s58
    buffer_store_dwordx4 v[128:131], v20, s[28:31], s48 offen offset:0 sc1
    v_exp_f32_e64 v122, v122
    v_mfma_f32_32x32x16_bf16 v[48:63], a[76:79], v[76:79], v[48:63]
    ds_read_b64_tr_b16 v[76:77], v19 offset:34560
    ds_read_b64_tr_b16 v[78:79], v19 offset:34816
    buffer_load_dwordx4 v[204:207], v12, s[28:31], s55 offen offset:1024 sc1
    v_mul_f32_e64 v120, v120, v40
    v_rcp_f32 v121, v121
    s_waitcnt lgkmcnt(8)
    v_mfma_f32_32x32x16_bf16 v[48:63], a[80:83], v[80:83], v[48:63]
    ds_read_b64_tr_b16 v[80:81], v19 offset:35072
    ds_read_b64_tr_b16 v[82:83], v19 offset:35328
    v_fma_f32 v122, v122, s58, s58
    v_exp_f32 v123, v123
    v_mul_f32 v121, v121, v41
    v_mfma_f32_32x32x16_bf16 v[48:63], a[84:87], v[84:87], v[48:63]
    ds_read_b64_tr_b16 v[84:85], v19 offset:35584
    ds_read_b64_tr_b16 v[86:87], v19 offset:35840
    buffer_load_dwordx4 v[208:211], v12, s[28:31], s54 offen offset:2048 sc1
    v_cvt_pk_bf16_f32 v132, v120, v121
    v_rcp_f32_e64 v122, v122
    v_fma_f32 v123, v123, s58, s58
    v_mfma_f32_32x32x16_bf16 v[48:63], a[88:91], v[88:91], v[48:63]
    ds_read_b64_tr_b16 v[88:89], v19 offset:36096
    ds_read_b64_tr_b16 v[90:91], v19 offset:36352
    v_exp_f32 v124, v124
    v_mul_f32 v122, v122, v42
    v_rcp_f32_e64 v123, v123
    v_mfma_f32_32x32x16_bf16 v[48:63], a[92:95], v[92:95], v[48:63]
    ds_read_b64_tr_b16 v[92:93], v19 offset:36608
    ds_read_b64_tr_b16 v[94:95], v19 offset:36864
    v_add_u32 v19, 66048, v19
    buffer_load_dwordx4 v[212:215], v12, s[28:31], s55 offen offset:2048 sc1
    v_fma_f32 v124, v124, s58, s58
    s_waitcnt lgkmcnt(8)
    v_mfma_f32_32x32x16_bf16 v[48:63], a[96:99], v[64:67], v[48:63]
    ds_read_b64_tr_b16 v[64:65], v16 offset:0
    ds_read_b64_tr_b16 v[66:67], v16 offset:256
    v_exp_f32 v125, v125
    v_mul_f32_e64 v123, v123, v43
    v_cvt_pk_bf16_f32 v133, v122, v123
    v_mfma_f32_32x32x16_bf16 v[48:63], a[100:103], v[68:71], v[48:63]
    ds_read_b64_tr_b16 v[68:69], v16 offset:512
    ds_read_b64_tr_b16 v[70:71], v16 offset:768
    buffer_load_dwordx4 v[216:219], v12, s[28:31], s54 offen offset:3072 sc1
    v_rcp_f32_e64 v124, v124
    v_fma_f32 v125, v125, s58, s58
    v_exp_f32_e64 v126, v126
    v_mfma_f32_32x32x16_bf16 v[48:63], a[104:107], v[72:75], v[48:63]
    ds_read_b64_tr_b16 v[72:73], v16 offset:1024
    ds_read_b64_tr_b16 v[74:75], v16 offset:1280
    v_mul_f32 v124, v124, v44
    v_rcp_f32 v125, v125
    v_fma_f32 v126, v126, s58, s58
    v_mfma_f32_32x32x16_bf16 v[48:63], a[108:111], v[76:79], v[48:63]
    ds_read_b64_tr_b16 v[76:77], v16 offset:1536
    ds_read_b64_tr_b16 v[78:79], v16 offset:1792
    buffer_load_dwordx4 v[220:223], v12, s[28:31], s55 offen offset:3072 sc1
    v_exp_f32_e64 v127, v127
    v_mul_f32 v125, v125, v45
    s_waitcnt lgkmcnt(8)
    v_mfma_f32_32x32x16_bf16 v[48:63], a[112:115], v[80:83], v[48:63]
    ds_read_b64_tr_b16 v[80:81], v16 offset:2048
    ds_read_b64_tr_b16 v[82:83], v16 offset:2304
    v_cvt_pk_bf16_f32 v134, v124, v125
    v_rcp_f32_e64 v126, v126
    v_fma_f32 v127, v127, s58, s58
    v_mfma_f32_32x32x16_bf16 v[48:63], a[116:119], v[84:87], v[48:63]
    ds_read_b64_tr_b16 v[84:85], v16 offset:2560
    ds_read_b64_tr_b16 v[86:87], v16 offset:2816
    s_waitcnt vmcnt(7)
    v_and_b32 v13, v26, v28
    v_cmp_le_i32 vcc, 0, v13
    s_mov_b32 s60, 0
    s_cbranch_vccz Lok_1015
Lretry_1016:
    buffer_load_dword v28, v8, s[28:31], s49 offen sc1
    buffer_load_dword v26, v8, s[28:31], s49 offen offset:256 sc1
    s_waitcnt vmcnt(0)
    v_and_b32 v13, v26, v28
    v_cmp_le_i32 vcc, 0, v13
    s_add_u32 s60, s60, 1
    s_cbranch_vccz Lok_1015
    s_sleep 1
    s_cmp_lt_u32 s60, s61
    s_cbranch_scc1 Lretry_1016
    s_mov_b32 s61, 1
Lok_1015:
    s_add_u32 s54, s54, 4096
    buffer_load_dwordx4 v[224:227], v12, s[28:31], s54 offen offset:0 sc1
    v_mul_f32_e64 v126, v126, v46
    v_mfma_f32_32x32x16_bf16 v[48:63], a[120:123], v[88:91], v[48:63]
    ds_read_b64_tr_b16 v[88:89], v16 offset:3072
    ds_read_b64_tr_b16 v[90:91], v16 offset:3328
    v_mov_b32 v30, v28
    v_mov_b32 v22, v26
    v_rcp_f32_e64 v127, v127
    v_mfma_f32_32x32x16_bf16 v[48:63], a[124:127], v[92:95], v[48:63]
    ds_read_b64_tr_b16 v[92:93], v16 offset:3584
    ds_read_b64_tr_b16 v[94:95], v16 offset:3840
    v_permlane32_swap_b32 v28, v30
    v_permlane32_swap_b32 v26, v22
    v_mul_f32 v127, v127, v47
    v_cvt_pk_bf16_f32 v135, v126, v127
    buffer_store_dwordx4 v[132:135], v20, s[28:31], s48 offen offset:1024 sc1
    s_nop 4
    v_pk_fma_f32 v[48:49], v[48:49], v[26:27], v[96:97] op_sel_hi:[1,0,1] neg_lo:[0,1,0] neg_hi:[0,1,0]
    v_pk_fma_f32 v[50:51], v[50:51], v[26:27], v[98:99] op_sel_hi:[1,0,1] neg_lo:[0,1,0] neg_hi:[0,1,0]
    v_pk_fma_f32 v[52:53], v[52:53], v[26:27], v[100:101] op_sel_hi:[1,0,1] neg_lo:[0,1,0] neg_hi:[0,1,0]
    v_pk_fma_f32 v[54:55], v[54:55], v[26:27], v[102:103] op_sel_hi:[1,0,1] neg_lo:[0,1,0] neg_hi:[0,1,0]
    v_pk_fma_f32 v[56:57], v[56:57], v[26:27], v[104:105] op_sel_hi:[1,0,1] neg_lo:[0,1,0] neg_hi:[0,1,0]
    v_pk_fma_f32 v[58:59], v[58:59], v[26:27], v[106:107] op_sel_hi:[1,0,1] neg_lo:[0,1,0] neg_hi:[0,1,0]
    v_pk_fma_f32 v[60:61], v[60:61], v[26:27], v[108:109] op_sel_hi:[1,0,1] neg_lo:[0,1,0] neg_hi:[0,1,0]
    v_pk_fma_f32 v[62:63], v[62:63], v[26:27], v[110:111] op_sel_hi:[1,0,1] neg_lo:[0,1,0] neg_hi:[0,1,0]
    v_pk_fma_f32 v[112:113], v[48:49], v[48:49], v[6:7]
    v_pk_fma_f32 v[114:115], v[50:51], v[50:51], v[6:7]
    v_pk_fma_f32 v[116:117], v[52:53], v[52:53], v[6:7]
    v_pk_fma_f32 v[118:119], v[54:55], v[54:55], v[6:7]
    v_pk_fma_f32 v[120:121], v[56:57], v[56:57], v[6:7]
    v_pk_fma_f32 v[122:123], v[58:59], v[58:59], v[6:7]
    v_pk_fma_f32 v[124:125], v[60:61], v[60:61], v[6:7]
    v_pk_fma_f32 v[126:127], v[62:63], v[62:63], v[6:7]
    v_pk_mul_f32 v[112:113], v[112:113], v[48:49] neg_lo:[1,0] neg_hi:[1,0]
    v_pk_mul_f32 v[114:115], v[114:115], v[50:51] neg_lo:[1,0] neg_hi:[1,0]
    v_pk_mul_f32 v[116:117], v[116:117], v[52:53] neg_lo:[1,0] neg_hi:[1,0]
    v_pk_mul_f32 v[118:119], v[118:119], v[54:55] neg_lo:[1,0] neg_hi:[1,0]
    v_pk_mul_f32 v[120:121], v[120:121], v[56:57] neg_lo:[1,0] neg_hi:[1,0]
    v_pk_mul_f32 v[122:123], v[122:123], v[58:59] neg_lo:[1,0] neg_hi:[1,0]
L_hop6:
    s_cbranch_execz HOPRET_1
    s_nop 0
    v_pk_mul_f32 v[124:125], v[124:125], v[60:61] neg_lo:[1,0] neg_hi:[1,0]
    v_pk_mul_f32 v[126:127], v[126:127], v[62:63] neg_lo:[1,0] neg_hi:[1,0]
    s_waitcnt lgkmcnt(8)
    s_nop 0
    v_mfma_f32_32x32x16_bf16 v[32:47], a[0:3], v[64:67], 0
    ds_read_b64_tr_b16 v[64:65], v17 offset:0
    ds_read_b64_tr_b16 v[66:67], v17 offset:256
    s_add_u32 s55, s55, 4096
    buffer_load_dwordx4 v[228:231], v12, s[28:31], s55 offen offset:0 sc1
    v_exp_f32_e64 v112, v112
    v_mfma_f32_32x32x16_bf16 v[32:47], a[4:7], v[68:71], v[32:47]
    ds_read_b64_tr_b16 v[68:69], v17 offset:512
    ds_read_b64_tr_b16 v[70:71], v17 offset:768
    v_fma_f32 v112, v112, s58, s58
    v_exp_f32_e64 v113, v113
    v_mfma_f32_32x32x16_bf16 v[32:47], a[8:11], v[72:75], v[32:47]
    ds_read_b64_tr_b16 v[72:73], v17 offset:1024
    ds_read_b64_tr_b16 v[74:75], v17 offset:1280
    v_rcp_f32_e64 v112, v112
    v_fma_f32 v113, v113, s58, s58
    v_exp_f32_e64 v114, v114
    v_mfma_f32_32x32x16_bf16 v[32:47], a[12:15], v[76:79], v[32:47]
    ds_read_b64_tr_b16 v[76:77], v17 offset:1536
    ds_read_b64_tr_b16 v[78:79], v17 offset:1792
    v_mul_f32_e64 v112, v112, v48
    v_rcp_f32 v113, v113
    s_waitcnt lgkmcnt(8)
    v_mfma_f32_32x32x16_bf16 v[32:47], a[16:19], v[80:83], v[32:47]
    ds_read_b64_tr_b16 v[80:81], v17 offset:2048
    ds_read_b64_tr_b16 v[82:83], v17 offset:2304
    buffer_load_dwordx4 v[232:235], v12, s[28:31], s54 offen offset:1024 sc1
    v_fma_f32 v114, v114, s58, s58
    v_exp_f32_e64 v115, v115
    v_mfma_f32_32x32x16_bf16 v[32:47], a[20:23], v[84:87], v[32:47]
    ds_read_b64_tr_b16 v[84:85], v17 offset:2560
    ds_read_b64_tr_b16 v[86:87], v17 offset:2816
    v_mul_f32_e64 v113, v113, v49
    v_cvt_pk_bf16_f32 v128, v112, v113
    v_rcp_f32_e64 v114, v114
    v_mfma_f32_32x32x16_bf16 v[32:47], a[24:27], v[88:91], v[32:47]
    ds_read_b64_tr_b16 v[88:89], v17 offset:3072
    ds_read_b64_tr_b16 v[90:91], v17 offset:3328
    v_fma_f32 v115, v115, s58, s58
    v_exp_f32_e64 v116, v116
    v_mfma_f32_32x32x16_bf16 v[32:47], a[28:31], v[92:95], v[32:47]
    ds_read_b64_tr_b16 v[92:93], v17 offset:3584
    ds_read_b64_tr_b16 v[94:95], v17 offset:3840
    v_mul_f32_e64 v114, v114, v50
    v_rcp_f32 v115, v115
    s_waitcnt lgkmcnt(8)
    v_mfma_f32_32x32x16_bf16 v[32:47], a[32:35], v[64:67], v[32:47]
    ds_read_b64_tr_b16 v[64:65], v18 offset:0
    ds_read_b64_tr_b16 v[66:67], v18 offset:256
    v_fma_f32 v116, v116, s58, s58
    v_exp_f32 v117, v117
    v_mul_f32 v115, v115, v51
    v_mfma_f32_32x32x16_bf16 v[32:47], a[36:39], v[68:71], v[32:47]
    ds_read_b64_tr_b16 v[68:69], v18 offset:512
    ds_read_b64_tr_b16 v[70:71], v18 offset:768
    buffer_load_dwordx4 v[236:239], v12, s[28:31], s55 offen offset:1024 sc1
    v_cvt_pk_bf16_f32 v129, v114, v115
    v_rcp_f32_e64 v116, v116
    v_mfma_f32_32x32x16_bf16 v[32:47], a[40:43], v[72:75], v[32:47]
    ds_read_b64_tr_b16 v[72:73], v18 offset:1024
    ds_read_b64_tr_b16 v[74:75], v18 offset:1280
    v_fma_f32 v117, v117, s58, s58
    v_exp_f32 v118, v118
    v_mul_f32 v116, v116, v52
    v_mfma_f32_32x32x16_bf16 v[32:47], a[44:47], v[76:79], v[32:47]
    ds_read_b64_tr_b16 v[76:77], v18 offset:1536
    ds_read_b64_tr_b16 v[78:79], v18 offset:1792
    v_rcp_f32 v117, v117
    v_fma_f32 v118, v118, s58, s58
    s_waitcnt lgkmcnt(8)
    v_mfma_f32_32x32x16_bf16 v[32:47], a[48:51], v[80:83], v[32:47]
    ds_read_b64_tr_b16 v[80:81], v18 offset:2048
    ds_read_b64_tr_b16 v[82:83], v18 offset:2304
    v_exp_f32 v119, v119
    v_mul_f32 v117, v117, v53
    v_mfma_f32_32x32x16_bf16 v[32:47], a[52:55], v[84:87], v[32:47]
    ds_read_b64_tr_b16 v[84:85], v18 offset:2560
    ds_read_b64_tr_b16 v[86:87], v18 offset:2816
    buffer_load_dwordx4 v[240:243], v12, s[28:31], s54 offen offset:2048 sc1
    v_cvt_pk_bf16_f32 v130, v116, v117
    v_rcp_f32_e64 v118, v118
    v_mfma_f32_32x32x16_bf16 v[32:47], a[56:59], v[88:91], v[32:47]
    ds_read_b64_tr_b16 v[88:89], v18 offset:3072
    ds_read_b64_tr_b16 v[90:91], v18 offset:3328
    v_fma_f32 v119, v119, s58, s58
    v_exp_f32 v120, v120
    v_mul_f32 v118, v118, v54
    v_mfma_f32_32x32x16_bf16 v[32:47], a[60:63], v[92:95], v[32:47]
    ds_read_b64_tr_b16 v[92:93], v18 offset:3584
    ds_read_b64_tr_b16 v[94:95], v18 offset:3840
    v_rcp_f32 v119, v119
    s_waitcnt lgkmcnt(8)
    s_waitcnt vmcnt(15)
    s_barrier
    v_mfma_f32_32x32x16_bf16 v[32:47], a[64:67], v[64:67], v[32:47]
    ds_read_b64_tr_b16 v[64:65], v19 offset:0
    ds_read_b64_tr_b16 v[66:67], v19 offset:256
    v_fma_f32 v120, v120, s58, s58
    v_exp_f32_e64 v121, v121
    v_mfma_f32_32x32x16_bf16 v[32:47], a[68:71], v[68:71], v[32:47]
    ds_read_b64_tr_b16 v[68:69], v19 offset:512
    ds_read_b64_tr_b16 v[70:71], v19 offset:768
    v_mul_f32_e64 v119, v119, v55
    v_cvt_pk_bf16_f32 v131, v118, v119
    v_rcp_f32_e64 v120, v120
    v_mfma_f32_32x32x16_bf16 v[32:47], a[72:75], v[72:75], v[32:47]
    ds_read_b64_tr_b16 v[72:73], v19 offset:1024
    ds_read_b64_tr_b16 v[74:75], v19 offset:1280
    buffer_load_dwordx4 v[244:247], v12, s[28:31], s55 offen offset:2048 sc1
    v_fma_f32 v121, v121, s58, s58
    s_add_u32 s48, s48, 262144
    buffer_store_dwordx4 v[128:131], v20, s[28:31], s48 offen offset:0 sc1
    v_mfma_f32_32x32x16_bf16 v[32:47], a[76:79], v[76:79], v[32:47]
    ds_read_b64_tr_b16 v[76:77], v19 offset:1536
    ds_read_b64_tr_b16 v[78:79], v19 offset:1792
    v_exp_f32_e64 v122, v122
    v_mul_f32 v120, v120, v56
    s_waitcnt lgkmcnt(8)
    v_mfma_f32_32x32x16_bf16 v[32:47], a[80:83], v[80:83], v[32:47]
    ds_read_b64_tr_b16 v[80:81], v19 offset:2048
    ds_read_b64_tr_b16 v[82:83], v19 offset:2304
    v_rcp_f32_e64 v121, v121
    v_fma_f32 v122, v122, s58, s58
    v_mfma_f32_32x32x16_bf16 v[32:47], a[84:87], v[84:87], v[32:47]
    ds_read_b64_tr_b16 v[84:85], v19 offset:2560
    ds_read_b64_tr_b16 v[86:87], v19 offset:2816
    v_exp_f32 v123, v123
    v_mul_f32 v121, v121, v57
    v_cvt_pk_bf16_f32 v132, v120, v121
    v_mfma_f32_32x32x16_bf16 v[32:47], a[88:91], v[88:91], v[32:47]
    ds_read_b64_tr_b16 v[88:89], v19 offset:3072
    ds_read_b64_tr_b16 v[90:91], v19 offset:3328
    buffer_load_dwordx4 v[248:251], v12, s[28:31], s54 offen offset:3072 sc1
    v_rcp_f32_e64 v122, v122
    v_fma_f32 v123, v123, s58, s58
    v_mfma_f32_32x32x16_bf16 v[32:47], a[92:95], v[92:95], v[32:47]
    ds_read_b64_tr_b16 v[92:93], v19 offset:3584
    ds_read_b64_tr_b16 v[94:95], v19 offset:3840
    v_exp_f32_e64 v124, v124
    v_mul_f32 v122, v122, v58
    s_waitcnt lgkmcnt(8)
    v_mfma_f32_32x32x16_bf16 v[32:47], a[96:99], v[64:67], v[32:47]
    ds_read_b64_tr_b16 v[64:65], v16 offset:33024
    ds_read_b64_tr_b16 v[66:67], v16 offset:33280
    v_rcp_f32_e64 v123, v123
    v_fma_f32 v124, v124, s58, s58
    v_mfma_f32_32x32x16_bf16 v[32:47], a[100:103], v[68:71], v[32:47]
    ds_read_b64_tr_b16 v[68:69], v16 offset:33536
    ds_read_b64_tr_b16 v[70:71], v16 offset:33792
    v_exp_f32 v125, v125
    v_mul_f32 v123, v123, v59
    v_cvt_pk_bf16_f32 v133, v122, v123
    v_mfma_f32_32x32x16_bf16 v[32:47], a[104:107], v[72:75], v[32:47]
    ds_read_b64_tr_b16 v[72:73], v16 offset:34048
    ds_read_b64_tr_b16 v[74:75], v16 offset:34304
    v_rcp_f32_e64 v124, v124
    v_fma_f32 v125, v125, s58, s58
    v_exp_f32_e64 v126, v126
    v_mfma_f32_32x32x16_bf16 v[32:47], a[108:111], v[76:79], v[32:47]
    ds_read_b64_tr_b16 v[76:77], v16 offset:34560
    ds_read_b64_tr_b16 v[78:79], v16 offset:34816
    buffer_load_dwordx4 v[252:255], v12, s[28:31], s55 offen offset:3072 sc1
    v_mul_f32 v124, v124, v60
    s_waitcnt lgkmcnt(8)
    v_mfma_f32_32x32x16_bf16 v[32:47], a[112:115], v[80:83], v[32:47]
    ds_read_b64_tr_b16 v[80:81], v16 offset:35072
    ds_read_b64_tr_b16 v[82:83], v16 offset:35328
    v_rcp_f32_e64 v125, v125
    v_fma_f32 v126, v126, s58, s58
    v_exp_f32_e64 v127, v127
    v_mfma_f32_32x32x16_bf16 v[32:47], a[116:119], v[84:87], v[32:47]
    ds_read_b64_tr_b16 v[84:85], v16 offset:35584
    ds_read_b64_tr_b16 v[86:87], v16 offset:35840
    v_mul_f32_e64 v125, v125, v61
    v_cvt_pk_bf16_f32 v134, v124, v125
    v_rcp_f32_e64 v126, v126
    v_mfma_f32_32x32x16_bf16 v[32:47], a[120:123], v[88:91], v[32:47]
    ds_read_b64_tr_b16 v[88:89], v16 offset:36096
    ds_read_b64_tr_b16 v[90:91], v16 offset:36352
    v_fma_f32 v127, v127, s58, s58
    v_mul_f32 v126, v126, v62
    v_rcp_f32 v127, v127
    v_mfma_f32_32x32x16_bf16 v[32:47], a[124:127], v[92:95], v[32:47]
    ds_read_b64_tr_b16 v[92:93], v16 offset:36608
    ds_read_b64_tr_b16 v[94:95], v16 offset:36864
    v_mul_f32 v127, v127, v63
    v_cvt_pk_bf16_f32 v135, v126, v127
    buffer_store_dwordx4 v[132:135], v20, s[28:31], s48 offen offset:1024 sc1
    s_nop 6
    v_pk_fma_f32 v[32:33], v[32:33], v[30:31], v[96:97] op_sel_hi:[1,0,1] neg_lo:[0,1,0] neg_hi:[0,1,0]
    v_pk_fma_f32 v[34:35], v[34:35], v[30:31], v[98:99] op_sel_hi:[1,0,1] neg_lo:[0,1,0] neg_hi:[0,1,0]
    v_pk_fma_f32 v[36:37], v[36:37], v[30:31], v[100:101] op_sel_hi:[1,0,1] neg_lo:[0,1,0] neg_hi:[0,1,0]
    v_pk_fma_f32 v[38:39], v[38:39], v[30:31], v[102:103] op_sel_hi:[1,0,1] neg_lo:[0,1,0] neg_hi:[0,1,0]
    v_pk_fma_f32 v[40:41], v[40:41], v[30:31], v[104:105] op_sel_hi:[1,0,1] neg_lo:[0,1,0] neg_hi:[0,1,0]
    v_pk_fma_f32 v[42:43], v[42:43], v[30:31], v[106:107] op_sel_hi:[1,0,1] neg_lo:[0,1,0] neg_hi:[0,1,0]
    v_pk_fma_f32 v[44:45], v[44:45], v[30:31], v[108:109] op_sel_hi:[1,0,1] neg_lo:[0,1,0] neg_hi:[0,1,0]
    v_pk_fma_f32 v[46:47], v[46:47], v[30:31], v[110:111] op_sel_hi:[1,0,1] neg_lo:[0,1,0] neg_hi:[0,1,0]
    v_pk_fma_f32 v[112:113], v[32:33], v[32:33], v[6:7]
    v_pk_fma_f32 v[114:115], v[34:35], v[34:35], v[6:7]
    v_pk_fma_f32 v[116:117], v[36:37], v[36:37], v[6:7]
    v_pk_fma_f32 v[118:119], v[38:39], v[38:39], v[6:7]
    v_pk_fma_f32 v[120:121], v[40:41], v[40:41], v[6:7]
    v_pk_fma_f32 v[122:123], v[42:43], v[42:43], v[6:7]
    v_pk_fma_f32 v[124:125], v[44:45], v[44:45], v[6:7]
    v_pk_fma_f32 v[126:127], v[46:47], v[46:47], v[6:7]
    v_pk_mul_f32 v[112:113], v[112:113], v[32:33] neg_lo:[1,0] neg_hi:[1,0]
    v_pk_mul_f32 v[114:115], v[114:115], v[34:35] neg_lo:[1,0] neg_hi:[1,0]
    v_pk_mul_f32 v[116:117], v[116:117], v[36:37] neg_lo:[1,0] neg_hi:[1,0]
    v_pk_mul_f32 v[118:119], v[118:119], v[38:39] neg_lo:[1,0] neg_hi:[1,0]
    v_pk_mul_f32 v[120:121], v[120:121], v[40:41] neg_lo:[1,0] neg_hi:[1,0]
    v_pk_mul_f32 v[122:123], v[122:123], v[42:43] neg_lo:[1,0] neg_hi:[1,0]
    v_pk_mul_f32 v[124:125], v[124:125], v[44:45] neg_lo:[1,0] neg_hi:[1,0]
    v_pk_mul_f32 v[126:127], v[126:127], v[46:47] neg_lo:[1,0] neg_hi:[1,0]
    s_waitcnt lgkmcnt(8)
    s_nop 0
    v_mfma_f32_32x32x16_bf16 v[48:63], a[0:3], v[64:67], 0
    ds_read_b64_tr_b16 v[64:65], v17 offset:33024
    ds_read_b64_tr_b16 v[66:67], v17 offset:33280
    buffer_load_dwordx4 a[0:3], v12, s[28:31], s52 offen offset:0 sc1
    v_exp_f32 v112, v112
    s_nop 0
    v_fma_f32 v112, v112, s58, s58
    v_mfma_f32_32x32x16_bf16 v[48:63], a[4:7], v[68:71], v[48:63]
    ds_read_b64_tr_b16 v[68:69], v17 offset:33536
    ds_read_b64_tr_b16 v[70:71], v17 offset:33792
    v_exp_f32 v113, v113
    v_rcp_f32 v112, v112
    v_mfma_f32_32x32x16_bf16 v[48:63], a[8:11], v[72:75], v[48:63]
    ds_read_b64_tr_b16 v[72:73], v17 offset:34048
    ds_read_b64_tr_b16 v[74:75], v17 offset:34304
    v_fma_f32 v113, v113, s58, s58
    v_exp_f32_e64 v114, v114
    v_mfma_f32_32x32x16_bf16 v[48:63], a[12:15], v[76:79], v[48:63]
    ds_read_b64_tr_b16 v[76:77], v17 offset:34560
    ds_read_b64_tr_b16 v[78:79], v17 offset:34816
    v_mul_f32_e64 v112, v112, v32
    v_rcp_f32 v113, v113
    s_waitcnt lgkmcnt(8)
    v_mfma_f32_32x32x16_bf16 v[48:63], a[16:19], v[80:83], v[48:63]
    ds_read_b64_tr_b16 v[80:81], v17 offset:35072
    ds_read_b64_tr_b16 v[82:83], v17 offset:35328
    buffer_load_dwordx4 a[4:7], v12, s[28:31], s52 offen offset:1024 sc1
    v_fma_f32 v114, v114, s58, s58
    v_exp_f32_e64 v115, v115
    v_mfma_f32_32x32x16_bf16 v[48:63], a[20:23], v[84:87], v[48:63]
    ds_read_b64_tr_b16 v[84:85], v17 offset:35584
    ds_read_b64_tr_b16 v[86:87], v17 offset:35840
    v_mul_f32_e64 v113, v113, v33
    v_cvt_pk_bf16_f32 v128, v112, v113
    v_mfma_f32_32x32x16_bf16 v[48:63], a[24:27], v[88:91], v[48:63]
    ds_read_b64_tr_b16 v[88:89], v17 offset:36096
    ds_read_b64_tr_b16 v[90:91], v17 offset:36352
    v_rcp_f32_e64 v114, v114
    v_fma_f32 v115, v115, s58, s58
    v_exp_f32_e64 v116, v116
    v_mfma_f32_32x32x16_bf16 v[48:63], a[28:31], v[92:95], v[48:63]
    ds_read_b64_tr_b16 v[92:93], v17 offset:36608
    ds_read_b64_tr_b16 v[94:95], v17 offset:36864
    v_mul_f32_e64 v114, v114, v34
    v_rcp_f32 v115, v115
    s_waitcnt lgkmcnt(8)
    v_mfma_f32_32x32x16_bf16 v[48:63], a[32:35], v[64:67], v[48:63]
    ds_read_b64_tr_b16 v[64:65], v18 offset:33024
    ds_read_b64_tr_b16 v[66:67], v18 offset:33280
    buffer_load_dwordx4 a[8:11], v12, s[28:31], s52 offen offset:2048 sc1
    v_fma_f32 v116, v116, s58, s58
    v_mfma_f32_32x32x16_bf16 v[48:63], a[36:39], v[68:71], v[48:63]
    ds_read_b64_tr_b16 v[68:69], v18 offset:33536
    ds_read_b64_tr_b16 v[70:71], v18 offset:33792
    v_exp_f32 v117, v117
    v_mul_f32 v115, v115, v35
    v_cvt_pk_bf16_f32 v129, v114, v115
    v_mfma_f32_32x32x16_bf16 v[48:63], a[40:43], v[72:75], v[48:63]
    ds_read_b64_tr_b16 v[72:73], v18 offset:34048
    ds_read_b64_tr_b16 v[74:75], v18 offset:34304
    v_rcp_f32_e64 v116, v116
    v_fma_f32 v117, v117, s58, s58
    v_mfma_f32_32x32x16_bf16 v[48:63], a[44:47], v[76:79], v[48:63]
    ds_read_b64_tr_b16 v[76:77], v18 offset:34560
    ds_read_b64_tr_b16 v[78:79], v18 offset:34816
    v_exp_f32 v118, v118
    s_waitcnt lgkmcnt(8)
    s_waitcnt vmcnt(3)
    s_barrier
    v_mfma_f32_32x32x16_bf16 v[48:63], a[48:51], v[80:83], v[48:63]
    ds_read_b64_tr_b16 v[80:81], v18 offset:35072
    ds_read_b64_tr_b16 v[82:83], v18 offset:35328
    s_cmp_lg_u32 s3, 0
    s_cbranch_scc1 Lfl_1018
    v_mov_b32_e64 v9, 3
    v_lshlrev_b32 v11, 2, v0
    s_mov_b64 exec, 0xffff
    buffer_store_dword v9, v11, s[28:31], s63 offen sc1
    s_mov_b64 exec, -1
Lfl_1018:
    buffer_load_dwordx4 a[12:15], v12, s[28:31], s52 offen offset:3072 sc1
    v_mfma_f32_32x32x16_bf16 v[48:63], a[52:55], v[84:87], v[48:63]
    ds_read_b64_tr_b16 v[84:85], v18 offset:35584
    ds_read_b64_tr_b16 v[86:87], v18 offset:35840
    v_mfma_f32_32x32x16_bf16 v[48:63], a[56:59], v[88:91], v[48:63]
    ds_read_b64_tr_b16 v[88:89], v18 offset:36096
    ds_read_b64_tr_b16 v[90:91], v18 offset:36352
    v_mul_f32 v116, v116, v36
    v_rcp_f32 v117, v117
    v_mfma_f32_32x32x16_bf16 v[48:63], a[60:63], v[92:95], v[48:63]
    ds_read_b64_tr_b16 v[92:93], v18 offset:36608
    ds_read_b64_tr_b16 v[94:95], v18 offset:36864
    v_fma_f32 v118, v118, s58, s58
    v_exp_f32 v119, v119
    s_waitcnt lgkmcnt(8)
    v_mfma_f32_32x32x16_bf16 v[48:63], a[64:67], v[64:67], v[48:63]
    ds_read_b64_tr_b16 v[64:65], v19 offset:33024
    ds_read_b64_tr_b16 v[66:67], v19 offset:33280
    s_add_u32 s52, s52, 4096
    buffer_load_dwordx4 a[16:19], v12, s[28:31], s52 offen offset:0 sc1
    v_mul_f32_e64 v117, v117, v37
    v_mfma_f32_32x32x16_bf16 v[48:63], a[68:71], v[68:71], v[48:63]
    ds_read_b64_tr_b16 v[68:69], v19 offset:33536
    ds_read_b64_tr_b16 v[70:71], v19 offset:33792
    v_cvt_pk_bf16_f32 v130, v116, v117
    v_rcp_f32_e64 v118, v118
    v_mfma_f32_32x32x16_bf16 v[48:63], a[72:75], v[72:75], v[48:63]
    ds_read_b64_tr_b16 v[72:73], v19 offset:34048
    ds_read_b64_tr_b16 v[74:75], v19 offset:34304
    v_fma_f32 v119, v119, s58, s58
    v_exp_f32 v120, v120
    v_mul_f32 v118, v118, v38
    v_mfma_f32_32x32x16_bf16 v[48:63], a[76:79], v[76:79], v[48:63]
    ds_read_b64_tr_b16 v[76:77], v19 offset:34560
    ds_read_b64_tr_b16 v[78:79], v19 offset:34816
    v_rcp_f32 v119, v119
    v_fma_f32 v120, v120, s58, s58
    s_waitcnt lgkmcnt(8)
    v_mfma_f32_32x32x16_bf16 v[48:63], a[80:83], v[80:83], v[48:63]
    ds_read_b64_tr_b16 v[80:81], v19 offset:35072
    ds_read_b64_tr_b16 v[82:83], v19 offset:35328
    buffer_load_dwordx4 a[20:23], v12, s[28:31], s52 offen offset:1024 sc1
    v_exp_f32_e64 v121, v121
    v_mfma_f32_32x32x16_bf16 v[48:63], a[84:87], v[84:87], v[48:63]
    ds_read_b64_tr_b16 v[84:85], v19 offset:35584
    ds_read_b64_tr_b16 v[86:87], v19 offset:35840
    v_mul_f32_e64 v119, v119, v39
    v_cvt_pk_bf16_f32 v131, v118, v119
    v_rcp_f32_e64 v120, v120
    v_mfma_f32_32x32x16_bf16 v[48:63], a[88:91], v[88:91], v[48:63]
    ds_read_b64_tr_b16 v[88:89], v19 offset:36096
    ds_read_b64_tr_b16 v[90:91], v19 offset:36352
    v_fma_f32 v121, v121, s58, s58
    s_add_u32 s48, s48, 262144
    buffer_store_dwordx4 v[128:131], v20, s[28:31], s48 offen offset:0 sc1
    v_mfma_f32_32x32x16_bf16 v[48:63], a[92:95], v[92:95], v[48:63]
    ds_read_b64_tr_b16 v[92:93], v19 offset:36608
    ds_read_b64_tr_b16 v[94:95], v19 offset:36864
    v_exp_f32_e64 v122, v122
    v_mul_f32 v120, v120, v40
    s_waitcnt lgkmcnt(8)
    v_mfma_f32_32x32x16_bf16 v[48:63], a[96:99], v[64:67], v[48:63]
    buffer_load_dwordx4 a[24:27], v12, s[28:31], s52 offen offset:2048 sc1
    v_rcp_f32_e64 v121, v121
    v_fma_f32 v122, v122, s58, s58
    v_exp_f32_e64 v123, v123
    v_mfma_f32_32x32x16_bf16 v[48:63], a[100:103], v[68:71], v[48:63]
    v_mul_f32_e64 v121, v121, v41
    v_cvt_pk_bf16_f32 v132, v120, v121
    v_rcp_f32_e64 v122, v122
    v_fma_f32 v123, v123, s58, s58
    v_mfma_f32_32x32x16_bf16 v[48:63], a[104:107], v[72:75], v[48:63]
    v_exp_f32 v124, v124
    v_mul_f32 v122, v122, v42
    v_rcp_f32_e64 v123, v123
    v_fma_f32 v124, v124, s58, s58
    v_mfma_f32_32x32x16_bf16 v[48:63], a[108:111], v[76:79], v[48:63]
    v_exp_f32_e64 v125, v125
    v_mul_f32 v123, v123, v43
    v_cvt_pk_bf16_f32 v133, v122, v123
    s_waitcnt lgkmcnt(0)
    v_mfma_f32_32x32x16_bf16 v[48:63], a[112:115], v[80:83], v[48:63]
    buffer_load_dwordx4 a[28:31], v12, s[28:31], s52 offen offset:3072 sc1
    v_rcp_f32_e64 v124, v124
    v_fma_f32 v125, v125, s58, s58
    v_exp_f32_e64 v126, v126
    v_mfma_f32_32x32x16_bf16 v[48:63], a[116:119], v[84:87], v[48:63]
    v_mul_f32 v124, v124, v44
    v_rcp_f32 v125, v125
    v_fma_f32 v126, v126, s58, s58
    v_exp_f32_e64 v127, v127
    v_mfma_f32_32x32x16_bf16 v[48:63], a[120:123], v[88:91], v[48:63]
    v_mul_f32_e64 v125, v125, v45
    v_cvt_pk_bf16_f32 v134, v124, v125
    v_rcp_f32_e64 v126, v126
    v_fma_f32 v127, v127, s58, s58
    v_mfma_f32_32x32x16_bf16 v[48:63], a[124:127], v[92:95], v[48:63]
    v_mul_f32 v126, v126, v46
    v_rcp_f32 v127, v127
    s_nop 0
    v_mul_f32 v127, v127, v47
    v_cvt_pk_bf16_f32 v135, v126, v127
    buffer_store_dwordx4 v[132:135], v20, s[28:31], s48 offen offset:1024 sc1
    buffer_load_dword v13, v10, s[28:31], s40 offen sc1
    ds_read_b64_tr_b16 v[64:65], v25 offset:0
    ds_read_b64_tr_b16 v[66:67], v25 offset:256
    s_nop 2
    s_nop 0
    v_pk_fma_f32 v[48:49], v[48:49], v[22:23], v[96:97] op_sel_hi:[1,0,1] neg_lo:[0,1,0] neg_hi:[0,1,0]
    v_pk_fma_f32 v[50:51], v[50:51], v[22:23], v[98:99] op_sel_hi:[1,0,1] neg_lo:[0,1,0] neg_hi:[0,1,0]
    v_pk_fma_f32 v[52:53], v[52:53], v[22:23], v[100:101] op_sel_hi:[1,0,1] neg_lo:[0,1,0] neg_hi:[0,1,0]
    v_pk_fma_f32 v[54:55], v[54:55], v[22:23], v[102:103] op_sel_hi:[1,0,1] neg_lo:[0,1,0] neg_hi:[0,1,0]
    v_pk_fma_f32 v[112:113], v[48:49], v[48:49], v[6:7]
    v_pk_fma_f32 v[114:115], v[50:51], v[50:51], v[6:7]
    v_pk_fma_f32 v[116:117], v[52:53], v[52:53], v[6:7]
    v_pk_fma_f32 v[118:119], v[54:55], v[54:55], v[6:7]
    ds_read_b64_tr_b16 v[68:69], v25 offset:512
    ds_read_b64_tr_b16 v[70:71], v25 offset:768
    v_pk_mul_f32 v[112:113], v[112:113], v[48:49] neg_lo:[1,0] neg_hi:[1,0]
    v_pk_mul_f32 v[114:115], v[114:115], v[50:51] neg_lo:[1,0] neg_hi:[1,0]
    v_pk_mul_f32 v[116:117], v[116:117], v[52:53] neg_lo:[1,0] neg_hi:[1,0]
    v_pk_mul_f32 v[118:119], v[118:119], v[54:55] neg_lo:[1,0] neg_hi:[1,0]
    v_exp_f32 v112, v112
    v_exp_f32 v113, v113
    v_exp_f32 v114, v114
    v_exp_f32 v115, v115
    ds_read_b64_tr_b16 v[72:73], v25 offset:1024
    ds_read_b64_tr_b16 v[74:75], v25 offset:1280
    v_exp_f32 v116, v116
    v_exp_f32 v117, v117
    v_exp_f32 v118, v118
    v_exp_f32 v119, v119
    v_pk_fma_f32 v[112:113], v[112:113], s[58:59], s[58:59]
    v_pk_fma_f32 v[114:115], v[114:115], s[58:59], s[58:59]
    v_pk_fma_f32 v[116:117], v[116:117], s[58:59], s[58:59]
    v_pk_fma_f32 v[118:119], v[118:119], s[58:59], s[58:59]
    ds_read_b64_tr_b16 v[76:77], v25 offset:1536
    ds_read_b64_tr_b16 v[78:79], v25 offset:1792
    v_rcp_f32 v112, v112
    v_rcp_f32 v113, v113
    v_rcp_f32 v114, v114
    v_rcp_f32 v115, v115
    v_rcp_f32 v116, v116
    v_rcp_f32 v117, v117
    v_rcp_f32 v118, v118
    v_rcp_f32 v119, v119
    v_pk_mul_f32 v[112:113], v[112:113], v[48:49]
    ds_read_b64_tr_b16 v[80:81], v25 offset:2048
    ds_read_b64_tr_b16 v[82:83], v25 offset:2304
    v_pk_mul_f32 v[114:115], v[114:115], v[50:51]
    v_pk_mul_f32 v[116:117], v[116:117], v[52:53]
    v_pk_mul_f32 v[118:119], v[118:119], v[54:55]
    v_cvt_pk_bf16_f32 v128, v112, v113
    v_cvt_pk_bf16_f32 v129, v114, v115
    v_cvt_pk_bf16_f32 v130, v116, v117
    v_cvt_pk_bf16_f32 v131, v118, v119
    s_add_u32 s48, s48, 262144
    ds_read_b64_tr_b16 v[84:85], v25 offset:2560
    ds_read_b64_tr_b16 v[86:87], v25 offset:2816
    buffer_store_dwordx4 v[128:131], v20, s[28:31], s48 offen offset:0 sc1
    v_pk_fma_f32 v[56:57], v[56:57], v[22:23], v[104:105] op_sel_hi:[1,0,1] neg_lo:[0,1,0] neg_hi:[0,1,0]
    v_pk_fma_f32 v[58:59], v[58:59], v[22:23], v[106:107] op_sel_hi:[1,0,1] neg_lo:[0,1,0] neg_hi:[0,1,0]
    v_pk_fma_f32 v[60:61], v[60:61], v[22:23], v[108:109] op_sel_hi:[1,0,1] neg_lo:[0,1,0] neg_hi:[0,1,0]
    v_pk_fma_f32 v[62:63], v[62:63], v[22:23], v[110:111] op_sel_hi:[1,0,1] neg_lo:[0,1,0] neg_hi:[0,1,0]
    v_pk_fma_f32 v[120:121], v[56:57], v[56:57], v[6:7]
    v_pk_fma_f32 v[122:123], v[58:59], v[58:59], v[6:7]
    v_pk_fma_f32 v[124:125], v[60:61], v[60:61], v[6:7]
    ds_read_b64_tr_b16 v[88:89], v25 offset:3072
    ds_read_b64_tr_b16 v[90:91], v25 offset:3328
    v_pk_fma_f32 v[126:127], v[62:63], v[62:63], v[6:7]
    v_pk_mul_f32 v[120:121], v[120:121], v[56:57] neg_lo:[1,0] neg_hi:[1,0]
    v_pk_mul_f32 v[122:123], v[122:123], v[58:59] neg_lo:[1,0] neg_hi:[1,0]
    v_pk_mul_f32 v[124:125], v[124:125], v[60:61] neg_lo:[1,0] neg_hi:[1,0]
    v_pk_mul_f32 v[126:127], v[126:127], v[62:63] neg_lo:[1,0] neg_hi:[1,0]
    v_exp_f32 v120, v120
    v_exp_f32 v121, v121
    v_exp_f32_e64 v122, v122
    ds_read_b64_tr_b16 v[92:93], v25 offset:3584
    ds_read_b64_tr_b16 v[94:95], v25 offset:3840
    v_exp_f32 v123, v123
    v_exp_f32 v124, v124
    v_exp_f32 v125, v125
    v_exp_f32 v126, v126
    v_exp_f32_e64 v127, v127
    v_pk_fma_f32 v[120:121], v[120:121], s[58:59], s[58:59]
    v_pk_fma_f32 v[122:123], v[122:123], s[58:59], s[58:59]
    v_pk_fma_f32 v[124:125], v[124:125], s[58:59], s[58:59]
    v_pk_fma_f32 v[126:127], v[126:127], s[58:59], s[58:59]
    v_rcp_f32 v120, v120
    v_rcp_f32 v121, v121
    v_rcp_f32 v122, v122
    v_rcp_f32 v123, v123
    v_rcp_f32 v124, v124
    v_rcp_f32 v125, v125
    v_rcp_f32 v126, v126
    v_rcp_f32 v127, v127
    v_pk_mul_f32 v[120:121], v[120:121], v[56:57]
    v_pk_mul_f32 v[122:123], v[122:123], v[58:59]
    v_pk_mul_f32 v[124:125], v[124:125], v[60:61]
    v_pk_mul_f32 v[126:127], v[126:127], v[62:63]
    v_cvt_pk_bf16_f32 v132, v120, v121
    v_cvt_pk_bf16_f32 v133, v122, v123
    v_cvt_pk_bf16_f32 v134, v124, v125
    v_cvt_pk_bf16_f32 v135, v126, v127
    buffer_store_dwordx4 v[132:135], v20, s[28:31], s48 offen offset:1024 sc1
L_g1_join1:
    s_waitcnt vmcnt(2)
    v_cmp_gt_u32 vcc, 3, v13
    s_mov_b32 s60, 0
    s_cbranch_vccz Lok_35
Lretry_36:
    buffer_load_dword v13, v10, s[28:31], s40 offen sc1
    s_waitcnt vmcnt(0)
    v_cmp_gt_u32 vcc, 3, v13
    s_add_u32 s60, s60, 1
    s_cbranch_vccz Lok_35
    s_sleep 1
    s_cmp_lt_u32 s60, s61
    s_cbranch_scc1 Lretry_36
    s_mov_b32 s61, 1
Lok_35:
    v_lshlrev_b32_e64 v32, 16, v144
    v_and_b32 v33, 0xffff0000, v144
    v_lshlrev_b32_e64 v34, 16, v145
    v_and_b32 v35, 0xffff0000, v145
    v_lshlrev_b32_e64 v36, 16, v146
    v_and_b32 v37, 0xffff0000, v146
    v_lshlrev_b32_e64 v38, 16, v147
    v_and_b32 v39, 0xffff0000, v147
    v_mov_b32 v40, 0
    v_mov_b32 v41, 0
    v_mov_b32 v42, 0
    v_mov_b32 v43, 0
    v_mov_b32 v44, 0
    v_mov_b32 v45, 0
    v_mov_b32 v46, 0
    v_mov_b32 v47, 0
    v_add_u32 v25, 66048, v25
    s_waitcnt vmcnt(4) lgkmcnt(0)
    v_xor_b32 v65, s25, v65
    v_xor_b32 v67, s25, v67
    v_xor_b32 v69, s25, v69
    v_xor_b32_e64 v71, s25, v71
    v_mfma_f32_32x32x16_bf16 v[32:47], a[0:3], v[64:67], v[32:47]
    v_xor_b32 v65, s24, v65
    v_xor_b32 v67, s24, v67
    ds_read_b64_tr_b16 v[128:129], v25 offset:0
    ds_read_b64_tr_b16 v[130:131], v25 offset:256
    buffer_load_dwordx4 v[96:99], v2, s[28:31], s4 offen offset:0 sc1
    v_xor_b32 v73, s25, v73
    v_xor_b32 v75, s25, v75
    v_mfma_f32_32x32x16_bf16 v[32:47], a[4:7], v[68:71], v[32:47]
    v_xor_b32 v69, s24, v69
    v_xor_b32 v71, s24, v71
    ds_read_b64_tr_b16 v[132:133], v25 offset:512
    ds_read_b64_tr_b16 v[134:135], v25 offset:768
    v_mfma_f32_32x32x16_bf16 v[48:63], a[0:3], v[64:67], 0
    buffer_load_dwordx4 v[100:103], v2, s[28:31], s4 offen offset:1024 sc1
    v_xor_b32 v77, s25, v77
    v_xor_b32 v79, s25, v79
    v_mfma_f32_32x32x16_bf16 v[32:47], a[8:11], v[72:75], v[32:47]
    v_xor_b32 v73, s24, v73
    v_xor_b32 v75, s24, v75
    ds_read_b64_tr_b16 v[136:137], v25 offset:1024
    ds_read_b64_tr_b16 v[138:139], v25 offset:1280
    v_mfma_f32_32x32x16_bf16 v[48:63], a[4:7], v[68:71], v[48:63]
    buffer_load_dwordx4 v[104:107], v2, s[28:31], s4 offen offset:2048 sc1
    v_xor_b32 v81, s25, v81
    v_xor_b32 v83, s25, v83
    v_mfma_f32_32x32x16_bf16 v[32:47], a[12:15], v[76:79], v[32:47]
    v_xor_b32 v77, s24, v77
    v_xor_b32 v79, s24, v79
    ds_read_b64_tr_b16 v[140:141], v25 offset:1536
    ds_read_b64_tr_b16 v[142:143], v25 offset:1792
    v_mfma_f32_32x32x16_bf16 v[48:63], a[8:11], v[72:75], v[48:63]
    buffer_load_dwordx4 v[108:111], v2, s[28:31], s4 offen offset:3072 sc1
    v_xor_b32 v85, s25, v85
    v_xor_b32 v87, s25, v87
    v_mfma_f32_32x32x16_bf16 v[32:47], a[16:19], v[80:83], v[32:47]
    v_xor_b32 v81, s24, v81
    v_xor_b32 v83, s24, v83
    ds_read_b64_tr_b16 v[16:17], v25 offset:2048
    ds_read_b64_tr_b16 v[18:19], v25 offset:2304
    v_mfma_f32_32x32x16_bf16 v[48:63], a[12:15], v[76:79], v[48:63]
    v_lshlrev_b32_e64 v64, 16, v144
    v_and_b32 v65, 0xffff0000, v144
    v_lshlrev_b32 v66, 16, v145
    v_and_b32 v67, 0xffff0000, v145
    s_add_u32 s4, s4, s22
    buffer_load_dwordx4 v[112:115], v2, s[28:31], s4 offen offset:0 sc1
    v_xor_b32 v89, s25, v89
    v_xor_b32 v91, s25, v91
L_hop7:
    s_cbranch_execz HOPRET_2
    v_mfma_f32_32x32x16_bf16 v[32:47], a[20:23], v[84:87], v[32:47]
    v_xor_b32_e64 v85, s24, v85
    v_xor_b32 v87, s24, v87
    ds_read_b64_tr_b16 v[20:21], v25 offset:2560
    ds_read_b64_tr_b16 v[22:23], v25 offset:2816
    v_mfma_f32_32x32x16_bf16 v[48:63], a[16:19], v[80:83], v[48:63]
    v_lshlrev_b32_e64 v68, 16, v146
    v_and_b32 v69, 0xffff0000, v146
    v_lshlrev_b32_e64 v70, 16, v147
    v_and_b32 v71, 0xffff0000, v147
    buffer_load_dwordx4 v[116:119], v2, s[28:31], s4 offen offset:1024 sc1
    v_xor_b32 v93, s25, v93
    v_xor_b32 v95, s25, v95
    v_mfma_f32_32x32x16_bf16 v[32:47], a[24:27], v[88:91], v[32:47]
    v_xor_b32 v89, s24, v89
    v_xor_b32 v91, s24, v91
    ds_read_b64_tr_b16 v[28:29], v25 offset:3072
    ds_read_b64_tr_b16 v[30:31], v25 offset:3328
    v_mfma_f32_32x32x16_bf16 v[48:63], a[20:23], v[84:87], v[48:63]
    v_mov_b32 v72, 0
    v_mov_b32 v73, 0
    v_mov_b32 v74, 0
    v_mov_b32 v75, 0
    buffer_load_dwordx4 v[120:123], v2, s[28:31], s4 offen offset:2048 sc1
    s_waitcnt lgkmcnt(6)
    v_xor_b32 v129, s25, v129
    v_xor_b32_e64 v131, s25, v131
    v_mfma_f32_32x32x16_bf16 v[32:47], a[28:31], v[92:95], v[32:47]
    v_xor_b32 v93, s24, v93
    v_xor_b32 v95, s24, v95
    ds_read_b64_tr_b16 v[156:157], v25 offset:3584
    ds_read_b64_tr_b16 v[158:159], v25 offset:3840
    v_mfma_f32_32x32x16_bf16 v[48:63], a[24:27], v[88:91], v[48:63]
    v_mov_b32 v76, 0
    v_mov_b32 v77, 0
    v_mov_b32 v78, 0
    v_mov_b32 v79, 0
    buffer_load_dwordx4 v[124:127], v2, s[28:31], s4 offen offset:3072 sc1
    v_xor_b32 v133, s25, v133
    v_xor_b32 v135, s25, v135
    v_mfma_f32_32x32x16_bf16 v[64:79], a[0:3], v[128:131], v[64:79]
    v_xor_b32 v129, s24, v129
    v_xor_b32 v131, s24, v131
    v_mfma_f32_32x32x16_bf16 v[48:63], a[28:31], v[92:95], v[48:63]
    s_xor_b32 s45, s3, 1
    s_mul_i32 s45, s45, 6144
    s_add_u32 s45, s45, 0
    v_add_u32 v6, s45, v1
    v_xor_b32 v137, s25, v137
    v_xor_b32_e64 v139, s25, v139
    v_mfma_f32_32x32x16_bf16 v[64:79], a[4:7], v[132:135], v[64:79]
    v_xor_b32_e64 v133, s24, v133
    v_xor_b32 v135, s24, v135
    v_mfma_f32_32x32x16_bf16 v[80:95], a[0:3], v[128:131], 0
    s_xor_b32 s45, s3, 2
    s_mul_i32 s45, s45, 6144
    s_add_u32 s45, s45, 2048
    v_add_u32 v7, s45, v1
    s_add_u32 s4, s4, s23
    buffer_load_dwordx4 v[128:131], v2, s[28:31], s4 offen offset:0 sc1
    v_xor_b32 v141, s25, v141
    v_xor_b32 v143, s25, v143
    v_mfma_f32_32x32x16_bf16 v[64:79], a[8:11], v[136:139], v[64:79]
    v_xor_b32_e64 v137, s24, v137
    v_xor_b32 v139, s24, v139
    v_mfma_f32_32x32x16_bf16 v[80:95], a[4:7], v[132:135], v[80:95]
    s_xor_b32 s45, s3, 3
    s_mul_i32 s45, s45, 6144
    s_add_u32 s45, s45, 4096
    v_add_u32_e64 v8, s45, v1
    buffer_load_dwordx4 v[132:135], v2, s[28:31], s4 offen offset:1024 sc1
    s_waitcnt lgkmcnt(0)
    v_xor_b32 v17, s25, v17
    v_xor_b32_e64 v19, s25, v19
    v_mfma_f32_32x32x16_bf16 v[64:79], a[12:15], v[140:143], v[64:79]
    v_xor_b32 v141, s24, v141
    v_xor_b32 v143, s24, v143
    v_mfma_f32_32x32x16_bf16 v[80:95], a[8:11], v[136:139], v[80:95]
    buffer_load_dwordx4 v[136:139], v2, s[28:31], s4 offen offset:2048 sc1
    s_waitcnt vmcnt(11)
    s_barrier
    s_cmp_lg_u32 s3, 0
    s_cbranch_scc1 Lfl_37
    v_mov_b32 v9, 4
    v_lshlrev_b32 v11, 2, v0
    s_mov_b64 exec, 0xffff
    buffer_store_dword v9, v11, s[28:31], s63 offen sc1
    s_mov_b64 exec, -1
Lfl_37:
    v_xor_b32 v21, s25, v21
    v_xor_b32_e64 v23, s25, v23
    v_mfma_f32_32x32x16_bf16 v[64:79], a[16:19], v[16:19], v[64:79]
    v_xor_b32 v17, s24, v17
    v_xor_b32 v19, s24, v19
    v_mfma_f32_32x32x16_bf16 v[80:95], a[12:15], v[140:143], v[80:95]
    buffer_load_dwordx4 v[140:143], v2, s[28:31], s4 offen offset:3072 sc1
    v_xor_b32 v29, s25, v29
    v_xor_b32 v31, s25, v31
    v_mfma_f32_32x32x16_bf16 v[64:79], a[20:23], v[20:23], v[64:79]
    v_xor_b32 v21, s24, v21
    v_xor_b32 v23, s24, v23
    v_mfma_f32_32x32x16_bf16 v[80:95], a[16:19], v[16:19], v[80:95]
    s_add_u32 s4, s4, s22
    buffer_load_dwordx4 v[16:19], v2, s[28:31], s4 offen offset:0 sc1
    v_xor_b32 v157, s25, v157
    v_xor_b32_e64 v159, s25, v159
    v_mfma_f32_32x32x16_bf16 v[64:79], a[24:27], v[28:31], v[64:79]
    v_xor_b32 v29, s24, v29
    v_xor_b32 v31, s24, v31
    v_mfma_f32_32x32x16_bf16 v[80:95], a[20:23], v[20:23], v[80:95]
    buffer_load_dwordx4 v[20:23], v2, s[28:31], s4 offen offset:1024 sc1
    v_mfma_f32_32x32x16_bf16 v[64:79], a[28:31], v[156:159], v[64:79]
    v_xor_b32 v157, s24, v157
    v_xor_b32 v159, s24, v159
    v_mfma_f32_32x32x16_bf16 v[80:95], a[24:27], v[28:31], v[80:95]
    s_nop 0
    v_mfma_f32_32x32x16_bf16 v[80:95], a[28:31], v[156:159], v[80:95]
    s_waitcnt vmcnt(13)
    v_mfma_f32_32x32x16_bf16 v[32:47], a[128:131], v[96:99], v[32:47]
    v_mfma_f32_32x32x16_bf16 v[48:63], a[132:135], v[96:99], v[48:63]
    buffer_load_dwordx4 v[96:99], v2, s[28:31], s4 offen offset:2048 sc1
    s_waitcnt vmcnt(13)
    v_mfma_f32_32x32x16_bf16 v[32:47], a[136:139], v[100:103], v[32:47]
    v_mfma_f32_32x32x16_bf16 v[48:63], a[140:143], v[100:103], v[48:63]
    buffer_load_dwordx4 v[100:103], v2, s[28:31], s4 offen offset:3072 sc1
    s_waitcnt vmcnt(13)
    v_mfma_f32_32x32x16_bf16 v[32:47], a[144:147], v[104:107], v[32:47]
    v_mfma_f32_32x32x16_bf16 v[48:63], a[148:151], v[104:107], v[48:63]
    s_add_u32 s4, s4, s23
    buffer_load_dwordx4 v[104:107], v2, s[28:31], s4 offen offset:0 sc1
    s_waitcnt vmcnt(13)
    v_mfma_f32_32x32x16_bf16 v[32:47], a[152:155], v[108:111], v[32:47]
    v_mfma_f32_32x32x16_bf16 v[48:63], a[156:159], v[108:111], v[48:63]
    buffer_load_dwordx4 v[108:111], v2, s[28:31], s4 offen offset:1024 sc1
    s_waitcnt vmcnt(13)
    v_mfma_f32_32x32x16_bf16 v[32:47], a[160:163], v[112:115], v[32:47]
    v_mfma_f32_32x32x16_bf16 v[48:63], a[164:167], v[112:115], v[48:63]
    buffer_load_dwordx4 v[112:115], v2, s[28:31], s4 offen offset:2048 sc1
    s_waitcnt vmcnt(13)
    v_mfma_f32_32x32x16_bf16 v[32:47], a[168:171], v[116:119], v[32:47]
    v_mfma_f32_32x32x16_bf16 v[48:63], a[172:175], v[116:119], v[48:63]
    buffer_load_dwordx4 v[116:119], v2, s[28:31], s4 offen offset:3072 sc1
    buffer_load_dword v13, v10, s[28:31], s40 offen sc1
    s_waitcnt vmcnt(14)
    s_nop 0
    v_mfma_f32_32x32x16_bf16 v[32:47], a[176:179], v[120:123], v[32:47]
    v_mfma_f32_32x32x16_bf16 v[48:63], a[180:183], v[120:123], v[48:63]
    s_add_u32 s4, s4, s22
    buffer_load_dwordx4 v[120:123], v2, s[28:31], s4 offen offset:0 sc1
    s_waitcnt vmcnt(14)
    v_mfma_f32_32x32x16_bf16 v[32:47], a[184:187], v[124:127], v[32:47]
    v_mfma_f32_32x32x16_bf16 v[48:63], a[188:191], v[124:127], v[48:63]
    buffer_load_dwordx4 v[124:127], v2, s[28:31], s4 offen offset:1024 sc1
    s_waitcnt vmcnt(14)
    v_mfma_f32_32x32x16_bf16 v[32:47], a[192:195], v[128:131], v[32:47]
    v_mfma_f32_32x32x16_bf16 v[48:63], a[196:199], v[128:131], v[48:63]
    buffer_load_dwordx4 v[128:131], v2, s[28:31], s4 offen offset:2048 sc1
    s_waitcnt vmcnt(14)
    v_mfma_f32_32x32x16_bf16 v[32:47], a[200:203], v[132:135], v[32:47]
    v_mfma_f32_32x32x16_bf16 v[48:63], a[204:207], v[132:135], v[48:63]
    buffer_load_dwordx4 v[132:135], v2, s[28:31], s4 offen offset:3072 sc1
    s_waitcnt vmcnt(14)
    v_mfma_f32_32x32x16_bf16 v[32:47], a[208:211], v[136:139], v[32:47]
    v_mfma_f32_32x32x16_bf16 v[48:63], a[212:215], v[136:139], v[48:63]
    s_add_u32 s4, s4, s23
    buffer_load_dwordx4 v[136:139], v2, s[28:31], s4 offen offset:0 sc1
    s_waitcnt vmcnt(14)
    v_mfma_f32_32x32x16_bf16 v[32:47], a[216:219], v[140:143], v[32:47]
    v_mfma_f32_32x32x16_bf16 v[48:63], a[220:223], v[140:143], v[48:63]
    buffer_load_dwordx4 v[140:143], v2, s[28:31], s4 offen offset:1024 sc1
    s_waitcnt vmcnt(14)
    v_mfma_f32_32x32x16_bf16 v[32:47], a[224:227], v[16:19], v[32:47]
    v_mfma_f32_32x32x16_bf16 v[48:63], a[228:231], v[16:19], v[48:63]
    buffer_load_dwordx4 v[16:19], v2, s[28:31], s4 offen offset:2048 sc1
    s_waitcnt vmcnt(14)
    v_mfma_f32_32x32x16_bf16 v[32:47], a[232:235], v[20:23], v[32:47]
    v_mfma_f32_32x32x16_bf16 v[48:63], a[236:239], v[20:23], v[48:63]
    buffer_load_dwordx4 v[20:23], v2, s[28:31], s4 offen offset:3072 sc1
    s_waitcnt vmcnt(14)
    v_mfma_f32_32x32x16_bf16 v[32:47], a[240:243], v[96:99], v[32:47]
    v_mfma_f32_32x32x16_bf16 v[48:63], a[244:247], v[96:99], v[48:63]
    s_waitcnt vmcnt(13)
    v_mfma_f32_32x32x16_bf16 v[32:47], a[248:251], v[100:103], v[32:47]
    v_mfma_f32_32x32x16_bf16 v[48:63], a[252:255], v[100:103], v[48:63]
    s_waitcnt vmcnt(12)
    v_mfma_f32_32x32x16_bf16 v[32:47], v[160:163], v[104:107], v[32:47]
    v_mfma_f32_32x32x16_bf16 v[48:63], v[164:167], v[104:107], v[48:63]
    s_waitcnt vmcnt(8)
    v_cmp_gt_u32 vcc, 4, v13
    s_mov_b32 s60, 0
    s_cbranch_vccz Lok_38
Lretry_39:
    buffer_load_dword v13, v10, s[28:31], s40 offen sc1
    s_waitcnt vmcnt(0)
    v_cmp_gt_u32 vcc, 4, v13
    s_add_u32 s60, s60, 1
    s_cbranch_vccz Lok_38
    s_sleep 1
    s_cmp_lt_u32 s60, s61
    s_cbranch_scc1 Lretry_39
    s_mov_b32 s61, 1
Lok_38:
    buffer_load_dwordx4 v[96:99], v2, s[28:31], s5 offen offset:0 sc1
    buffer_load_dwordx4 v[100:103], v2, s[28:31], s5 offen offset:1024 sc1
    s_waitcnt vmcnt(13)
    v_mfma_f32_32x32x16_bf16 v[32:47], v[168:171], v[108:111], v[32:47]
    v_mfma_f32_32x32x16_bf16 v[48:63], v[172:175], v[108:111], v[48:63]
    buffer_load_dwordx4 v[104:107], v2, s[28:31], s5 offen offset:2048 sc1
    buffer_load_dwordx4 v[108:111], v2, s[28:31], s5 offen offset:3072 sc1
    s_waitcnt vmcnt(14)
    v_mfma_f32_32x32x16_bf16 v[32:47], v[176:179], v[112:115], v[32:47]
    v_mfma_f32_32x32x16_bf16 v[48:63], v[180:183], v[112:115], v[48:63]
    s_add_u32 s5, s5, s22
    buffer_load_dwordx4 v[112:115], v2, s[28:31], s5 offen offset:0 sc1
    s_waitcnt vmcnt(14)
    v_mfma_f32_32x32x16_bf16 v[32:47], v[184:187], v[116:119], v[32:47]
    v_mfma_f32_32x32x16_bf16 v[48:63], v[188:191], v[116:119], v[48:63]
    buffer_load_dwordx4 v[116:119], v2, s[28:31], s5 offen offset:1024 sc1
    s_waitcnt vmcnt(13)
    v_mfma_f32_32x32x16_bf16 v[32:47], v[192:195], v[120:123], v[32:47]
    v_mfma_f32_32x32x16_bf16 v[48:63], v[196:199], v[120:123], v[48:63]
    buffer_load_dwordx4 v[120:123], v2, s[28:31], s5 offen offset:2048 sc1
    s_waitcnt vmcnt(13)
    v_mfma_f32_32x32x16_bf16 v[32:47], v[200:203], v[124:127], v[32:47]
    v_mfma_f32_32x32x16_bf16 v[48:63], v[204:207], v[124:127], v[48:63]
    buffer_load_dwordx4 v[124:127], v2, s[28:31], s5 offen offset:3072 sc1
    s_waitcnt vmcnt(13)
    v_mfma_f32_32x32x16_bf16 v[32:47], v[208:211], v[128:131], v[32:47]
    v_mfma_f32_32x32x16_bf16 v[48:63], v[212:215], v[128:131], v[48:63]
    s_add_u32 s5, s5, s23
    buffer_load_dwordx4 v[128:131], v2, s[28:31], s5 offen offset:0 sc1
    s_waitcnt vmcnt(13)
    v_mfma_f32_32x32x16_bf16 v[32:47], v[216:219], v[132:135], v[32:47]
    v_mfma_f32_32x32x16_bf16 v[48:63], v[220:223], v[132:135], v[48:63]
    buffer_load_dwordx4 v[132:135], v2, s[28:31], s5 offen offset:1024 sc1
    s_waitcnt vmcnt(13)
    v_mfma_f32_32x32x16_bf16 v[32:47], v[224:227], v[136:139], v[32:47]
    v_mfma_f32_32x32x16_bf16 v[48:63], v[228:231], v[136:139], v[48:63]
    buffer_load_dwordx4 v[136:139], v2, s[28:31], s5 offen offset:2048 sc1
    s_waitcnt vmcnt(13)
    v_mfma_f32_32x32x16_bf16 v[32:47], v[232:235], v[140:143], v[32:47]
    v_mfma_f32_32x32x16_bf16 v[48:63], v[236:239], v[140:143], v[48:63]
    buffer_load_dwordx4 v[140:143], v2, s[28:31], s5 offen offset:3072 sc1
    s_waitcnt vmcnt(13)
    v_mfma_f32_32x32x16_bf16 v[32:47], v[240:243], v[16:19], v[32:47]
    v_mfma_f32_32x32x16_bf16 v[48:63], v[244:247], v[16:19], v[48:63]
    s_add_u32 s5, s5, s22
    buffer_load_dwordx4 v[16:19], v2, s[28:31], s5 offen offset:0 sc1
    s_waitcnt vmcnt(13)
    v_mfma_f32_32x32x16_bf16 v[32:47], v[248:251], v[20:23], v[32:47]
    v_mfma_f32_32x32x16_bf16 v[48:63], v[252:255], v[20:23], v[48:63]
    buffer_load_dwordx4 v[20:23], v2, s[28:31], s5 offen offset:1024 sc1
    s_waitcnt vmcnt(13)
    v_mfma_f32_32x32x16_bf16 v[64:79], a[128:131], v[96:99], v[64:79]
    v_mfma_f32_32x32x16_bf16 v[80:95], a[132:135], v[96:99], v[80:95]
    buffer_load_dwordx4 v[96:99], v2, s[28:31], s5 offen offset:2048 sc1
    s_waitcnt vmcnt(13)
    v_mfma_f32_32x32x16_bf16 v[64:79], a[136:139], v[100:103], v[64:79]
    v_mfma_f32_32x32x16_bf16 v[80:95], a[140:143], v[100:103], v[80:95]
    s_nop 2
    ds_write_b128 v6, v[40:43] offset:0
    buffer_load_dwordx4 v[100:103], v2, s[28:31], s5 offen offset:3072 sc1
    s_waitcnt vmcnt(13)
    v_mfma_f32_32x32x16_bf16 v[64:79], a[144:147], v[104:107], v[64:79]
    ds_write_b128 v6, v[44:47] offset:1024
    v_mfma_f32_32x32x16_bf16 v[80:95], a[148:151], v[104:107], v[80:95]
    ds_write_b128 v7, v[48:51] offset:0
    s_add_u32 s5, s5, s23
    buffer_load_dwordx4 v[104:107], v2, s[28:31], s5 offen offset:0 sc1
    s_waitcnt vmcnt(13)
    v_mfma_f32_32x32x16_bf16 v[64:79], a[152:155], v[108:111], v[64:79]
    ds_write_b128 v7, v[52:55] offset:1024
    v_mfma_f32_32x32x16_bf16 v[80:95], a[156:159], v[108:111], v[80:95]
    ds_write_b128 v8, v[56:59] offset:0
    buffer_load_dwordx4 v[108:111], v2, s[28:31], s5 offen offset:1024 sc1
    s_waitcnt vmcnt(13)
    s_nop 0
    v_mfma_f32_32x32x16_bf16 v[64:79], a[160:163], v[112:115], v[64:79]
    ds_write_b128 v8, v[60:63] offset:1024
    v_mfma_f32_32x32x16_bf16 v[80:95], a[164:167], v[112:115], v[80:95]
    buffer_load_dwordx4 v[112:115], v2, s[28:31], s5 offen offset:2048 sc1
    s_waitcnt vmcnt(13)
    v_mfma_f32_32x32x16_bf16 v[64:79], a[168:171], v[116:119], v[64:79]
    v_mfma_f32_32x32x16_bf16 v[80:95], a[172:175], v[116:119], v[80:95]
    buffer_load_dwordx4 v[116:119], v2, s[28:31], s5 offen offset:3072 sc1
    s_waitcnt vmcnt(13)
    v_mfma_f32_32x32x16_bf16 v[64:79], a[176:179], v[120:123], v[64:79]
    v_mfma_f32_32x32x16_bf16 v[80:95], a[180:183], v[120:123], v[80:95]
    s_add_u32 s5, s5, s22
    buffer_load_dwordx4 v[120:123], v2, s[28:31], s5 offen offset:0 sc1
    s_waitcnt vmcnt(13)
    v_mfma_f32_32x32x16_bf16 v[64:79], a[184:187], v[124:127], v[64:79]
    s_waitcnt lgkmcnt(0)
    s_barrier
    ds_read_b128 v[40:43], v5 offset:0
    ds_read_b128 v[44:47], v5 offset:1024
    v_mfma_f32_32x32x16_bf16 v[80:95], a[188:191], v[124:127], v[80:95]
    ds_read_b128 v[48:51], v5 offset:2048
    ds_read_b128 v[52:55], v5 offset:3072
    buffer_load_dwordx4 v[124:127], v2, s[28:31], s5 offen offset:1024 sc1
    s_waitcnt vmcnt(13)
    v_mfma_f32_32x32x16_bf16 v[64:79], a[192:195], v[128:131], v[64:79]
    ds_read_b128 v[56:59], v5 offset:4096
    ds_read_b128 v[60:63], v5 offset:5120
    v_mfma_f32_32x32x16_bf16 v[80:95], a[196:199], v[128:131], v[80:95]
    buffer_load_dwordx4 v[128:131], v2, s[28:31], s5 offen offset:2048 sc1
    s_waitcnt vmcnt(13)
    v_mfma_f32_32x32x16_bf16 v[64:79], a[200:203], v[132:135], v[64:79]
    v_mfma_f32_32x32x16_bf16 v[80:95], a[204:207], v[132:135], v[80:95]
    buffer_load_dwordx4 v[132:135], v2, s[28:31], s5 offen offset:3072 sc1
    s_waitcnt vmcnt(13)
    v_mfma_f32_32x32x16_bf16 v[64:79], a[208:211], v[136:139], v[64:79]
    v_mfma_f32_32x32x16_bf16 v[80:95], a[212:215], v[136:139], v[80:95]
    s_waitcnt lgkmcnt(4)
    s_add_u32 s5, s5, s23
    buffer_load_dwordx4 v[136:139], v2, s[28:31], s5 offen offset:0 sc1
    s_waitcnt vmcnt(13)
    v_mfma_f32_32x32x16_bf16 v[64:79], a[216:219], v[140:143], v[64:79]
    v_add_f32_e64 v32, v32, v40
    v_mfma_f32_32x32x16_bf16 v[80:95], a[220:223], v[140:143], v[80:95]
    v_add_f32 v33, v33, v41
    buffer_load_dwordx4 v[140:143], v2, s[28:31], s5 offen offset:1024 sc1
    s_waitcnt vmcnt(13)
    v_mfma_f32_32x32x16_bf16 v[64:79], a[224:227], v[16:19], v[64:79]
    v_add_f32_e64 v34, v34, v42
    v_mfma_f32_32x32x16_bf16 v[80:95], a[228:231], v[16:19], v[80:95]
    v_add_f32 v35, v35, v43
    buffer_load_dwordx4 v[16:19], v2, s[28:31], s5 offen offset:2048 sc1
    s_waitcnt vmcnt(13)
    v_mfma_f32_32x32x16_bf16 v[64:79], a[232:235], v[20:23], v[64:79]
    v_add_f32_e64 v36, v36, v44
    v_mfma_f32_32x32x16_bf16 v[80:95], a[236:239], v[20:23], v[80:95]
    v_add_f32 v37, v37, v45
    buffer_load_dwordx4 v[20:23], v2, s[28:31], s5 offen offset:3072 sc1
    s_waitcnt vmcnt(13)
    v_mfma_f32_32x32x16_bf16 v[64:79], a[240:243], v[96:99], v[64:79]
    v_add_f32_e64 v38, v38, v46
    v_mfma_f32_32x32x16_bf16 v[80:95], a[244:247], v[96:99], v[80:95]
    v_add_f32_e64 v39, v39, v47
    s_waitcnt vmcnt(12)
    v_mfma_f32_32x32x16_bf16 v[64:79], a[248:251], v[100:103], v[64:79]
    s_waitcnt lgkmcnt(0)
    v_mfma_f32_32x32x16_bf16 v[80:95], a[252:255], v[100:103], v[80:95]
    v_add_f32 v48, v48, v56
    s_waitcnt vmcnt(11)
    v_mfma_f32_32x32x16_bf16 v[64:79], v[160:163], v[104:107], v[64:79]
    v_add_f32_e64 v49, v49, v57
    v_mfma_f32_32x32x16_bf16 v[80:95], v[164:167], v[104:107], v[80:95]
    v_add_f32 v50, v50, v58
    s_waitcnt vmcnt(10)
    v_mfma_f32_32x32x16_bf16 v[64:79], v[168:171], v[108:111], v[64:79]
    v_add_f32_e64 v51, v51, v59
    v_mfma_f32_32x32x16_bf16 v[80:95], v[172:175], v[108:111], v[80:95]
    v_add_f32 v52, v52, v60
    s_waitcnt vmcnt(9)
    v_mfma_f32_32x32x16_bf16 v[64:79], v[176:179], v[112:115], v[64:79]
    v_add_f32 v53, v53, v61
    v_mfma_f32_32x32x16_bf16 v[80:95], v[180:183], v[112:115], v[80:95]
    s_waitcnt vmcnt(8)
    v_mfma_f32_32x32x16_bf16 v[64:79], v[184:187], v[116:119], v[64:79]
    v_add_f32_e64 v54, v54, v62
    v_mfma_f32_32x32x16_bf16 v[80:95], v[188:191], v[116:119], v[80:95]
    v_add_f32 v55, v55, v63
    s_waitcnt vmcnt(7)
    v_add_f32_e64 v32, v32, v48
    v_mfma_f32_32x32x16_bf16 v[80:95], v[196:199], v[120:123], v[80:95]
    v_add_f32 v33, v33, v49
    s_waitcnt vmcnt(6)
    v_add_f32_e64 v34, v34, v50
    v_mfma_f32_32x32x16_bf16 v[80:95], v[204:207], v[124:127], v[80:95]
    v_add_f32 v35, v35, v51
    s_waitcnt vmcnt(5)
    v_add_f32_e64 v36, v36, v52
    v_mfma_f32_32x32x16_bf16 v[80:95], v[212:215], v[128:131], v[80:95]
    v_add_f32 v37, v37, v53
    s_waitcnt vmcnt(4)
    v_add_f32_e64 v38, v38, v54
    v_mfma_f32_32x32x16_bf16 v[80:95], v[220:223], v[132:135], v[80:95]
    v_add_f32 v39, v39, v55
    s_waitcnt vmcnt(3)
    v_cvt_pk_bf16_f32 v144, v32, v33
    v_mfma_f32_32x32x16_bf16 v[80:95], v[228:231], v[136:139], v[80:95]
    v_cvt_pk_bf16_f32 v145, v34, v35
    s_waitcnt vmcnt(2)
    v_cvt_pk_bf16_f32 v146, v36, v37
    v_mfma_f32_32x32x16_bf16 v[80:95], v[236:239], v[140:143], v[80:95]
    v_cvt_pk_bf16_f32 v147, v38, v39
    s_waitcnt vmcnt(1)
    buffer_store_dwordx4 v[144:147], v3, s[36:39], s6 offen
    v_mfma_f32_32x32x16_bf16 v[80:95], v[244:247], v[16:19], v[80:95]
    s_waitcnt vmcnt(1)
    v_mfma_f32_32x32x16_bf16 v[80:95], v[252:255], v[20:23], v[80:95]
    v_mfma_f32_32x32x16_bf16 v[64:79], v[192:195], v[120:123], v[64:79]
    v_mfma_f32_32x32x16_bf16 v[64:79], v[200:203], v[124:127], v[64:79]
    v_mfma_f32_32x32x16_bf16 v[64:79], v[208:211], v[128:131], v[64:79]
    s_nop 8
    ds_write_b128 v7, v[80:83] offset:24576
    v_mfma_f32_32x32x16_bf16 v[64:79], v[216:219], v[132:135], v[64:79]
    ds_write_b128 v7, v[84:87] offset:25600
    v_mfma_f32_32x32x16_bf16 v[64:79], v[224:227], v[136:139], v[64:79]
    v_mfma_f32_32x32x16_bf16 v[64:79], v[232:235], v[140:143], v[64:79]
    ds_write_b128 v8, v[88:91] offset:24576
    v_mfma_f32_32x32x16_bf16 v[64:79], v[240:243], v[16:19], v[64:79]
    ds_write_b128 v8, v[92:95] offset:25600
    v_mfma_f32_32x32x16_bf16 v[64:79], v[248:251], v[20:23], v[64:79]
    s_nop 11
    s_nop 0
    ds_write_b128 v6, v[72:75] offset:24576
    ds_write_b128 v6, v[76:79] offset:25600
    s_waitcnt lgkmcnt(0)
    s_barrier
    ds_read_b128 v[72:75], v5 offset:24576
    ds_read_b128 v[76:79], v5 offset:25600
    ds_read_b128 v[80:83], v5 offset:26624
    ds_read_b128 v[84:87], v5 offset:27648
    ds_read_b128 v[88:91], v5 offset:28672
    ds_read_b128 v[92:95], v5 offset:29696
    s_waitcnt lgkmcnt(4)
    v_pk_add_f32 v[64:65], v[64:65], v[72:73]
    v_pk_add_f32 v[66:67], v[66:67], v[74:75]
    v_pk_add_f32 v[68:69], v[68:69], v[76:77]
    v_pk_add_f32 v[70:71], v[70:71], v[78:79]
    s_waitcnt lgkmcnt(0)
    v_pk_add_f32 v[80:81], v[80:81], v[88:89]
    v_pk_add_f32 v[82:83], v[82:83], v[90:91]
    v_pk_add_f32 v[84:85], v[84:85], v[92:93]
    v_pk_add_f32 v[86:87], v[86:87], v[94:95]
    v_pk_add_f32 v[64:65], v[64:65], v[80:81]
    v_pk_add_f32 v[66:67], v[66:67], v[82:83]
    v_pk_add_f32 v[68:69], v[68:69], v[84:85]
    v_pk_add_f32 v[70:71], v[70:71], v[86:87]
    v_cvt_pk_bf16_f32 v148, v64, v65
    v_cvt_pk_bf16_f32 v149, v66, v67
    v_cvt_pk_bf16_f32 v150, v68, v69
    v_cvt_pk_bf16_f32 v151, v70, v71
    buffer_store_dwordx4 v[148:151], v3, s[36:39], s7 offen
    s_endpgm
L_g1_spare1:
    s_cmp_lg_u32 s3, 0
    s_cbranch_scc1 Lskip_40
    s_mov_b32 s60, 0
Lpoll_41:
    buffer_load_dword v13, v15, s[28:31], s62 offen offset:12 sc1
    s_waitcnt vmcnt(0)
    v_cmp_ne_u32 vcc, 8, v13
    s_add_u32 s60, s60, 1
    s_cbranch_vccz Lskip_40
    s_cmp_lt_u32 s60, s61
    s_cbranch_scc1 Lpoll_41
    s_mov_b32 s61, 1
Lskip_40:
    s_barrier
    s_and_b32 s45, s43, 1
    s_lshl_b32 s48, s45, 16
    s_add_u32 s48, s48, s47
    s_mul_i32 s12, s45, 33024
    s_add_u32 s46, s46, s12
    s_add_u32 m0, s46, 0
    s_add_u32 s57, s48, 0
    buffer_load_dwordx4 v1, s[28:31], s57 offen offset:0 sc1 lds
    buffer_load_dwordx4 v1, s[28:31], s57 offen offset:1024 sc1 lds
    buffer_load_dwordx4 v1, s[28:31], s57 offen offset:2048 sc1 lds
    buffer_load_dwordx4 v1, s[28:31], s57 offen offset:3072 sc1 lds
    s_add_u32 m0, s46, 16512
    s_add_u32 s57, s48, 32768
    buffer_load_dwordx4 v1, s[28:31], s57 offen offset:0 sc1 lds
    buffer_load_dwordx4 v1, s[28:31], s57 offen offset:1024 sc1 lds
    buffer_load_dwordx4 v1, s[28:31], s57 offen offset:2048 sc1 lds
    buffer_load_dwordx4 v1, s[28:31], s57 offen offset:3072 sc1 lds
    s_add_u32 m0, s46, 66048
    s_add_u32 s57, s48, 131072
    buffer_load_dwordx4 v1, s[28:31], s57 offen offset:0 sc1 lds
    buffer_load_dwordx4 v1, s[28:31], s57 offen offset:1024 sc1 lds
    buffer_load_dwordx4 v1, s[28:31], s57 offen offset:2048 sc1 lds
    buffer_load_dwordx4 v1, s[28:31], s57 offen offset:3072 sc1 lds
    s_add_u32 m0, s46, 82560
    s_add_u32 s57, s48, 163840
    buffer_load_dwordx4 v1, s[28:31], s57 offen offset:0 sc1 lds
    buffer_load_dwordx4 v1, s[28:31], s57 offen offset:1024 sc1 lds
    buffer_load_dwordx4 v1, s[28:31], s57 offen offset:2048 sc1 lds
    buffer_load_dwordx4 v1, s[28:31], s57 offen offset:3072 sc1 lds
    s_lshl_b32 s45, s45, 8
    s_add_u32 s49, s49, s45
    v_add_u32_e64 v16, s12, v16
    v_add_u32 v17, 66048, v16
    v_lshrrev_b32 v8, 5, v0
    v_lshl_add_u32 v22, v8, 9, v22
    v_lshl_add_u32 v23, v8, 9, v23
    s_waitcnt vmcnt(8)
    ds_read_b64_tr_b16 v[32:33], v16 offset:0
    ds_read_b64_tr_b16 v[34:35], v16 offset:256
    ds_read_b64_tr_b16 v[36:37], v16 offset:512
    ds_read_b64_tr_b16 v[38:39], v16 offset:768
    ds_read_b64_tr_b16 v[40:41], v16 offset:1024
    ds_read_b64_tr_b16 v[42:43], v16 offset:1280
    ds_read_b64_tr_b16 v[44:45], v16 offset:1536
    ds_read_b64_tr_b16 v[46:47], v16 offset:1792
    ds_read_b64_tr_b16 v[48:49], v16 offset:2048
    ds_read_b64_tr_b16 v[50:51], v16 offset:2304
    ds_read_b64_tr_b16 v[52:53], v16 offset:2560
    ds_read_b64_tr_b16 v[54:55], v16 offset:2816
    s_waitcnt lgkmcnt(8)
    s_nop 0
    ds_read_b64_tr_b16 v[56:57], v16 offset:3072
    ds_read_b64_tr_b16 v[58:59], v16 offset:3328
    ds_read_b64_tr_b16 v[60:61], v16 offset:3584
    ds_read_b64_tr_b16 v[62:63], v16 offset:3840
    v_and_b32 v32, v21, v32
    s_waitcnt lgkmcnt(12)
    v_dot2_f32_bf16 v96, v32, v32, 0
    v_dot2_f32_bf16 v97, v33, v33, 0
    v_dot2_f32_bf16 v98, v34, v34, 0
    v_dot2_f32_bf16 v99, v35, v35, 0
    v_dot2_f32_bf16 v96, v36, v36, v96
    v_dot2_f32_bf16 v97, v37, v37, v97
    v_dot2_f32_bf16 v98, v38, v38, v98
    v_dot2_f32_bf16 v99, v39, v39, v99
    s_waitcnt lgkmcnt(8)
    v_dot2_f32_bf16 v96, v40, v40, v96
    v_dot2_f32_bf16 v97, v41, v41, v97
    v_dot2_f32_bf16 v98, v42, v42, v98
    v_dot2_f32_bf16 v99, v43, v43, v99
    v_dot2_f32_bf16 v96, v44, v44, v96
    v_dot2_f32_bf16 v97, v45, v45, v97
    v_dot2_f32_bf16 v98, v46, v46, v98
    v_dot2_f32_bf16 v99, v47, v47, v99
    s_waitcnt lgkmcnt(4)
    v_dot2_f32_bf16 v96, v48, v48, v96
    v_dot2_f32_bf16 v97, v49, v49, v97
    v_dot2_f32_bf16 v98, v50, v50, v98
    v_dot2_f32_bf16 v99, v51, v51, v99
    v_dot2_f32_bf16 v96, v52, v52, v96
    v_dot2_f32_bf16 v97, v53, v53, v97
    v_dot2_f32_bf16 v98, v54, v54, v98
    v_dot2_f32_bf16 v99, v55, v55, v99
    s_waitcnt lgkmcnt(0)
    v_dot2_f32_bf16 v96, v56, v56, v96
    v_dot2_f32_bf16 v97, v57, v57, v97
    v_dot2_f32_bf16 v98, v58, v58, v98
    v_dot2_f32_bf16 v99, v59, v59, v99
    v_dot2_f32_bf16 v96, v60, v60, v96
    v_dot2_f32_bf16 v97, v61, v61, v97
    v_dot2_f32_bf16 v98, v62, v62, v98
    v_dot2_f32_bf16 v99, v63, v63, v99
    s_waitcnt vmcnt(0)
    ds_read_b64_tr_b16 v[64:65], v17 offset:0
    ds_read_b64_tr_b16 v[66:67], v17 offset:256
    ds_read_b64_tr_b16 v[68:69], v17 offset:512
    ds_read_b64_tr_b16 v[70:71], v17 offset:768
    ds_read_b64_tr_b16 v[72:73], v17 offset:1024
    ds_read_b64_tr_b16 v[74:75], v17 offset:1280
    ds_read_b64_tr_b16 v[76:77], v17 offset:1536
    ds_read_b64_tr_b16 v[78:79], v17 offset:1792
    ds_read_b64_tr_b16 v[80:81], v17 offset:2048
    ds_read_b64_tr_b16 v[82:83], v17 offset:2304
    ds_read_b64_tr_b16 v[84:85], v17 offset:2560
    ds_read_b64_tr_b16 v[86:87], v17 offset:2816
    s_waitcnt lgkmcnt(8)
    s_nop 0
    ds_read_b64_tr_b16 v[88:89], v17 offset:3072
    ds_read_b64_tr_b16 v[90:91], v17 offset:3328
    ds_read_b64_tr_b16 v[92:93], v17 offset:3584
    ds_read_b64_tr_b16 v[94:95], v17 offset:3840
    v_and_b32 v64, v21, v64
    s_waitcnt lgkmcnt(12)
    v_dot2_f32_bf16 v100, v64, v64, 0
    v_dot2_f32_bf16 v101, v65, v65, 0
    v_dot2_f32_bf16 v102, v66, v66, 0
    v_dot2_f32_bf16 v103, v67, v67, 0
    v_dot2_f32_bf16 v100, v68, v68, v100
    v_dot2_f32_bf16 v101, v69, v69, v101
    v_dot2_f32_bf16 v102, v70, v70, v102
    v_dot2_f32_bf16 v103, v71, v71, v103
    s_waitcnt lgkmcnt(8)
    s_nop 0
    v_dot2_f32_bf16 v100, v72, v72, v100
    v_dot2_f32_bf16 v101, v73, v73, v101
    v_dot2_f32_bf16 v102, v74, v74, v102
    v_dot2_f32_bf16 v103, v75, v75, v103
    v_dot2_f32_bf16 v100, v76, v76, v100
    v_dot2_f32_bf16 v101, v77, v77, v101
    v_dot2_f32_bf16 v102, v78, v78, v102
    v_dot2_f32_bf16 v103, v79, v79, v103
    s_waitcnt lgkmcnt(4)
    v_dot2_f32_bf16 v100, v80, v80, v100
    v_dot2_f32_bf16 v101, v81, v81, v101
    v_dot2_f32_bf16 v102, v82, v82, v102
    v_dot2_f32_bf16 v103, v83, v83, v103
    v_dot2_f32_bf16 v100, v84, v84, v100
    v_dot2_f32_bf16 v101, v85, v85, v101
    v_dot2_f32_bf16 v102, v86, v86, v102
    v_dot2_f32_bf16 v103, v87, v87, v103
    s_waitcnt lgkmcnt(0)
    v_dot2_f32_bf16 v100, v88, v88, v100
    v_dot2_f32_bf16 v101, v89, v89, v101
    v_dot2_f32_bf16 v102, v90, v90, v102
    v_dot2_f32_bf16 v103, v91, v91, v103
    v_dot2_f32_bf16 v100, v92, v92, v100
    v_dot2_f32_bf16 v101, v93, v93, v101
    v_dot2_f32_bf16 v102, v94, v94, v102
    v_dot2_f32_bf16 v103, v95, v95, v103
    v_pk_add_f32 v[96:97], v[96:97], v[98:99]
    v_add_f32 v96, v96, v97
    s_nop 0
    v_pk_add_f32 v[100:101], v[100:101], v[102:103]
    v_add_f32 v100, v100, v101
    s_nop 1
    v_permlane32_swap_b32 v96, v100
    v_add_f32 v96, v96, v100
    ds_write_b32 v23, v96
    s_waitcnt lgkmcnt(0)
    s_barrier
    s_cmp_lg_u32 s3, 0
    s_cbranch_scc1 Lnors_43
    ds_read_b128 v[28:31], v22
    v_lshlrev_b32 v8, 2, v0
    s_waitcnt lgkmcnt(0)
    v_add_f32 v28, v28, v29
    v_add_f32 v30, v30, v31
    v_add_f32_e64 v28, v28, v30
    v_mul_f32 v28, 0x3b000000, v28
    v_add_f32 v29, 0x3727c5ac, v28
    v_rsq_f32 v29, v29
    s_nop 0
    v_mul_f32_e64 v28, v28, v29
L_hop8:
    s_cbranch_execz HOPRET_2
    v_fmaak_f32 v28, v28, v29, 0x3727c5ac
    v_rsq_f32_e64 v28, v28
    v_mul_f32 v29, s58, v29
    v_mul_f32_e64 v28, v28, v29
    v_or_b32 v28, 0x80000000, v28
    buffer_store_dword v28, v8, s[28:31], s49 offen sc1
Lnors_43:
    s_barrier
    s_mov_b32 s32, s18
    s_and_b32 s33, s19, 0xffff
    s_mov_b32 s34, 0x400
    s_mov_b32 s35, 0x00020000
    buffer_load_dwordx4 v[144:147], v4, s[32:35], s9 offen
    buffer_load_dwordx4 v[200:203], v12, s[28:31], s54 offen offset:1024 sc1
    buffer_load_dwordx4 v[204:207], v12, s[28:31], s55 offen offset:1024 sc1
    buffer_load_dwordx4 v[208:211], v12, s[28:31], s54 offen offset:2048 sc1
    buffer_load_dwordx4 v[212:215], v12, s[28:31], s55 offen offset:2048 sc1
    buffer_load_dwordx4 v[216:219], v12, s[28:31], s54 offen offset:3072 sc1
    buffer_load_dwordx4 v[220:223], v12, s[28:31], s55 offen offset:3072 sc1
    s_add_u32 s54, s54, 4096
    buffer_load_dwordx4 v[224:227], v12, s[28:31], s54 offen offset:0 sc1
    s_add_u32 s55, s55, 4096
    buffer_load_dwordx4 v[228:231], v12, s[28:31], s55 offen offset:0 sc1
    buffer_load_dwordx4 v[232:235], v12, s[28:31], s54 offen offset:1024 sc1
    buffer_load_dwordx4 v[236:239], v12, s[28:31], s55 offen offset:1024 sc1
    buffer_load_dwordx4 v[240:243], v12, s[28:31], s54 offen offset:2048 sc1
    buffer_load_dwordx4 v[244:247], v12, s[28:31], s55 offen offset:2048 sc1
    buffer_load_dwordx4 v[248:251], v12, s[28:31], s54 offen offset:3072 sc1
    buffer_load_dwordx4 v[252:255], v12, s[28:31], s55 offen offset:3072 sc1
    buffer_load_dwordx4 a[0:3], v12, s[28:31], s52 offen offset:0 sc1
    buffer_load_dwordx4 a[4:7], v12, s[28:31], s52 offen offset:1024 sc1
    buffer_load_dwordx4 a[8:11], v12, s[28:31], s52 offen offset:2048 sc1
    buffer_load_dwordx4 a[12:15], v12, s[28:31], s52 offen offset:3072 sc1
    s_add_u32 s52, s52, 4096
    buffer_load_dwordx4 a[16:19], v12, s[28:31], s52 offen offset:0 sc1
    buffer_load_dwordx4 a[20:23], v12, s[28:31], s52 offen offset:1024 sc1
    buffer_load_dwordx4 a[24:27], v12, s[28:31], s52 offen offset:2048 sc1
    buffer_load_dwordx4 a[28:31], v12, s[28:31], s52 offen offset:3072 sc1
    s_waitcnt vmcnt(0)
    v_mov_b32 v13, 0
    ds_read_b64_tr_b16 v[64:65], v25 offset:0
    ds_read_b64_tr_b16 v[66:67], v25 offset:256
    ds_read_b64_tr_b16 v[68:69], v25 offset:512
    ds_read_b64_tr_b16 v[70:71], v25 offset:768
    ds_read_b64_tr_b16 v[72:73], v25 offset:1024
    ds_read_b64_tr_b16 v[74:75], v25 offset:1280
    ds_read_b64_tr_b16 v[76:77], v25 offset:1536
    ds_read_b64_tr_b16 v[78:79], v25 offset:1792
    s_waitcnt lgkmcnt(0)
    s_nop 0
    ds_read_b64_tr_b16 v[80:81], v25 offset:2048
    ds_read_b64_tr_b16 v[82:83], v25 offset:2304
    ds_read_b64_tr_b16 v[84:85], v25 offset:2560
    ds_read_b64_tr_b16 v[86:87], v25 offset:2816
    ds_read_b64_tr_b16 v[88:89], v25 offset:3072
    ds_read_b64_tr_b16 v[90:91], v25 offset:3328
    ds_read_b64_tr_b16 v[92:93], v25 offset:3584
    ds_read_b64_tr_b16 v[94:95], v25 offset:3840
    s_waitcnt lgkmcnt(0)
    s_branch L_g1_join1
L_code_end:
.section .rodata,"a"
.p2align 6
.amdhsa_kernel interleave_layers__spectral_gfnet__mixer_channel_mlp__prompt_kernel
  .amdhsa_next_free_vgpr 512
  .amdhsa_next_free_sgpr 102
  .amdhsa_accum_offset 256
  .amdhsa_group_segment_fixed_size 0
  .amdhsa_kernarg_size 88
  .amdhsa_user_sgpr_count 2
  .amdhsa_user_sgpr_kernarg_segment_ptr 1
  .amdhsa_system_sgpr_workgroup_id_x 1
.end_amdhsa_kernel
```
